```python
import torch

def _softmax(x, axis=-1):
    return torch.softmax(x, dim=axis)
def _gelu(x):
    return torch.nn.functional.gelu(x, approximate="tanh")
def _silu(x):
    return torch.nn.functional.silu(x)
def _sigmoid(x):
    return torch.sigmoid(x)
def _layernorm(x, axis=-1, eps=1e-5):
    m = x.mean(dim=axis, keepdim=True)
    v = x.var(dim=axis, keepdim=True, unbiased=False)
    return (x - m) / torch.sqrt(v + eps)
def _scatter_add(tgt, idx, src, axis=0):
    return tgt.clone().index_add_(axis, idx, src)
def _segment_sum(src, seg, n):
    out = torch.zeros((n,) + src.shape[1:], dtype=src.dtype)
    return out.index_add_(0, seg, src)
def _pad(x, pw):
    flat = tuple(v for pair in reversed(pw) for v in pair)
    return torch.nn.functional.pad(x, flat)

kernel_name = 'recurrent_scan__sliding_local_dilated__dense_activation_relu__prompt'

def setup_inputs():

    _w = (lambda a: (lambda t: t.to(torch.bfloat16) if t.is_floating_point() else t)(torch.as_tensor(a)))
    def _A_setup():
        B, S, D = 1, 2048, 448
        return {
            "x": _w((lambda *s: torch.randn(*s, dtype=torch.bfloat16) * 0.05)(B, S, D)),
            "wqkv": _w((lambda *s: torch.randn(*s, dtype=torch.bfloat16) * 0.05)(D, 3 * D)),
            "wo": _w((lambda *s: torch.randn(*s, dtype=torch.bfloat16) * 0.05)(D, D)),
        }
    _A_in = _A_setup()

    def _B_setup():
        B, S, D, Dff = 1, 2048, 448, 1792
        return {
            "x": _w((lambda *s: torch.randn(*s, dtype=torch.bfloat16) * 0.05)(B, S, D)),
            "w1": _w((lambda *s: torch.randn(*s, dtype=torch.bfloat16) * 0.05)(D, Dff)),
            "w2": _w((lambda *s: torch.randn(*s, dtype=torch.bfloat16) * 0.05)(Dff, D)),
        }
    _B_in = _B_setup()

    return {
        "A_x": _A_in["x"],
        "A_wqkv": _A_in["wqkv"],
        "A_wo": _A_in["wo"],
        "B_x": _B_in["x"],
        "B_w1": _B_in["w1"],
        "B_w2": _B_in["w2"],
    }

def reference(A_x, A_wqkv, A_wo, B_x, B_w1, B_w2):
    def _A_ref(x, wqkv, wo):
        B, S, D = x.shape
        H = 16; Dh = D // H
        W, dil = 8, 2
        qkv = (lambda x, *d: x.permute(*d))((x @ wqkv).reshape(B, S, 3, H, Dh), 2, 0, 3, 1, 4)
        q, k, v = qkv[0], qkv[1], qkv[2]
        scale = Dh ** -0.5
        pos = torch.arange(S)
        off = torch.arange(W) * dil
        idx = pos[:, None] - off[None, :]
        mask = idx >= 0
        idx_c = torch.where(mask, idx, 0).reshape(-1)
        kg = k[:, :, idx_c, :].reshape(B, H, S, W, Dh)
        vg = v[:, :, idx_c, :].reshape(B, H, S, W, Dh)
        logits = torch.einsum("bhsd,bhswd->bhsw", q, kg) * scale
        logits = torch.where(mask[None, None, :, :], logits, -1e9)
        attn = _softmax(logits, axis=-1)
        o = torch.einsum("bhsw,bhswd->bhsd", attn, vg)
        return (lambda x, *d: x.permute(*d))(o, 0, 2, 1, 3).reshape(B, S, D) @ wo

    def _B_ref(x, w1, w2):
        h = torch.einsum("bsd,df->bsf", x, w1)
        zero = torch.zeros_like(h)
        h = torch.maximum(h, zero)
        return torch.einsum("bsf,fd->bsd", h, w2)

    x = A_x
    xn = _layernorm(x, axis=-1)
    s = _A_ref(xn, A_wqkv, A_wo)
    g = _silu(_B_ref(xn, B_w1, B_w2))
    return x + s * g
```

```asm
; @launch grid=(256,1,1) block=(512,1,1) lds=163840
.amdgcn_target "amdgcn-amd-amdhsa--gfx950"
.text
.globl recurrent_scan__sliding_local_dilated__dense_activation_relu__prompt_kernel
.p2align 8
.type recurrent_scan__sliding_local_dilated__dense_activation_relu__prompt_kernel,@function
recurrent_scan__sliding_local_dilated__dense_activation_relu__prompt_kernel:
    s_cmp_ge_u32 s2, 256
    s_cbranch_scc1 L_END
    s_load_dwordx16 s[4:19], s[0:1], 0
    s_load_dwordx2 s[20:21], s[0:1], 64
    s_getpc_b64 s[22:23]
L_pc:
    s_lshl_b32 s58, s2, 10
    s_and_b32 s58, s58, 0xe000
    v_lshlrev_b32 v2, 4, v0
    v_add_u32 v2, s58, v2
    v_min_u32 v2, L_END-L_pc, v2
    s_mov_b32 exec_lo, 0x1010101
    s_mov_b32 exec_hi, 0x1010101
    global_load_dword v247, v2, s[22:23]
    s_mov_b64 exec, -1
    v_lshrrev_b32 v1, 6, v0
    v_and_b32 v0, 63, v0
    v_readfirstlane_b32 s48, v1
    s_and_b32 s58, s2, 7
    s_lshr_b32 s59, s2, 3
    s_and_b32 s49, s58, 1
    s_lshl_b32 s49, s49, 3
    s_and_b32 s60, s59, 7
    s_add_u32 s49, s49, s60
    s_and_b32 s50, s58, 6
    s_bfe_u32 s60, s59, 0x10003
    s_add_u32 s50, s50, s60
    s_and_b32 s60, s58, 2
    s_lshl_b32 s60, s60, 1
    s_and_b32 s61, s49, 11
    s_add_u32 s60, s60, s61
    s_and_b32 s61, s58, 4
    s_bfe_u32 s52, s59, 0x20002
    s_add_u32 s61, s61, s52
    s_lshr_b32 s52, s58, 2
    s_mul_i32 s52, s52, 3
    s_xor_b32 s61, s61, s52
    s_cmp_ge_u32 s59, 16
    s_cselect_b32 s49, s60, s49
    s_cselect_b32 s50, s61, s50
    s_lshr_b32 s51, s59, 4
    s_xor_b32 s51, s51, 0
    s_lshl_b32 s52, s51, 3
    s_add_u32 s52, s52, s50
    s_mul_i32 s60, s59, 9363
    s_lshr_b32 s60, s60, 16
    s_mul_i32 s61, s60, 7
    s_sub_u32 s61, s59, s61
    s_cmp_ge_u32 s59, 28
    s_cselect_b32 s54, 7, s61
    s_lshl_b32 s60, s60, 1
    s_and_b32 s53, s58, 6
    s_lshl_b32 s53, s53, 2
    s_add_u32 s53, s53, s60
    s_and_b32 s60, s58, 1
    s_add_u32 s53, s53, s60
    s_and_b32 s55, s50, 1
    s_mul_i32 s55, s55, 3
    s_and_b32 s60, s50, 3
    s_lshl_b32 s60, s60, 1
    s_add_u32 s60, s60, 1
    s_cmp_ge_u32 s59, 16
    s_cselect_b32 s55, s60, s55
    s_lshl_b32 s60, s49, 1
    s_add_u32 s55, s55, s60
    s_mul_i32 s60, s55, 9363
    s_lshr_b32 s60, s60, 16
    s_mul_i32 s60, s60, 7
    s_sub_u32 s55, s55, s60
    s_and_b32 s22, s55, 1
    s_cmp_ge_u32 s49, 7
    s_cselect_b32 s22, 1, s22
    s_mov_b32 s3, 0
    s_and_b32 s57, s48, 3
    s_cmp_ge_u32 s48, 4
    s_cbranch_scc1 L_C
    v_lshrrev_b32 v232, 3, v0
    v_lshl_add_u32 v232, s57, 3, v232
    v_mul_u32_u24 v164, 896, v232
    v_lshrrev_b32 v232, 1, v232
    v_xor_b32 v232, v232, v0
    v_and_b32 v232, 7, v232
    v_lshl_add_u32 v164, v232, 4, v164
    v_add_u32 v165, 28672, v164
    v_add_u32 v166, 57344, v164
    v_add_u32 v167, 86016, v164
    s_mul_i32 s62, s49, 114688
    s_lshl_b32 s58, s55, 7
    s_add_u32 s62, s62, s58
    s_mov_b32 s67, s55
    s_lshl_b32 s64, s57, 10
    s_cmp_eq_u32 s51, 0
    s_cbranch_scc1 L_LQ
    v_lshrrev_b32 v232, 3, v0
    v_mul_u32_u24 v168, 2688, v232
    v_bfe_u32 v232, v0, 4, 1
    v_lshlrev_b32 v232, 1, v232
    v_xor_b32 v232, v232, v0
    v_and_b32 v232, 7, v232
    v_lshlrev_b32 v232, 4, v232
    v_xor_b32 v233, 64, v232
    v_add_u32 v169, 21504, v168
    v_add_u32 v168, v168, v232
    v_add_u32 v169, v169, v233
    v_add_u32 v170, 896, v168
    v_add_u32 v171, 896, v169
    v_add_u32 v172, 1792, v168
    v_add_u32 v173, 1792, v169
    s_mul_i32 s58, s50, 112
    s_min_u32 s58, s58, 768
    s_and_b32 s58, s58, 65535
    s_lshl_b32 s65, s57, 11
    s_lshr_b32 s59, s57, 1
    s_mul_i32 s59, s59, 14336
    v_subrev_u32 v175, s59, v164
    s_mul_i32 s66, s49, 114688
    s_max_u32 s66, s66, 14336
    s_sub_u32 s66, s66, 14336
    s_lshl_b32 s59, s55, 2
    s_add_u32 s59, s59, s57
    s_mul_i32 s63, s59, 43008
    s_add_u32 s63, s63, s58
    s_waitcnt lgkmcnt(0)
    s_mov_b32 s24, s4
    s_mov_b32 s25, s5
    s_mov_b32 s26, 0x1c0000
    s_mov_b32 s27, 0x20000
    s_mov_b32 s28, s6
    s_mov_b32 s29, s7
    s_mov_b32 s30, 0x126000
    s_mov_b32 s31, 0x20000
    s_add_u32 m0, s64, 0
    s_nop 0
    buffer_load_dwordx4 v164, s[24:27], s62 offen lds
    s_add_u32 m0, s64, 4096
    s_nop 0
    buffer_load_dwordx4 v165, s[24:27], s62 offen lds
    s_add_u32 m0, s64, 8192
    s_nop 0
    buffer_load_dwordx4 v166, s[24:27], s62 offen lds
    s_add_u32 m0, s64, 12288
    s_nop 0
    buffer_load_dwordx4 v167, s[24:27], s62 offen lds
    s_lshr_b32 s58, s57, 1
    s_add_u32 s58, s58, s67
    s_cmp_eq_u32 s58, 7
    s_cselect_b32 s58, 0, s58
    s_lshl_b32 s58, s58, 7
    s_add_u32 s58, s58, s66
    s_add_u32 m0, s64, 141312
    s_nop 0
    buffer_load_dwordx4 v175, s[24:27], s58 offen lds
    s_add_u32 m0, s65, 49152
    s_nop 0
    buffer_load_dwordx4 v168, s[28:31], s63 offen lds
    s_add_u32 m0, s65, 50176
    s_nop 0
    buffer_load_dwordx4 v169, s[28:31], s63 offen lds
    s_add_u32 m0, s65, 57344
    s_nop 0
    buffer_load_dwordx4 v170, s[28:31], s63 offen lds
    s_add_u32 m0, s65, 58368
    s_nop 0
    buffer_load_dwordx4 v171, s[28:31], s63 offen lds
    s_add_u32 m0, s65, 65536
    s_nop 0
    buffer_load_dwordx4 v172, s[28:31], s63 offen lds
    s_add_u32 m0, s65, 66560
    s_nop 0
    buffer_load_dwordx4 v173, s[28:31], s63 offen lds
    s_add_u32 s67, s67, 1
    s_cmp_eq_u32 s67, 7
    s_cselect_b32 s67, 0, s67
    s_cselect_b32 s58, 896, 0
    s_cselect_b32 s59, 1204224, 0
    s_add_u32 s62, s62, 128
    s_add_u32 s63, s63, 172032
    s_sub_u32 s62, s62, s58
    s_sub_u32 s63, s63, s59
    s_load_dword s56, s[20:21], 0
    s_mov_b32 s32, s8
    s_mov_b32 s33, s9
    s_mov_b32 s34, 0x62000
    s_mov_b32 s35, 0x20000
    s_mov_b32 s36, s14
    s_mov_b32 s37, s15
    s_mov_b32 s38, 0x188000
    s_mov_b32 s39, 0x20000
    s_mov_b32 s40, s20
    s_mov_b32 s41, s21
    s_mov_b32 s42, 0xf00000
    s_mov_b32 s43, 0x20000
    s_mov_b32 s44, s16
    s_mov_b32 s45, s17
    s_mov_b32 s46, 0x1c0000
    s_mov_b32 s47, 0x20000
    v_bfe_u32 v232, v0, 2, 2
    v_mov_b32 v233, 0x3f803f80
    v_cmp_eq_u32 vcc, 0, v232
    s_nop 1
    v_cndmask_b32 v180, 0, v233, vcc
    v_mov_b32 v181, v180
    v_mov_b32 v182, v180
    v_mov_b32 v183, v180
    v_cmp_eq_u32 vcc, 1, v232
    s_nop 1
    v_cndmask_b32 v184, 0, v233, vcc
    v_mov_b32 v185, v184
    v_mov_b32 v186, v184
    v_mov_b32 v187, v184
    v_cmp_eq_u32 vcc, 2, v232
    s_nop 1
    v_cndmask_b32 v188, 0, v233, vcc
    v_mov_b32 v189, v188
    v_mov_b32 v190, v188
    v_mov_b32 v191, v188
    v_cmp_eq_u32 vcc, 3, v232
    s_nop 1
    v_cndmask_b32 v192, 0, v233, vcc
    v_mov_b32 v193, v192
    v_mov_b32 v194, v192
    v_mov_b32 v195, v192
    v_lshrrev_b32 v232, 4, v0
    v_lshlrev_b32 v232, 3, v232
    v_bfe_u32 v235, v0, 2, 2
    v_add_u32 v232, v232, v235
    v_lshlrev_b32 v232, 7, v232
    v_bfe_u32 v233, v0, 3, 2
    v_lshlrev_b32 v233, 5, v233
    v_and_b32 v234, 3, v0
    v_lshlrev_b32 v234, 3, v234
    s_cmp_eq_u32 s50, 7
    s_cselect_b32 s58, 16, 0
    v_add_u32 v234, s58, v234
    s_lshr_b32 s58, s57, 1
    s_mul_i32 s58, s58, 56
    s_and_b32 s59, s57, 1
    s_lshl_b32 s59, s59, 5
    s_add_u32 s58, s58, s59
    v_add_u32 v176, s58, v234
    v_min_u32 v176, 120, v176
    v_xor_b32 v176, v176, v233
    v_add_u32 v176, v176, v232
    v_bfe_u32 v232, v0, 2, 3
    v_lshlrev_b32 v232, 7, v232
    v_lshrrev_b32 v233, 5, v0
    v_lshl_add_u32 v232, v233, 12, v232
    v_and_b32 v233, 3, v0
    v_lshl_add_u32 v232, v233, 3, v232
    v_bfe_u32 v233, v0, 3, 2
    v_lshl_add_u32 v252, v233, 5, v232
    v_xor_b32 v253, 32, v252
    v_xor_b32 v254, 64, v252
    v_xor_b32 v255, 96, v252
    v_add_u32 v252, s64, v252
    v_add_u32 v144, 0x10000, v252
    v_add_u32 v148, 0x20000, v252
    v_add_u32 v253, s64, v253
    v_add_u32 v145, 0x10000, v253
    v_add_u32 v149, 0x20000, v253
    v_add_u32 v254, s64, v254
    v_add_u32 v146, 0x10000, v254
    v_add_u32 v150, 0x20000, v254
    v_add_u32 v255, s64, v255
    v_add_u32 v147, 0x10000, v255
    v_add_u32 v151, 0x20000, v255
    v_lshrrev_b32 v232, 3, v0
    v_mul_u32_u24 v2, 896, v232
    v_and_b32 v232, 6, v232
    v_xor_b32 v232, v232, v0
    v_and_b32 v232, 7, v232
    v_lshl_add_u32 v2, v232, 4, v2
    v_add_u32 v3, 7168, v2
    v_lshlrev_b32 v1, 4, v0
    s_and_b32 s58, s53, 1
    s_lshl_b32 s58, s58, 2
    s_add_u32 s58, s58, s57
    s_mul_i32 s68, s58, 200704
    s_lshr_b32 s23, s53, 1
    s_lshl_b32 s23, s23, 4
    s_add_u32 s23, s23, s58
    s_lshl_b32 s23, s23, 10
    s_add_u32 s23, s23, 9961472
    s_andn2_b32 s18, 1, s53
    s_lshl_b32 s18, s18, 8
    s_add_u32 s18, s18, s23
    s_lshl_b32 s58, s54, 7
    s_cmp_lt_u32 s54, 7
    s_cselect_b32 s58, s58, 0x40000000
    s_add_u32 s68, s68, s58
    s_mul_i32 s69, s57, 7168
    s_add_u32 s69, s69, s58
    v_lshl_add_u32 v178, s57, 6, v0
    v_min_u32 v179, 143, v178
    v_lshlrev_b32 v178, 3, v178
    s_lshl_b32 s58, s49, 7
    s_sub_u32 s58, s58, 16
    v_add_u32 v140, s58, v179
    v_max_i32 v140, 0, v140
    v_lshlrev_b32 v140, 4, v140
    v_add_u32 v140, 16384, v140
    v_lshlrev_b32 v179, 4, v179
    v_add_u32 v179, 157696, v179
    s_lshl_b32 s15, s57, 10
    s_cmp_eq_u32 s57, 3
    s_cselect_b32 s16, 1, 0xffff
    s_cselect_b32 s15, 2288, s15
    s_add_u32 s15, s15, 157696
    s_and_b32 s14, s57, 1
    s_mul_i32 s14, s14, 1792
    s_add_u32 s14, s14, 160000
    s_cmp_lt_u32 s57, 2
    s_cselect_b32 s16, -1, s16
    s_cselect_b32 s17, -1, 0
    s_cselect_b32 s58, 0, 86272
    s_sub_u32 s14, s14, s58
    v_add_u32 v141, s14, v1
    v_min_u32 v142, 752, v1
    v_add_u32 v142, s14, v142
    v_add_u32 v142, 1024, v142
    v_lshrrev_b32 v232, 4, v0
    v_lshlrev_b32 v232, 9, v232
    v_and_b32 v143, 15, v0
    v_lshl_add_u32 v143, v143, 3, v232
    v_mov_b32 v244, 163584
    v_lshl_add_u32 v245, s57, 2, v244
    s_add_u32 m0, s64, 16384
    s_nop 0
    buffer_load_dwordx4 v164, s[24:27], s62 offen lds
    s_add_u32 m0, s64, 20480
    s_nop 0
    buffer_load_dwordx4 v165, s[24:27], s62 offen lds
    s_add_u32 m0, s64, 24576
    s_nop 0
    buffer_load_dwordx4 v166, s[24:27], s62 offen lds
    s_add_u32 m0, s64, 28672
    s_nop 0
    buffer_load_dwordx4 v167, s[24:27], s62 offen lds
    s_waitcnt lgkmcnt(0)
    s_mul_i32 s56, s56, 0x9e3779b1
    s_add_u32 s56, s56, 0x7f4a7c15
    s_waitcnt vmcnt(4)
    s_barrier
    s_add_u32 m0, s65, 77824
    s_nop 0
    buffer_load_dwordx4 v168, s[28:31], s63 offen lds
    s_add_u32 m0, s65, 78848
    s_nop 0
    buffer_load_dwordx4 v169, s[28:31], s63 offen lds
    s_waitcnt vmcnt(5)
    s_add_u32 m0, s65, 86016
    s_nop 0
    buffer_load_dwordx4 v170, s[28:31], s63 offen lds
    s_waitcnt vmcnt(5)
    s_add_u32 m0, s65, 87040
    s_nop 0
    buffer_load_dwordx4 v171, s[28:31], s63 offen lds
    s_waitcnt vmcnt(5)
    s_add_u32 m0, s65, 94208
    s_nop 0
    buffer_load_dwordx4 v172, s[28:31], s63 offen lds
    s_waitcnt vmcnt(5)
    s_cmp_lg_u32 s22, 0
    s_cbranch_scc1 L_Qcs0
    v_add_u32 v177, 49152, v176
    ds_read_b64_tr_b16 v[200:201], v177 offset:0
    ds_read_b64_tr_b16 v[202:203], v177 offset:512
    ds_read_b64_tr_b16 v[204:205], v177 offset:8192
    ds_read_b64_tr_b16 v[206:207], v177 offset:8704
    ds_read_b64_tr_b16 v[208:209], v177 offset:16384
    ds_read_b64_tr_b16 v[210:211], v177 offset:16896
    ds_read_b64_tr_b16 v[216:217], v177 offset:4096
    ds_read_b64_tr_b16 v[218:219], v177 offset:4608
    ds_read_b64_tr_b16 v[220:221], v177 offset:12288
    ds_read_b64_tr_b16 v[222:223], v177 offset:12800
    ds_read_b64_tr_b16 v[224:225], v177 offset:20480
    ds_read_b64_tr_b16 v[226:227], v177 offset:20992
    s_waitcnt lgkmcnt(0)
    v_mfma_f32_16x16x32_bf16 v[196:199], v[180:183], v[200:203], 0
    v_mfma_f32_16x16x32_bf16 v[196:199], v[184:187], v[204:207], v[196:199]
    v_mfma_f32_16x16x32_bf16 v[196:199], v[188:191], v[208:211], v[196:199]
    v_mfma_f32_16x16x32_bf16 v[196:199], v[180:183], v[216:219], v[196:199]
    v_mfma_f32_16x16x32_bf16 v[196:199], v[184:187], v[220:223], v[196:199]
    v_mfma_f32_16x16x32_bf16 v[196:199], v[188:191], v[224:227], v[196:199]
L_Qcs0:
    s_add_u32 m0, s65, 95232
    s_nop 0
    buffer_load_dwordx4 v173, s[28:31], s63 offen lds
    s_add_u32 s67, s67, 1
    s_cmp_eq_u32 s67, 7
    s_cselect_b32 s67, 0, s67
    s_cselect_b32 s58, 896, 0
    s_cselect_b32 s59, 1204224, 0
    s_add_u32 s62, s62, 128
    s_add_u32 s63, s63, 172032
    s_sub_u32 s62, s62, s58
    s_sub_u32 s63, s63, s59
    s_waitcnt vmcnt(5)
    s_add_u32 m0, s64, 32768
    s_nop 0
    buffer_load_dwordx4 v164, s[24:27], s62 offen lds
    s_waitcnt vmcnt(5)
    s_add_u32 m0, s64, 36864
    s_nop 0
    buffer_load_dwordx4 v165, s[24:27], s62 offen lds
    s_waitcnt vmcnt(5)
    s_add_u32 m0, s64, 40960
    s_nop 0
    buffer_load_dwordx4 v166, s[24:27], s62 offen lds
    s_waitcnt vmcnt(5)
    s_add_u32 m0, s64, 45056
    s_nop 0
    buffer_load_dwordx4 v167, s[24:27], s62 offen lds
    s_waitcnt vmcnt(5)
    s_lshr_b32 s58, s57, 1
    s_add_u32 s58, s58, s67
    s_cmp_eq_u32 s58, 7
    s_cselect_b32 s58, 0, s58
    s_lshl_b32 s58, s58, 7
    s_add_u32 s58, s58, s66
    s_add_u32 m0, s64, 145408
    s_nop 0
    buffer_load_dwordx4 v175, s[24:27], s58 offen lds
    s_waitcnt vmcnt(5)
    s_add_u32 m0, s65, 106496
    s_nop 0
    buffer_load_dwordx4 v168, s[28:31], s63 offen lds
    s_waitcnt vmcnt(5)
    s_add_u32 m0, s65, 107520
    s_nop 0
    buffer_load_dwordx4 v169, s[28:31], s63 offen lds
    s_waitcnt vmcnt(5)
    s_barrier
    s_add_u32 m0, s65, 114688
    s_nop 0
    buffer_load_dwordx4 v170, s[28:31], s63 offen lds
    s_waitcnt vmcnt(5)
    s_add_u32 m0, s65, 115712
    s_nop 0
    buffer_load_dwordx4 v171, s[28:31], s63 offen lds
    s_waitcnt vmcnt(5)
    s_add_u32 m0, s65, 122880
    s_nop 0
    buffer_load_dwordx4 v172, s[28:31], s63 offen lds
    s_waitcnt vmcnt(5)
    s_add_u32 m0, s65, 123904
    s_nop 0
    buffer_load_dwordx4 v173, s[28:31], s63 offen lds
    s_add_u32 s67, s67, 1
    s_cmp_eq_u32 s67, 7
    s_cselect_b32 s67, 0, s67
    s_cselect_b32 s58, 896, 0
    s_cselect_b32 s59, 1204224, 0
    s_add_u32 s62, s62, 128
    s_add_u32 s63, s63, 172032
    s_sub_u32 s62, s62, s58
    s_sub_u32 s63, s63, s59
    s_waitcnt vmcnt(5)
    s_add_u32 m0, s64, 0
    s_nop 0
    buffer_load_dwordx4 v164, s[24:27], s62 offen lds
    s_waitcnt vmcnt(5)
    s_cmp_lg_u32 s22, 0
    s_cbranch_scc1 L_Qcs1
    s_cmp_eq_u32 s55, 6
    s_cbranch_scc1 L_Qcs1b
    v_add_u32 v177, 77824, v176
    ds_read_b64_tr_b16 v[200:201], v177 offset:0
    ds_read_b64_tr_b16 v[202:203], v177 offset:512
    ds_read_b64_tr_b16 v[204:205], v177 offset:8192
    ds_read_b64_tr_b16 v[206:207], v177 offset:8704
    ds_read_b64_tr_b16 v[208:209], v177 offset:16384
    ds_read_b64_tr_b16 v[210:211], v177 offset:16896
    ds_read_b64_tr_b16 v[216:217], v177 offset:4096
    ds_read_b64_tr_b16 v[218:219], v177 offset:4608
    ds_read_b64_tr_b16 v[220:221], v177 offset:12288
    ds_read_b64_tr_b16 v[222:223], v177 offset:12800
    ds_read_b64_tr_b16 v[224:225], v177 offset:20480
    ds_read_b64_tr_b16 v[226:227], v177 offset:20992
    s_waitcnt lgkmcnt(0)
    v_mfma_f32_16x16x32_bf16 v[196:199], v[180:183], v[200:203], v[196:199]
    v_mfma_f32_16x16x32_bf16 v[196:199], v[184:187], v[204:207], v[196:199]
    v_mfma_f32_16x16x32_bf16 v[196:199], v[188:191], v[208:211], v[196:199]
    v_mfma_f32_16x16x32_bf16 v[196:199], v[180:183], v[216:219], v[196:199]
    v_mfma_f32_16x16x32_bf16 v[196:199], v[184:187], v[220:223], v[196:199]
    v_mfma_f32_16x16x32_bf16 v[196:199], v[188:191], v[224:227], v[196:199]
L_Qcs1b:
    s_nop 7
    v_cvt_pk_bf16_f32 v197, 0, v196
    v_sub_f32 v197, v196, v197
    v_cvt_pk_bf16_f32 v196, v196, v197
    v_mov_b32 v197, s56
L_Qcs1:
    s_lshl_b32 s58, s52, 13
    s_lshl_b32 s59, s55, 10
    s_add_u32 s58, s58, s59
    s_lshl_b32 s59, s57, 7
    s_add_u32 s58, s58, s59
    s_add_u32 s58, s58, 65536
    s_cmp_lg_u32 s22, 0
    s_cselect_b32 s58, 0x40000000, s58
    buffer_store_dwordx2 v[196:197], v143, s[40:43], s58 offen sc1
    s_add_u32 m0, s64, 4096
    s_nop 0
    buffer_load_dwordx4 v165, s[24:27], s62 offen lds
    s_waitcnt vmcnt(5)
    s_add_u32 m0, s64, 8192
    s_nop 0
    buffer_load_dwordx4 v166, s[24:27], s62 offen lds
    s_waitcnt vmcnt(5)
    s_add_u32 m0, s64, 12288
    s_nop 0
    buffer_load_dwordx4 v167, s[24:27], s62 offen lds
    s_waitcnt vmcnt(5)
    s_add_u32 m0, s65, 49152
    s_nop 0
    buffer_load_dwordx4 v168, s[28:31], s63 offen lds
    s_waitcnt vmcnt(5)
    s_add_u32 m0, s65, 50176
    s_nop 0
    buffer_load_dwordx4 v169, s[28:31], s63 offen lds
    s_waitcnt vmcnt(5)
    s_add_u32 m0, s65, 57344
    s_nop 0
    buffer_load_dwordx4 v170, s[28:31], s63 offen lds
    s_waitcnt vmcnt(5)
    s_add_u32 m0, s65, 58368
    s_nop 0
    buffer_load_dwordx4 v171, s[28:31], s63 offen lds
    s_waitcnt vmcnt(5)
    s_add_u32 m0, s65, 65536
    s_nop 0
    buffer_load_dwordx4 v172, s[28:31], s63 offen lds
    s_waitcnt vmcnt(5)
    s_add_u32 m0, s65, 66560
    s_nop 0
    buffer_load_dwordx4 v173, s[28:31], s63 offen lds
    s_add_u32 s67, s67, 1
    s_cmp_eq_u32 s67, 7
    s_cselect_b32 s67, 0, s67
    s_cselect_b32 s58, 896, 0
    s_cselect_b32 s59, 1204224, 0
    s_add_u32 s62, s62, 128
    s_add_u32 s63, s63, 172032
    s_sub_u32 s62, s62, s58
    s_sub_u32 s63, s63, s59
    s_waitcnt vmcnt(5)
    s_barrier
    s_add_u32 m0, s64, 16384
    s_nop 0
    buffer_load_dwordx4 v164, s[24:27], s62 offen lds
    s_waitcnt vmcnt(5)
    s_add_u32 m0, s64, 20480
    s_nop 0
    buffer_load_dwordx4 v165, s[24:27], s62 offen lds
    s_waitcnt vmcnt(5)
    s_add_u32 m0, s64, 24576
    s_nop 0
    buffer_load_dwordx4 v166, s[24:27], s62 offen lds
    s_waitcnt vmcnt(5)
    s_add_u32 m0, s64, 28672
    s_nop 0
    buffer_load_dwordx4 v167, s[24:27], s62 offen lds
    s_waitcnt vmcnt(5)
    s_lshr_b32 s58, s57, 1
    s_add_u32 s58, s58, s67
    s_cmp_eq_u32 s58, 7
    s_cselect_b32 s58, 0, s58
    s_lshl_b32 s58, s58, 7
    s_add_u32 s58, s58, s66
    s_add_u32 m0, s64, 135168
    s_nop 0
    buffer_load_dwordx4 v175, s[24:27], s58 offen lds
    s_waitcnt vmcnt(5)
    s_add_u32 m0, s65, 77824
    s_nop 0
    buffer_load_dwordx4 v168, s[28:31], s63 offen lds
    s_waitcnt vmcnt(5)
    s_add_u32 m0, s65, 78848
    s_nop 0
    buffer_load_dwordx4 v169, s[28:31], s63 offen lds
    s_waitcnt vmcnt(5)
    s_add_u32 m0, s65, 86016
    s_nop 0
    buffer_load_dwordx4 v170, s[28:31], s63 offen lds
    s_waitcnt vmcnt(5)
    s_add_u32 m0, s65, 87040
    s_nop 0
    buffer_load_dwordx4 v171, s[28:31], s63 offen lds
    s_waitcnt vmcnt(5)
    s_add_u32 m0, s65, 94208
    s_nop 0
    buffer_load_dwordx4 v172, s[28:31], s63 offen lds
    s_waitcnt vmcnt(5)
    s_add_u32 m0, s65, 95232
    s_nop 0
    buffer_load_dwordx4 v173, s[28:31], s63 offen lds
    s_add_u32 s67, s67, 1
    s_cmp_eq_u32 s67, 7
    s_cselect_b32 s67, 0, s67
    s_cselect_b32 s58, 896, 0
    s_cselect_b32 s59, 1204224, 0
    s_add_u32 s62, s62, 128
    s_add_u32 s63, s63, 172032
    s_sub_u32 s62, s62, s58
    s_sub_u32 s63, s63, s59
    s_waitcnt vmcnt(5)
    s_lshl_b32 s59, s2, 2
    s_add_u32 s59, s59, s57
    s_lshl_b32 s59, s59, 11
    v_lshlrev_b32 v240, 7, v0
    s_mov_b64 exec, 0xffff
    buffer_load_dword v241, v240, s[36:39], s59 offen
    buffer_load_dword v241, v240, s[32:35], s59 offen
    s_mov_b64 exec, -1
    s_buffer_load_dword s4, s[40:43], s23 offset:0 glc
    s_buffer_load_dword s5, s[40:43], s23 offset:128 glc
    s_buffer_load_dword s6, s[40:43], s23 offset:256 glc
    s_buffer_load_dword s7, s[40:43], s23 offset:384 glc
    s_lshr_b32 s58, s53, 1
    s_lshl_b32 s58, s58, 14
    s_and_b32 s59, s53, 1
    s_lshl_b32 s59, s59, 1
    s_lshr_b32 s10, s57, 1
    s_add_u32 s59, s59, s10
    s_lshl_b32 s59, s59, 7
    s_add_u32 s58, s58, s59
    s_add_u32 s58, s58, 9969664
    s_and_b32 s59, s57, 1
    s_lshl_b32 s59, s59, 12
    s_add_u32 s58, s58, s59
    s_buffer_load_dword s11, s[40:43], s58 offset:0 glc
    s_buffer_load_dword s11, s[40:43], s58 offset:1024 glc
    s_buffer_load_dword s11, s[40:43], s58 offset:2048 glc
    s_buffer_load_dword s11, s[40:43], s58 offset:3072 glc
    s_mul_i32 s58, s53, 7
    s_add_u32 s58, s58, s54
    s_lshl_b32 s58, s58, 4
    s_add_u32 s58, s58, s57
    s_lshl_b32 s58, s58, 10
    s_add_u32 s58, s58, 10494972
    s_buffer_load_dword s11, s[40:43], s58 glc
    s_buffer_load_dword s11, s[40:43], s58 offset:4096 glc
    s_barrier
    s_add_u32 m0, s64, 32768
    s_nop 0
    buffer_load_dwordx4 v164, s[24:27], s62 offen lds
    s_waitcnt vmcnt(5)
    s_add_u32 m0, s64, 36864
    s_nop 0
    buffer_load_dwordx4 v165, s[24:27], s62 offen lds
    s_waitcnt vmcnt(5)
    s_add_u32 m0, s64, 40960
    s_nop 0
    buffer_load_dwordx4 v166, s[24:27], s62 offen lds
    s_waitcnt vmcnt(5)
    s_add_u32 m0, s64, 45056
    s_nop 0
    buffer_load_dwordx4 v167, s[24:27], s62 offen lds
    s_waitcnt vmcnt(5)
    s_add_u32 m0, s65, 106496
    s_nop 0
    buffer_load_dwordx4 v168, s[28:31], s63 offen lds
    s_waitcnt vmcnt(5)
    s_add_u32 m0, s65, 107520
    s_nop 0
    buffer_load_dwordx4 v169, s[28:31], s63 offen lds
    s_waitcnt vmcnt(5)
    s_add_u32 m0, s65, 114688
    s_nop 0
    buffer_load_dwordx4 v170, s[28:31], s63 offen lds
    s_waitcnt vmcnt(5)
    s_add_u32 m0, s65, 115712
    s_nop 0
    buffer_load_dwordx4 v171, s[28:31], s63 offen lds
    s_waitcnt vmcnt(5)
    s_add_u32 m0, s65, 122880
    s_nop 0
    buffer_load_dwordx4 v172, s[28:31], s63 offen lds
    s_waitcnt vmcnt(5)
    s_add_u32 m0, s65, 123904
    s_nop 0
    buffer_load_dwordx4 v173, s[28:31], s63 offen lds
    s_add_u32 s67, s67, 1
    s_cmp_eq_u32 s67, 7
    s_cselect_b32 s67, 0, s67
    s_cselect_b32 s58, 896, 0
    s_cselect_b32 s59, 1204224, 0
    s_add_u32 s62, s62, 128
    s_add_u32 s63, s63, 172032
    s_sub_u32 s62, s62, s58
    s_sub_u32 s63, s63, s59
    s_waitcnt vmcnt(5)
    s_barrier
    s_lshl_b32 s60, s52, 2
    s_add_u32 s60, s60, s57
    s_lshl_b32 s60, s60, 11
    s_add_u32 s60, s60, 65536
    s_mov_b32 m0, s14
    s_nop 0
    buffer_load_dwordx4 v1, s[40:43], s60 offen sc1 lds
    s_mov_b32 exec_hi, 0xffff
    buffer_load_dwordx4 v1, s[40:43], s60 offen offset:1024 sc1 lds
    s_mov_b32 m0, s15
    s_mov_b64 exec, s[16:17]
    buffer_load_dwordx4 v140, s[40:43], 0 offen sc1 lds
    s_mov_b64 exec, -1
    s_add_u32 m0, s64, 0
    s_nop 0
    buffer_load_dwordx4 v164, s[24:27], s62 offen lds
    s_waitcnt vmcnt(5)
    s_add_u32 m0, s64, 4096
    s_nop 0
    buffer_load_dwordx4 v165, s[24:27], s62 offen lds
    s_waitcnt vmcnt(5)
    s_add_u32 m0, s64, 8192
    s_nop 0
    buffer_load_dwordx4 v166, s[24:27], s62 offen lds
    s_waitcnt vmcnt(5)
    s_add_u32 m0, s64, 12288
    s_nop 0
    buffer_load_dwordx4 v167, s[24:27], s62 offen lds
    s_waitcnt vmcnt(5)
    s_lshl_b32 s58, s67, 7
    s_add_u32 s58, s58, s66
    s_and_b32 s59, s64, 1024
    s_add_u32 m0, s59, 139264
    s_nop 0
    buffer_load_dwordx4 v175, s[24:27], s58 offen lds
    s_waitcnt vmcnt(5)
    s_add_u32 m0, s65, 49152
    s_nop 0
    buffer_load_dwordx4 v168, s[28:31], s63 offen lds
    s_waitcnt vmcnt(5)
    s_add_u32 m0, s65, 50176
    s_nop 0
    buffer_load_dwordx4 v169, s[28:31], s63 offen lds
    s_waitcnt vmcnt(5)
    s_add_u32 m0, s65, 57344
    s_nop 0
    buffer_load_dwordx4 v170, s[28:31], s63 offen lds
    s_waitcnt vmcnt(5)
    s_add_u32 m0, s65, 58368
    s_nop 0
    buffer_load_dwordx4 v171, s[28:31], s63 offen lds
    s_waitcnt vmcnt(5)
    s_add_u32 m0, s65, 65536
    s_nop 0
    buffer_load_dwordx4 v172, s[28:31], s63 offen lds
    s_waitcnt vmcnt(5)
    s_add_u32 m0, s65, 66560
    s_nop 0
    buffer_load_dwordx4 v173, s[28:31], s63 offen lds
    s_waitcnt vmcnt(5)
    s_barrier
    ds_read_b128 v[200:203], v141
    ds_read_b128 v[204:207], v142
    ds_read_b128 v[208:211], v179
    s_waitcnt lgkmcnt(0)
    v_cmp_ne_u32 vcc, s56, v201
    v_cmp_ne_u32 s[4:5], s56, v203
    v_cmp_ne_u32 s[6:7], s56, v205
    v_cmp_ne_u32 s[8:9], s56, v207
    v_cmp_ne_u32 s[10:11], s56, v209
    v_cmp_ne_u32 s[12:13], s56, v211
    s_or_b64 s[4:5], s[4:5], s[6:7]
    s_or_b64 vcc, vcc, s[8:9]
    s_or_b64 s[4:5], s[4:5], s[10:11]
    s_or_b64 vcc, vcc, s[12:13]
    s_or_b64 vcc, vcc, s[4:5]
    s_cbranch_vccz L_Qgok
L_Qgre:
    s_add_u32 s3, s3, 1
    s_cmp_gt_u32 s3, 2097152
    s_cbranch_scc1 L_Qgok
    s_sleep 1
    s_mov_b32 m0, s14
    s_nop 0
    buffer_load_dwordx4 v1, s[40:43], s60 offen sc1 lds
    s_mov_b32 exec_hi, 0xffff
    buffer_load_dwordx4 v1, s[40:43], s60 offen offset:1024 sc1 lds
    s_mov_b32 m0, s15
    s_mov_b64 exec, s[16:17]
    buffer_load_dwordx4 v140, s[40:43], 0 offen sc1 lds
    s_mov_b64 exec, -1
    s_waitcnt vmcnt(0)
    ds_read_b128 v[200:203], v141
    ds_read_b128 v[204:207], v142
    ds_read_b128 v[208:211], v179
    s_waitcnt lgkmcnt(0)
    v_cmp_ne_u32 vcc, s56, v201
    v_cmp_ne_u32 s[4:5], s56, v203
    v_cmp_ne_u32 s[6:7], s56, v205
    v_cmp_ne_u32 s[8:9], s56, v207
    v_cmp_ne_u32 s[10:11], s56, v209
    v_cmp_ne_u32 s[12:13], s56, v211
    s_or_b64 s[4:5], s[4:5], s[6:7]
    s_or_b64 vcc, vcc, s[8:9]
    s_or_b64 s[4:5], s[4:5], s[10:11]
    s_or_b64 vcc, vcc, s[12:13]
    s_or_b64 vcc, vcc, s[4:5]
    s_cbranch_vccnz L_Qgre
L_Qgok:
    s_waitcnt vmcnt(0)
    s_waitcnt lgkmcnt(0)
    v_mov_b32 v246, 7
    ds_write_b32 v245, v246
    s_cmp_ge_u32 s54, 7
    s_cbranch_scc1 L_IDLE
    s_add_u32 m0, s64, 16384
    s_nop 0
    buffer_load_dwordx4 v2, s[36:39], s68 offen lds
    s_add_u32 m0, s64, 20480
    s_nop 0
    buffer_load_dwordx4 v3, s[36:39], s68 offen lds
    s_add_u32 s68, s68, 14336
    s_add_u32 m0, s64, 77824
    s_nop 0
    buffer_load_dwordx4 v2, s[36:39], s68 offen lds
    s_add_u32 m0, s64, 81920
    s_nop 0
    buffer_load_dwordx4 v3, s[36:39], s68 offen lds
    s_add_u32 s68, s68, 14336
    s_add_u32 m0, s64, 86016
    s_nop 0
    buffer_load_dwordx4 v2, s[36:39], s68 offen lds
    s_add_u32 m0, s64, 90112
    s_nop 0
    buffer_load_dwordx4 v3, s[36:39], s68 offen lds
    s_add_u32 s68, s68, 14336
    s_add_u32 m0, s64, 94208
    s_nop 0
    buffer_load_dwordx4 v2, s[36:39], s68 offen lds
    s_add_u32 m0, s64, 98304
    s_nop 0
    buffer_load_dwordx4 v3, s[36:39], s68 offen lds
    s_add_u32 s68, s68, 14336
    s_waitcnt vmcnt(7)
    s_waitcnt vmcnt(6)
    ds_read_b64_tr_b16 v[24:25], v252 offset:16384
    ds_read_b64_tr_b16 v[28:29], v253 offset:16384
    ds_read_b64_tr_b16 v[32:33], v254 offset:16384
    ds_read_b64_tr_b16 v[36:37], v255 offset:16384
    s_waitcnt lgkmcnt(0)
    s_add_u32 m0, s64, 16384
    s_nop 0
    buffer_load_dwordx4 v2, s[36:39], s68 offen lds
    s_add_u32 m0, s64, 20480
    s_nop 0
    buffer_load_dwordx4 v3, s[36:39], s68 offen lds
    s_add_u32 s68, s68, 14336
    s_waitcnt vmcnt(7)
    s_waitcnt vmcnt(6)
    ds_read_b64_tr_b16 v[26:27], v144 offset:12288
    ds_read_b64_tr_b16 v[30:31], v145 offset:12288
    ds_read_b64_tr_b16 v[34:35], v146 offset:12288
    ds_read_b64_tr_b16 v[38:39], v147 offset:12288
    s_waitcnt lgkmcnt(0)
    s_add_u32 m0, s64, 77824
    s_nop 0
    buffer_load_dwordx4 v2, s[36:39], s68 offen lds
    s_add_u32 m0, s64, 81920
    s_nop 0
    buffer_load_dwordx4 v3, s[36:39], s68 offen lds
    s_add_u32 s68, s68, 14336
    s_waitcnt vmcnt(7)
    s_waitcnt vmcnt(6)
    ds_read_b64_tr_b16 v[40:41], v144 offset:20480
    ds_read_b64_tr_b16 v[44:45], v145 offset:20480
    ds_read_b64_tr_b16 v[48:49], v146 offset:20480
    ds_read_b64_tr_b16 v[52:53], v147 offset:20480
    s_waitcnt lgkmcnt(0)
    s_add_u32 m0, s64, 86016
    s_nop 0
    buffer_load_dwordx4 v2, s[36:39], s68 offen lds
    s_add_u32 m0, s64, 90112
    s_nop 0
    buffer_load_dwordx4 v3, s[36:39], s68 offen lds
    s_add_u32 s68, s68, 14336
    s_waitcnt vmcnt(7)
    ds_read_b128 v[248:251], v244 offset:16
    s_waitcnt lgkmcnt(0)
    v_min3_u32 v248, v248, v249, v250
    v_min_u32 v248, v248, v251
    v_cmp_gt_u32 vcc, 6, v248
    s_nop 0
    s_cbranch_vccz L_Qcp6_ok
L_Qcp6:
    s_add_u32 s3, s3, 1
    s_cmp_gt_u32 s3, 2097152
    s_cbranch_scc1 L_Qcp6_ok
    s_sleep 2
    ds_read_b128 v[248:251], v244 offset:16
    s_waitcnt lgkmcnt(0)
    v_min3_u32 v248, v248, v249, v250
    v_min_u32 v248, v248, v251
    v_cmp_gt_u32 vcc, 6, v248
    s_nop 0
    s_cbranch_vccnz L_Qcp6
L_Qcp6_ok:
    s_add_u32 m0, s64, 32768
    s_nop 0
    buffer_load_dwordx4 v2, s[36:39], s68 offen lds
    s_add_u32 m0, s64, 36864
    s_nop 0
    buffer_load_dwordx4 v3, s[36:39], s68 offen lds
    s_add_u32 s68, s68, 14336
    s_waitcnt vmcnt(8)
    ds_read_b64_tr_b16 v[42:43], v144 offset:28672
    ds_read_b64_tr_b16 v[46:47], v145 offset:28672
    ds_read_b64_tr_b16 v[50:51], v146 offset:28672
    ds_read_b64_tr_b16 v[54:55], v147 offset:28672
    s_waitcnt vmcnt(7)
    s_add_u32 m0, s64, 40960
    s_nop 0
    buffer_load_dwordx4 v2, s[36:39], s68 offen lds
    s_add_u32 m0, s64, 45056
    s_nop 0
    buffer_load_dwordx4 v3, s[36:39], s68 offen lds
    s_add_u32 s68, s68, 14336
    s_waitcnt vmcnt(8)
    s_waitcnt lgkmcnt(0)
    ds_read_b64_tr_b16 v[56:57], v252 offset:16384
    ds_read_b64_tr_b16 v[60:61], v253 offset:16384
    ds_read_b64_tr_b16 v[64:65], v254 offset:16384
    ds_read_b64_tr_b16 v[68:69], v255 offset:16384
    s_waitcnt vmcnt(7)
    s_add_u32 m0, s64, 94208
    s_nop 0
    buffer_load_dwordx4 v2, s[36:39], s68 offen lds
    s_add_u32 m0, s64, 98304
    s_nop 0
    buffer_load_dwordx4 v3, s[36:39], s68 offen lds
    s_add_u32 s68, s68, 14336
    s_waitcnt vmcnt(8)
    s_waitcnt lgkmcnt(0)
    ds_read_b64_tr_b16 v[58:59], v144 offset:12288
    ds_read_b64_tr_b16 v[62:63], v145 offset:12288
    ds_read_b64_tr_b16 v[66:67], v146 offset:12288
    ds_read_b64_tr_b16 v[70:71], v147 offset:12288
    s_waitcnt vmcnt(7)
    s_add_u32 m0, s64, 16384
    s_nop 0
    buffer_load_dwordx4 v2, s[36:39], s68 offen lds
    s_add_u32 m0, s64, 20480
    s_nop 0
    buffer_load_dwordx4 v3, s[36:39], s68 offen lds
    s_add_u32 s68, s68, 14336
    s_waitcnt vmcnt(8)
    s_waitcnt lgkmcnt(0)
    ds_read_b64_tr_b16 v[72:73], v144 offset:20480
    ds_read_b64_tr_b16 v[76:77], v145 offset:20480
    ds_read_b64_tr_b16 v[80:81], v146 offset:20480
    ds_read_b64_tr_b16 v[84:85], v147 offset:20480
    s_waitcnt vmcnt(7)
    s_add_u32 m0, s64, 77824
    s_nop 0
    buffer_load_dwordx4 v2, s[36:39], s68 offen lds
    s_add_u32 m0, s64, 81920
    s_nop 0
    buffer_load_dwordx4 v3, s[36:39], s68 offen lds
    s_add_u32 s68, s68, 14336
    s_waitcnt vmcnt(8)
    s_waitcnt lgkmcnt(0)
    ds_read_b64_tr_b16 v[74:75], v252 offset:32768
    ds_read_b64_tr_b16 v[78:79], v253 offset:32768
    ds_read_b64_tr_b16 v[82:83], v254 offset:32768
    ds_read_b64_tr_b16 v[86:87], v255 offset:32768
    s_waitcnt vmcnt(7)
    s_add_u32 m0, s64, 86016
    s_nop 0
    buffer_load_dwordx4 v2, s[36:39], s68 offen lds
    s_add_u32 m0, s64, 90112
    s_nop 0
    buffer_load_dwordx4 v3, s[36:39], s68 offen lds
    s_add_u32 s68, s68, 14336
    s_waitcnt vmcnt(8)
    s_waitcnt lgkmcnt(0)
    ds_read_b64_tr_b16 v[88:89], v252 offset:40960
    ds_read_b64_tr_b16 v[92:93], v253 offset:40960
    ds_read_b64_tr_b16 v[96:97], v254 offset:40960
    ds_read_b64_tr_b16 v[100:101], v255 offset:40960
    s_waitcnt vmcnt(7)
    s_add_u32 m0, s64, 32768
    s_nop 0
    buffer_load_dwordx4 v2, s[36:39], s68 offen lds
    s_add_u32 m0, s64, 36864
    s_nop 0
    buffer_load_dwordx4 v3, s[36:39], s68 offen lds
    s_add_u32 s68, s68, 14336
    s_waitcnt vmcnt(8)
    s_waitcnt lgkmcnt(0)
    ds_read_b64_tr_b16 v[90:91], v144 offset:28672
    ds_read_b64_tr_b16 v[94:95], v145 offset:28672
    ds_read_b64_tr_b16 v[98:99], v146 offset:28672
    ds_read_b64_tr_b16 v[102:103], v147 offset:28672
    s_waitcnt vmcnt(7)
    s_add_u32 s58, s69, 372736
    s_add_u32 m0, s64, 131072
    s_nop 0
    buffer_load_dwordx4 v2, s[32:35], s58 offen lds
    s_waitcnt vmcnt(7)
    s_waitcnt lgkmcnt(0)
    ds_read_b64_tr_b16 v[104:105], v252 offset:16384
    ds_read_b64_tr_b16 v[108:109], v253 offset:16384
    ds_read_b64_tr_b16 v[112:113], v254 offset:16384
    ds_read_b64_tr_b16 v[116:117], v255 offset:16384
    s_add_u32 s58, s69, 344064
    s_add_u32 m0, s64, 126976
    s_nop 0
    buffer_load_dwordx4 v2, s[32:35], s58 offen lds
    s_waitcnt vmcnt(7)
    s_add_u32 s58, s69, 315392
    s_add_u32 m0, s64, 122880
    s_nop 0
    buffer_load_dwordx4 v2, s[32:35], s58 offen lds
    s_waitcnt vmcnt(7)
    s_waitcnt lgkmcnt(0)
    ds_read_b64_tr_b16 v[106:107], v144 offset:12288
    ds_read_b64_tr_b16 v[110:111], v145 offset:12288
    ds_read_b64_tr_b16 v[114:115], v146 offset:12288
    ds_read_b64_tr_b16 v[118:119], v147 offset:12288
    s_add_u32 s58, s69, 286720
    s_add_u32 m0, s64, 118784
    s_nop 0
    buffer_load_dwordx4 v2, s[32:35], s58 offen lds
    s_waitcnt vmcnt(7)
    s_add_u32 s58, s69, 258048
    s_add_u32 m0, s64, 114688
    s_nop 0
    buffer_load_dwordx4 v2, s[32:35], s58 offen lds
    s_waitcnt vmcnt(7)
    s_waitcnt lgkmcnt(0)
    ds_read_b64_tr_b16 v[120:121], v144 offset:20480
    ds_read_b64_tr_b16 v[124:125], v145 offset:20480
    ds_read_b64_tr_b16 v[128:129], v146 offset:20480
    ds_read_b64_tr_b16 v[132:133], v147 offset:20480
    s_add_u32 s58, s69, 229376
    s_add_u32 m0, s64, 110592
    s_nop 0
    buffer_load_dwordx4 v2, s[32:35], s58 offen lds
    s_waitcnt vmcnt(7)
    s_add_u32 s58, s69, 200704
    s_add_u32 m0, s64, 106496
    s_nop 0
    buffer_load_dwordx4 v2, s[32:35], s58 offen lds
    s_waitcnt vmcnt(7)
    s_waitcnt lgkmcnt(0)
    ds_read_b64_tr_b16 v[122:123], v252 offset:32768
    ds_read_b64_tr_b16 v[126:127], v253 offset:32768
    ds_read_b64_tr_b16 v[130:131], v254 offset:32768
    ds_read_b64_tr_b16 v[134:135], v255 offset:32768
    s_add_u32 s58, s69, 172032
    s_add_u32 m0, s64, 102400
    s_nop 0
    buffer_load_dwordx4 v2, s[32:35], s58 offen lds
    s_waitcnt vmcnt(7)
    s_add_u32 s58, s69, 143360
    s_add_u32 m0, s64, 98304
    s_nop 0
    buffer_load_dwordx4 v2, s[32:35], s58 offen lds
    s_waitcnt vmcnt(7)
    s_add_u32 s58, s69, 114688
    s_add_u32 m0, s64, 94208
    s_nop 0
    buffer_load_dwordx4 v2, s[32:35], s58 offen lds
    s_waitcnt vmcnt(7)
    s_buffer_load_dword s4, s[40:43], s23 offset:0 glc
    s_buffer_load_dword s5, s[40:43], s23 offset:128 glc
    s_buffer_load_dword s6, s[40:43], s23 offset:256 glc
    s_buffer_load_dword s7, s[40:43], s23 offset:384 glc
    s_add_u32 s58, s69, 86016
    s_add_u32 m0, s64, 90112
    s_nop 0
    buffer_load_dwordx4 v2, s[32:35], s58 offen lds
    s_waitcnt vmcnt(7)
    s_add_u32 s58, s69, 57344
    s_add_u32 m0, s64, 86016
    s_nop 0
    buffer_load_dwordx4 v2, s[32:35], s58 offen lds
    s_waitcnt vmcnt(7)
    s_add_u32 s58, s69, 28672
    s_add_u32 m0, s64, 81920
    s_nop 0
    buffer_load_dwordx4 v2, s[32:35], s58 offen lds
    s_waitcnt vmcnt(7)
    s_add_u32 s58, s69, 0
    s_add_u32 m0, s64, 77824
    s_nop 0
    buffer_load_dwordx4 v2, s[32:35], s58 offen lds
    s_waitcnt vmcnt(7)
    s_waitcnt lgkmcnt(0)
    s_branch L_P2L
L_LQ:
    s_movk_i32 s58, 3136
    v_add_u32 v232, 0, v0
    v_mul_u32_u24 v233, 2341, v232
    v_lshrrev_b32 v233, 16, v233
    v_lshlrev_b32 v232, 4, v232
    v_mad_u32_u24 v168, v233, s58, v232
    v_add_u32 v232, 64, v0
    v_mul_u32_u24 v233, 2341, v232
    v_lshrrev_b32 v233, 16, v233
    v_lshlrev_b32 v232, 4, v232
    v_mad_u32_u24 v169, v233, s58, v232
    v_add_u32 v232, 128, v0
    v_mul_u32_u24 v233, 2341, v232
    v_lshrrev_b32 v233, 16, v233
    v_lshlrev_b32 v232, 4, v232
    v_mad_u32_u24 v170, v233, s58, v232
    v_add_u32 v232, 192, v0
    v_mul_u32_u24 v233, 2341, v232
    v_lshrrev_b32 v233, 16, v233
    v_lshlrev_b32 v232, 4, v232
    v_mad_u32_u24 v171, v233, s58, v232
    v_and_b32 v233, 8, v233
    v_lshlrev_b32 v233, 2, v233
    v_xor_b32 v171, v171, v233
    v_add_u32 v232, 256, v0
    v_mul_u32_u24 v233, 2341, v232
    v_lshrrev_b32 v233, 16, v233
    v_lshlrev_b32 v232, 4, v232
    v_mad_u32_u24 v172, v233, s58, v232
    v_xor_b32 v172, 32, v172
    v_add_u32 v232, 320, v0
    v_mul_u32_u24 v233, 2341, v232
    v_lshrrev_b32 v233, 16, v233
    v_lshlrev_b32 v232, 4, v232
    v_mad_u32_u24 v173, v233, s58, v232
    v_xor_b32 v173, 32, v173
    v_add_u32 v232, 384, v0
    v_mul_u32_u24 v233, 2341, v232
    v_lshrrev_b32 v233, 16, v233
    v_lshlrev_b32 v232, 4, v232
    v_mad_u32_u24 v174, v233, s58, v232
    v_xor_b32 v174, 32, v174
    s_mul_i32 s58, s50, 448
    s_mul_i32 s65, s57, 7168
    s_lshl_b32 s59, s55, 2
    s_add_u32 s59, s59, s57
    s_mul_i32 s63, s59, 57344
    s_add_u32 s63, s63, s58
    s_waitcnt lgkmcnt(0)
    s_mov_b32 s24, s4
    s_mov_b32 s25, s5
    s_mov_b32 s26, 0x1c0000
    s_mov_b32 s27, 0x20000
    s_mov_b32 s28, s12
    s_mov_b32 s29, s13
    s_mov_b32 s30, 0x188000
    s_mov_b32 s31, 0x20000
    s_add_u32 m0, s64, 0
    s_nop 0
    buffer_load_dwordx4 v164, s[24:27], s62 offen lds
    s_add_u32 m0, s64, 4096
    s_nop 0
    buffer_load_dwordx4 v165, s[24:27], s62 offen lds
    s_add_u32 m0, s64, 8192
    s_nop 0
    buffer_load_dwordx4 v166, s[24:27], s62 offen lds
    s_add_u32 m0, s64, 12288
    s_nop 0
    buffer_load_dwordx4 v167, s[24:27], s62 offen lds
    s_add_u32 m0, s65, 49152
    s_nop 0
    buffer_load_dwordx4 v168, s[28:31], s63 offen lds
    s_add_u32 m0, s65, 50176
    s_nop 0
    buffer_load_dwordx4 v169, s[28:31], s63 offen lds
    s_add_u32 m0, s65, 51200
    s_nop 0
    buffer_load_dwordx4 v170, s[28:31], s63 offen lds
    s_add_u32 m0, s65, 52224
    s_nop 0
    buffer_load_dwordx4 v171, s[28:31], s63 offen lds
    s_add_u32 m0, s65, 53248
    s_nop 0
    buffer_load_dwordx4 v172, s[28:31], s63 offen lds
    s_add_u32 m0, s65, 54272
    s_nop 0
    buffer_load_dwordx4 v173, s[28:31], s63 offen lds
    s_add_u32 m0, s65, 55296
    s_nop 0
    buffer_load_dwordx4 v174, s[28:31], s63 offen lds
    s_add_u32 s67, s67, 1
    s_cmp_eq_u32 s67, 7
    s_cselect_b32 s67, 0, s67
    s_cselect_b32 s58, 896, 0
    s_cselect_b32 s59, 1605632, 0
    s_add_u32 s62, s62, 128
    s_add_u32 s63, s63, 229376
    s_sub_u32 s62, s62, s58
    s_sub_u32 s63, s63, s59
    s_load_dword s56, s[20:21], 0
    s_mov_b32 s32, s8
    s_mov_b32 s33, s9
    s_mov_b32 s34, 0x62000
    s_mov_b32 s35, 0x20000
    s_mov_b32 s36, s14
    s_mov_b32 s37, s15
    s_mov_b32 s38, 0x188000
    s_mov_b32 s39, 0x20000
    s_mov_b32 s40, s20
    s_mov_b32 s41, s21
    s_mov_b32 s42, 0xf00000
    s_mov_b32 s43, 0x20000
    s_mov_b32 s44, s16
    s_mov_b32 s45, s17
    s_mov_b32 s46, 0x1c0000
    s_mov_b32 s47, 0x20000
    v_bfe_u32 v232, v0, 2, 2
    v_mov_b32 v233, 0x3f803f80
    v_cmp_eq_u32 vcc, 0, v232
    s_nop 1
    v_cndmask_b32 v180, 0, v233, vcc
    v_mov_b32 v181, v180
    v_mov_b32 v182, v180
    v_mov_b32 v183, v180
    v_cmp_eq_u32 vcc, 1, v232
    s_nop 1
    v_cndmask_b32 v184, 0, v233, vcc
    v_mov_b32 v185, v184
    v_mov_b32 v186, v184
    v_mov_b32 v187, v184
    v_cmp_eq_u32 vcc, 2, v232
    s_nop 1
    v_cndmask_b32 v188, 0, v233, vcc
    v_mov_b32 v189, v188
    v_mov_b32 v190, v188
    v_mov_b32 v191, v188
    v_cmp_eq_u32 vcc, 3, v232
    s_nop 1
    v_cndmask_b32 v192, 0, v233, vcc
    v_mov_b32 v193, v192
    v_mov_b32 v194, v192
    v_mov_b32 v195, v192
    v_lshrrev_b32 v232, 4, v0
    v_lshlrev_b32 v232, 3, v232
    v_bfe_u32 v233, v0, 2, 2
    v_add_u32 v232, v232, v233
    v_mul_u32_u24 v232, 448, v232
    v_bfe_u32 v233, v0, 4, 1
    v_lshl_add_u32 v232, v233, 5, v232
    v_and_b32 v233, 3, v0
    v_lshl_add_u32 v176, v233, 3, v232
    s_and_b32 s58, s57, 1
    s_lshl_b32 s58, s58, 5
    v_xor_b32 v176, s58, v176
    s_lshr_b32 s58, s57, 1
    s_lshl_b32 s58, s58, 6
    v_add_u32 v176, s58, v176
    v_bfe_u32 v232, v0, 2, 3
    v_lshlrev_b32 v232, 7, v232
    v_lshrrev_b32 v233, 5, v0
    v_lshl_add_u32 v232, v233, 12, v232
    v_and_b32 v233, 3, v0
    v_lshl_add_u32 v232, v233, 3, v232
    v_bfe_u32 v233, v0, 3, 2
    v_lshl_add_u32 v252, v233, 5, v232
    v_xor_b32 v253, 32, v252
    v_xor_b32 v254, 64, v252
    v_xor_b32 v255, 96, v252
    v_add_u32 v252, s64, v252
    v_add_u32 v144, 0x10000, v252
    v_add_u32 v148, 0x20000, v252
    v_add_u32 v253, s64, v253
    v_add_u32 v145, 0x10000, v253
    v_add_u32 v149, 0x20000, v253
    v_add_u32 v254, s64, v254
    v_add_u32 v146, 0x10000, v254
    v_add_u32 v150, 0x20000, v254
    v_add_u32 v255, s64, v255
    v_add_u32 v147, 0x10000, v255
    v_add_u32 v151, 0x20000, v255
    v_lshrrev_b32 v232, 3, v0
    v_mul_u32_u24 v2, 896, v232
    v_and_b32 v232, 6, v232
    v_xor_b32 v232, v232, v0
    v_and_b32 v232, 7, v232
    v_lshl_add_u32 v2, v232, 4, v2
    v_add_u32 v3, 7168, v2
    v_lshlrev_b32 v1, 4, v0
    s_and_b32 s58, s53, 1
    s_lshl_b32 s58, s58, 2
    s_add_u32 s58, s58, s57
    s_mul_i32 s68, s58, 200704
    s_lshr_b32 s23, s53, 1
    s_lshl_b32 s23, s23, 4
    s_add_u32 s23, s23, s58
    s_lshl_b32 s23, s23, 10
    s_add_u32 s23, s23, 9961472
    s_andn2_b32 s18, 1, s53
    s_lshl_b32 s18, s18, 8
    s_add_u32 s18, s18, s23
    s_lshl_b32 s58, s54, 7
    s_cmp_lt_u32 s54, 7
    s_cselect_b32 s58, s58, 0x40000000
    s_add_u32 s68, s68, s58
    s_mul_i32 s69, s57, 7168
    s_add_u32 s69, s69, s58
    v_lshl_add_u32 v178, s57, 6, v0
    v_min_u32 v179, 143, v178
    v_lshlrev_b32 v178, 3, v178
    s_lshl_b32 s58, s49, 7
    s_sub_u32 s58, s58, 16
    v_add_u32 v140, s58, v179
    v_max_i32 v140, 0, v140
    v_lshlrev_b32 v140, 4, v140
    v_add_u32 v140, 16384, v140
    v_lshlrev_b32 v179, 4, v179
    v_add_u32 v179, 157696, v179
    s_lshl_b32 s15, s57, 10
    s_cmp_eq_u32 s57, 3
    s_cselect_b32 s16, 1, 0xffff
    s_cselect_b32 s15, 2288, s15
    s_add_u32 s15, s15, 157696
    s_and_b32 s14, s57, 1
    s_mul_i32 s14, s14, 1792
    s_add_u32 s14, s14, 160000
    s_cmp_lt_u32 s57, 2
    s_cselect_b32 s16, -1, s16
    s_cselect_b32 s17, -1, 0
    s_cselect_b32 s58, 0, 8448
    s_sub_u32 s14, s14, s58
    v_add_u32 v141, s14, v1
    v_min_u32 v142, 752, v1
    v_add_u32 v142, s14, v142
    v_add_u32 v142, 1024, v142
    v_lshrrev_b32 v232, 4, v0
    v_lshlrev_b32 v232, 9, v232
    v_and_b32 v143, 15, v0
    v_lshl_add_u32 v143, v143, 3, v232
    v_mov_b32 v244, 163584
    v_lshl_add_u32 v245, s57, 2, v244
    s_add_u32 m0, s64, 16384
    s_nop 0
    buffer_load_dwordx4 v164, s[24:27], s62 offen lds
    s_add_u32 m0, s64, 20480
    s_nop 0
    buffer_load_dwordx4 v165, s[24:27], s62 offen lds
    s_add_u32 m0, s64, 24576
    s_nop 0
    buffer_load_dwordx4 v166, s[24:27], s62 offen lds
    s_add_u32 m0, s64, 28672
    s_nop 0
    buffer_load_dwordx4 v167, s[24:27], s62 offen lds
    s_add_u32 m0, s65, 77824
    s_nop 0
    buffer_load_dwordx4 v168, s[28:31], s63 offen lds
    s_waitcnt lgkmcnt(0)
    s_mul_i32 s56, s56, 0x9e3779b1
    s_add_u32 s56, s56, 0x7f4a7c15
    s_waitcnt vmcnt(5)
    s_barrier
    s_add_u32 m0, s65, 78848
    s_nop 0
    buffer_load_dwordx4 v169, s[28:31], s63 offen lds
    s_add_u32 m0, s65, 79872
    s_nop 0
    buffer_load_dwordx4 v170, s[28:31], s63 offen lds
    s_add_u32 m0, s65, 80896
    s_nop 0
    buffer_load_dwordx4 v171, s[28:31], s63 offen lds
    s_add_u32 m0, s65, 81920
    s_nop 0
    buffer_load_dwordx4 v172, s[28:31], s63 offen lds
    s_add_u32 m0, s65, 82944
    s_nop 0
    buffer_load_dwordx4 v173, s[28:31], s63 offen lds
    s_cmp_lg_u32 s22, 0
    s_cbranch_scc1 L_Hcs0
    v_add_u32 v177, 49152, v176
    s_and_b32 s58, s57, 2
    s_lshl_b32 s58, s58, 6
    v_subrev_u32 v236, s58, v177
    ds_read_b64_tr_b16 v[200:201], v177 offset:0
    ds_read_b64_tr_b16 v[202:203], v177 offset:1792
    ds_read_b64_tr_b16 v[204:205], v177 offset:128
    ds_read_b64_tr_b16 v[206:207], v177 offset:1920
    ds_read_b64_tr_b16 v[208:209], v177 offset:256
    ds_read_b64_tr_b16 v[210:211], v177 offset:2048
    ds_read_b64_tr_b16 v[212:213], v236 offset:384
    ds_read_b64_tr_b16 v[214:215], v236 offset:2176
    ds_read_b64_tr_b16 v[216:217], v177 offset:14336
    ds_read_b64_tr_b16 v[218:219], v177 offset:16128
    ds_read_b64_tr_b16 v[220:221], v177 offset:14464
    ds_read_b64_tr_b16 v[222:223], v177 offset:16256
    ds_read_b64_tr_b16 v[224:225], v177 offset:14592
    ds_read_b64_tr_b16 v[226:227], v177 offset:16384
    ds_read_b64_tr_b16 v[228:229], v236 offset:14720
    ds_read_b64_tr_b16 v[230:231], v236 offset:16512
    s_waitcnt lgkmcnt(0)
    v_mfma_f32_16x16x32_bf16 v[196:199], v[180:183], v[200:203], 0
    v_mfma_f32_16x16x32_bf16 v[196:199], v[184:187], v[204:207], v[196:199]
    v_mfma_f32_16x16x32_bf16 v[196:199], v[188:191], v[208:211], v[196:199]
    v_mfma_f32_16x16x32_bf16 v[196:199], v[192:195], v[212:215], v[196:199]
    v_mfma_f32_16x16x32_bf16 v[196:199], v[180:183], v[216:219], v[196:199]
    v_mfma_f32_16x16x32_bf16 v[196:199], v[184:187], v[220:223], v[196:199]
    v_mfma_f32_16x16x32_bf16 v[196:199], v[188:191], v[224:227], v[196:199]
    v_mfma_f32_16x16x32_bf16 v[196:199], v[192:195], v[228:231], v[196:199]
L_Hcs0:
    s_add_u32 m0, s65, 83968
    s_nop 0
    buffer_load_dwordx4 v174, s[28:31], s63 offen lds
    s_add_u32 s67, s67, 1
    s_cmp_eq_u32 s67, 7
    s_cselect_b32 s67, 0, s67
    s_cselect_b32 s58, 896, 0
    s_cselect_b32 s59, 1605632, 0
    s_add_u32 s62, s62, 128
    s_add_u32 s63, s63, 229376
    s_sub_u32 s62, s62, s58
    s_sub_u32 s63, s63, s59
    s_add_u32 m0, s64, 32768
    s_nop 0
    buffer_load_dwordx4 v164, s[24:27], s62 offen lds
    s_add_u32 m0, s64, 36864
    s_nop 0
    buffer_load_dwordx4 v165, s[24:27], s62 offen lds
    s_add_u32 m0, s64, 40960
    s_nop 0
    buffer_load_dwordx4 v166, s[24:27], s62 offen lds
    s_add_u32 m0, s64, 45056
    s_nop 0
    buffer_load_dwordx4 v167, s[24:27], s62 offen lds
    s_add_u32 m0, s65, 106496
    s_nop 0
    buffer_load_dwordx4 v168, s[28:31], s63 offen lds
    s_add_u32 m0, s65, 107520
    s_nop 0
    buffer_load_dwordx4 v169, s[28:31], s63 offen lds
    s_add_u32 m0, s65, 108544
    s_nop 0
    buffer_load_dwordx4 v170, s[28:31], s63 offen lds
    s_add_u32 m0, s65, 109568
    s_nop 0
    buffer_load_dwordx4 v171, s[28:31], s63 offen lds
    s_waitcnt vmcnt(8)
    s_barrier
    s_add_u32 m0, s65, 110592
    s_nop 0
    buffer_load_dwordx4 v172, s[28:31], s63 offen lds
    s_add_u32 m0, s65, 111616
    s_nop 0
    buffer_load_dwordx4 v173, s[28:31], s63 offen lds
    s_add_u32 m0, s65, 112640
    s_nop 0
    buffer_load_dwordx4 v174, s[28:31], s63 offen lds
    s_add_u32 s67, s67, 1
    s_cmp_eq_u32 s67, 7
    s_cselect_b32 s67, 0, s67
    s_cselect_b32 s58, 896, 0
    s_cselect_b32 s59, 1605632, 0
    s_add_u32 s62, s62, 128
    s_add_u32 s63, s63, 229376
    s_sub_u32 s62, s62, s58
    s_sub_u32 s63, s63, s59
    s_add_u32 m0, s64, 0
    s_nop 0
    buffer_load_dwordx4 v164, s[24:27], s62 offen lds
    s_add_u32 m0, s64, 4096
    s_nop 0
    buffer_load_dwordx4 v165, s[24:27], s62 offen lds
    s_cmp_lg_u32 s22, 0
    s_cbranch_scc1 L_Hcs1
    s_cmp_eq_u32 s55, 6
    s_cbranch_scc1 L_Hcs1b
    v_add_u32 v177, 77824, v176
    s_and_b32 s58, s57, 2
    s_lshl_b32 s58, s58, 6
    v_subrev_u32 v236, s58, v177
    ds_read_b64_tr_b16 v[200:201], v177 offset:0
    ds_read_b64_tr_b16 v[202:203], v177 offset:1792
    ds_read_b64_tr_b16 v[204:205], v177 offset:128
    ds_read_b64_tr_b16 v[206:207], v177 offset:1920
    ds_read_b64_tr_b16 v[208:209], v177 offset:256
    ds_read_b64_tr_b16 v[210:211], v177 offset:2048
    ds_read_b64_tr_b16 v[212:213], v236 offset:384
    ds_read_b64_tr_b16 v[214:215], v236 offset:2176
    ds_read_b64_tr_b16 v[216:217], v177 offset:14336
    ds_read_b64_tr_b16 v[218:219], v177 offset:16128
    ds_read_b64_tr_b16 v[220:221], v177 offset:14464
    ds_read_b64_tr_b16 v[222:223], v177 offset:16256
    ds_read_b64_tr_b16 v[224:225], v177 offset:14592
    ds_read_b64_tr_b16 v[226:227], v177 offset:16384
    ds_read_b64_tr_b16 v[228:229], v236 offset:14720
    ds_read_b64_tr_b16 v[230:231], v236 offset:16512
    s_waitcnt lgkmcnt(0)
    v_mfma_f32_16x16x32_bf16 v[196:199], v[180:183], v[200:203], v[196:199]
    v_mfma_f32_16x16x32_bf16 v[196:199], v[184:187], v[204:207], v[196:199]
    v_mfma_f32_16x16x32_bf16 v[196:199], v[188:191], v[208:211], v[196:199]
    v_mfma_f32_16x16x32_bf16 v[196:199], v[192:195], v[212:215], v[196:199]
    v_mfma_f32_16x16x32_bf16 v[196:199], v[180:183], v[216:219], v[196:199]
    v_mfma_f32_16x16x32_bf16 v[196:199], v[184:187], v[220:223], v[196:199]
    v_mfma_f32_16x16x32_bf16 v[196:199], v[188:191], v[224:227], v[196:199]
    v_mfma_f32_16x16x32_bf16 v[196:199], v[192:195], v[228:231], v[196:199]
L_Hcs1b:
    s_nop 7
    v_cvt_pk_bf16_f32 v197, 0, v196
    v_sub_f32 v197, v196, v197
    v_cvt_pk_bf16_f32 v196, v196, v197
    v_mov_b32 v197, s56
L_Hcs1:
    s_lshl_b32 s58, s52, 13
    s_lshl_b32 s59, s55, 10
    s_add_u32 s58, s58, s59
    s_lshl_b32 s59, s57, 7
    s_add_u32 s58, s58, s59
    s_add_u32 s58, s58, 65536
    s_cmp_lg_u32 s22, 0
    s_cselect_b32 s58, 0x40000000, s58
    buffer_store_dwordx2 v[196:197], v143, s[40:43], s58 offen sc1
    s_add_u32 m0, s64, 8192
    s_nop 0
    buffer_load_dwordx4 v166, s[24:27], s62 offen lds
    s_add_u32 m0, s64, 12288
    s_nop 0
    buffer_load_dwordx4 v167, s[24:27], s62 offen lds
    s_add_u32 m0, s65, 49152
    s_nop 0
    buffer_load_dwordx4 v168, s[28:31], s63 offen lds
    s_add_u32 m0, s65, 50176
    s_nop 0
    buffer_load_dwordx4 v169, s[28:31], s63 offen lds
    s_add_u32 m0, s65, 51200
    s_nop 0
    buffer_load_dwordx4 v170, s[28:31], s63 offen lds
    s_add_u32 m0, s65, 52224
    s_nop 0
    buffer_load_dwordx4 v171, s[28:31], s63 offen lds
    s_add_u32 m0, s65, 53248
    s_nop 0
    buffer_load_dwordx4 v172, s[28:31], s63 offen lds
    s_add_u32 m0, s65, 54272
    s_nop 0
    buffer_load_dwordx4 v173, s[28:31], s63 offen lds
    s_add_u32 m0, s65, 55296
    s_nop 0
    buffer_load_dwordx4 v174, s[28:31], s63 offen lds
    s_add_u32 s67, s67, 1
    s_cmp_eq_u32 s67, 7
    s_cselect_b32 s67, 0, s67
    s_cselect_b32 s58, 896, 0
    s_cselect_b32 s59, 1605632, 0
    s_add_u32 s62, s62, 128
    s_add_u32 s63, s63, 229376
    s_sub_u32 s62, s62, s58
    s_sub_u32 s63, s63, s59
    s_waitcnt vmcnt(12)
    s_barrier
    s_add_u32 m0, s64, 16384
    s_nop 0
    buffer_load_dwordx4 v164, s[24:27], s62 offen lds
    s_add_u32 m0, s64, 20480
    s_nop 0
    buffer_load_dwordx4 v165, s[24:27], s62 offen lds
    s_add_u32 m0, s64, 24576
    s_nop 0
    buffer_load_dwordx4 v166, s[24:27], s62 offen lds
    s_add_u32 m0, s64, 28672
    s_nop 0
    buffer_load_dwordx4 v167, s[24:27], s62 offen lds
    s_add_u32 m0, s65, 77824
    s_nop 0
    buffer_load_dwordx4 v168, s[28:31], s63 offen lds
    s_add_u32 m0, s65, 78848
    s_nop 0
    buffer_load_dwordx4 v169, s[28:31], s63 offen lds
    s_add_u32 m0, s65, 79872
    s_nop 0
    buffer_load_dwordx4 v170, s[28:31], s63 offen lds
    s_add_u32 m0, s65, 80896
    s_nop 0
    buffer_load_dwordx4 v171, s[28:31], s63 offen lds
    s_add_u32 m0, s65, 81920
    s_nop 0
    buffer_load_dwordx4 v172, s[28:31], s63 offen lds
    s_add_u32 m0, s65, 82944
    s_nop 0
    buffer_load_dwordx4 v173, s[28:31], s63 offen lds
    s_add_u32 m0, s65, 83968
    s_nop 0
    buffer_load_dwordx4 v174, s[28:31], s63 offen lds
    s_add_u32 s67, s67, 1
    s_cmp_eq_u32 s67, 7
    s_cselect_b32 s67, 0, s67
    s_cselect_b32 s58, 896, 0
    s_cselect_b32 s59, 1605632, 0
    s_add_u32 s62, s62, 128
    s_add_u32 s63, s63, 229376
    s_sub_u32 s62, s62, s58
    s_sub_u32 s63, s63, s59
    s_lshl_b32 s59, s2, 2
    s_add_u32 s59, s59, s57
    s_lshl_b32 s59, s59, 11
    v_lshlrev_b32 v240, 7, v0
    s_mov_b64 exec, 0xffff
    buffer_load_dword v241, v240, s[36:39], s59 offen
    buffer_load_dword v241, v240, s[32:35], s59 offen
    s_mov_b64 exec, -1
    s_buffer_load_dword s4, s[40:43], s23 offset:0 glc
    s_buffer_load_dword s5, s[40:43], s23 offset:128 glc
    s_buffer_load_dword s6, s[40:43], s23 offset:256 glc
    s_buffer_load_dword s7, s[40:43], s23 offset:384 glc
    s_lshr_b32 s58, s53, 1
    s_lshl_b32 s58, s58, 14
    s_and_b32 s59, s53, 1
    s_lshl_b32 s59, s59, 1
    s_lshr_b32 s10, s57, 1
    s_add_u32 s59, s59, s10
    s_lshl_b32 s59, s59, 7
    s_add_u32 s58, s58, s59
    s_add_u32 s58, s58, 9969664
    s_and_b32 s59, s57, 1
    s_lshl_b32 s59, s59, 12
    s_add_u32 s58, s58, s59
    s_buffer_load_dword s11, s[40:43], s58 offset:0 glc
    s_buffer_load_dword s11, s[40:43], s58 offset:1024 glc
    s_buffer_load_dword s11, s[40:43], s58 offset:2048 glc
    s_buffer_load_dword s11, s[40:43], s58 offset:3072 glc
    s_mul_i32 s58, s53, 7
    s_add_u32 s58, s58, s54
    s_lshl_b32 s58, s58, 4
    s_add_u32 s58, s58, s57
    s_lshl_b32 s58, s58, 10
    s_add_u32 s58, s58, 10494972
    s_buffer_load_dword s11, s[40:43], s58 glc
    s_buffer_load_dword s11, s[40:43], s58 offset:4096 glc
    s_waitcnt vmcnt(13)
    s_barrier
    s_add_u32 m0, s64, 32768
    s_nop 0
    buffer_load_dwordx4 v164, s[24:27], s62 offen lds
    s_add_u32 m0, s64, 36864
    s_nop 0
    buffer_load_dwordx4 v165, s[24:27], s62 offen lds
    s_add_u32 m0, s64, 40960
    s_nop 0
    buffer_load_dwordx4 v166, s[24:27], s62 offen lds
    s_add_u32 m0, s64, 45056
    s_nop 0
    buffer_load_dwordx4 v167, s[24:27], s62 offen lds
    s_add_u32 m0, s65, 106496
    s_nop 0
    buffer_load_dwordx4 v168, s[28:31], s63 offen lds
    s_add_u32 m0, s65, 107520
    s_nop 0
    buffer_load_dwordx4 v169, s[28:31], s63 offen lds
    s_add_u32 m0, s65, 108544
    s_nop 0
    buffer_load_dwordx4 v170, s[28:31], s63 offen lds
    s_add_u32 m0, s65, 109568
    s_nop 0
    buffer_load_dwordx4 v171, s[28:31], s63 offen lds
    s_add_u32 m0, s65, 110592
    s_nop 0
    buffer_load_dwordx4 v172, s[28:31], s63 offen lds
    s_add_u32 m0, s65, 111616
    s_nop 0
    buffer_load_dwordx4 v173, s[28:31], s63 offen lds
    s_add_u32 m0, s65, 112640
    s_nop 0
    buffer_load_dwordx4 v174, s[28:31], s63 offen lds
    s_add_u32 s67, s67, 1
    s_cmp_eq_u32 s67, 7
    s_cselect_b32 s67, 0, s67
    s_cselect_b32 s58, 896, 0
    s_cselect_b32 s59, 1605632, 0
    s_add_u32 s62, s62, 128
    s_add_u32 s63, s63, 229376
    s_sub_u32 s62, s62, s58
    s_sub_u32 s63, s63, s59
    s_waitcnt vmcnt(13)
    s_barrier
    s_lshl_b32 s60, s52, 2
    s_add_u32 s60, s60, s57
    s_lshl_b32 s60, s60, 11
    s_add_u32 s60, s60, 65536
    s_mov_b32 m0, s14
    s_nop 0
    buffer_load_dwordx4 v1, s[40:43], s60 offen sc1 lds
    s_mov_b32 exec_hi, 0xffff
    buffer_load_dwordx4 v1, s[40:43], s60 offen offset:1024 sc1 lds
    s_mov_b32 m0, s15
    s_mov_b64 exec, s[16:17]
    buffer_load_dwordx4 v140, s[40:43], 0 offen sc1 lds
    s_mov_b64 exec, -1
    s_add_u32 m0, s64, 0
    s_nop 0
    buffer_load_dwordx4 v164, s[24:27], s62 offen lds
    s_add_u32 m0, s64, 4096
    s_nop 0
    buffer_load_dwordx4 v165, s[24:27], s62 offen lds
    s_add_u32 m0, s64, 8192
    s_nop 0
    buffer_load_dwordx4 v166, s[24:27], s62 offen lds
    s_add_u32 m0, s64, 12288
    s_nop 0
    buffer_load_dwordx4 v167, s[24:27], s62 offen lds
    s_add_u32 m0, s65, 49152
    s_nop 0
    buffer_load_dwordx4 v168, s[28:31], s63 offen lds
    s_add_u32 m0, s65, 50176
    s_nop 0
    buffer_load_dwordx4 v169, s[28:31], s63 offen lds
    s_add_u32 m0, s65, 51200
    s_nop 0
    buffer_load_dwordx4 v170, s[28:31], s63 offen lds
    s_add_u32 m0, s65, 52224
    s_nop 0
    buffer_load_dwordx4 v171, s[28:31], s63 offen lds
    s_add_u32 m0, s65, 53248
    s_nop 0
    buffer_load_dwordx4 v172, s[28:31], s63 offen lds
    s_add_u32 m0, s65, 54272
    s_nop 0
    buffer_load_dwordx4 v173, s[28:31], s63 offen lds
    s_add_u32 m0, s65, 55296
    s_nop 0
    buffer_load_dwordx4 v174, s[28:31], s63 offen lds
    s_waitcnt vmcnt(14)
    s_barrier
    s_waitcnt vmcnt(11)
    ds_read_b128 v[200:203], v141
    ds_read_b128 v[204:207], v142
    ds_read_b128 v[208:211], v179
    s_waitcnt lgkmcnt(0)
    v_cmp_ne_u32 vcc, s56, v201
    v_cmp_ne_u32 s[4:5], s56, v203
    v_cmp_ne_u32 s[6:7], s56, v205
    v_cmp_ne_u32 s[8:9], s56, v207
    v_cmp_ne_u32 s[10:11], s56, v209
    v_cmp_ne_u32 s[12:13], s56, v211
    s_or_b64 s[4:5], s[4:5], s[6:7]
    s_or_b64 vcc, vcc, s[8:9]
    s_or_b64 s[4:5], s[4:5], s[10:11]
    s_or_b64 vcc, vcc, s[12:13]
    s_or_b64 vcc, vcc, s[4:5]
    s_cbranch_vccz L_Hgok
L_Hgre:
    s_add_u32 s3, s3, 1
    s_cmp_gt_u32 s3, 2097152
    s_cbranch_scc1 L_Hgok
    s_sleep 1
    s_mov_b32 m0, s14
    s_nop 0
    buffer_load_dwordx4 v1, s[40:43], s60 offen sc1 lds
    s_mov_b32 exec_hi, 0xffff
    buffer_load_dwordx4 v1, s[40:43], s60 offen offset:1024 sc1 lds
    s_mov_b32 m0, s15
    s_mov_b64 exec, s[16:17]
    buffer_load_dwordx4 v140, s[40:43], 0 offen sc1 lds
    s_mov_b64 exec, -1
    s_waitcnt vmcnt(0)
    ds_read_b128 v[200:203], v141
    ds_read_b128 v[204:207], v142
    ds_read_b128 v[208:211], v179
    s_waitcnt lgkmcnt(0)
    v_cmp_ne_u32 vcc, s56, v201
    v_cmp_ne_u32 s[4:5], s56, v203
    v_cmp_ne_u32 s[6:7], s56, v205
    v_cmp_ne_u32 s[8:9], s56, v207
    v_cmp_ne_u32 s[10:11], s56, v209
    v_cmp_ne_u32 s[12:13], s56, v211
    s_or_b64 s[4:5], s[4:5], s[6:7]
    s_or_b64 vcc, vcc, s[8:9]
    s_or_b64 s[4:5], s[4:5], s[10:11]
    s_or_b64 vcc, vcc, s[12:13]
    s_or_b64 vcc, vcc, s[4:5]
    s_cbranch_vccnz L_Hgre
L_Hgok:
    s_add_u32 m0, s64, 135168
    s_nop 0
    buffer_load_dwordx4 v2, s[36:39], s68 offen lds
    s_add_u32 m0, s64, 139264
    s_nop 0
    buffer_load_dwordx4 v3, s[36:39], s68 offen lds
    s_add_u32 s68, s68, 14336
    s_add_u32 m0, s64, 143360
    s_nop 0
    buffer_load_dwordx4 v2, s[36:39], s68 offen lds
    s_add_u32 m0, s64, 147456
    s_nop 0
    buffer_load_dwordx4 v3, s[36:39], s68 offen lds
    s_add_u32 s68, s68, 14336
    s_waitcnt vmcnt(4)
    s_waitcnt lgkmcnt(0)
    v_mov_b32 v246, 7
    ds_write_b32 v245, v246
    s_cmp_ge_u32 s54, 7
    s_cbranch_scc1 L_IDLE
    s_add_u32 m0, s64, 16384
    s_nop 0
    buffer_load_dwordx4 v2, s[36:39], s68 offen lds
    s_add_u32 m0, s64, 20480
    s_nop 0
    buffer_load_dwordx4 v3, s[36:39], s68 offen lds
    s_add_u32 s68, s68, 14336
    s_add_u32 m0, s64, 24576
    s_nop 0
    buffer_load_dwordx4 v2, s[36:39], s68 offen lds
    s_add_u32 m0, s64, 28672
    s_nop 0
    buffer_load_dwordx4 v3, s[36:39], s68 offen lds
    s_add_u32 s68, s68, 14336
    s_waitcnt vmcnt(7)
    s_add_u32 m0, s64, 77824
    s_nop 0
    buffer_load_dwordx4 v2, s[36:39], s68 offen lds
    s_add_u32 m0, s64, 81920
    s_nop 0
    buffer_load_dwordx4 v3, s[36:39], s68 offen lds
    s_add_u32 s68, s68, 14336
    s_waitcnt vmcnt(8)
    ds_read_b64_tr_b16 v[24:25], v148 offset:4096
    ds_read_b64_tr_b16 v[28:29], v149 offset:4096
    ds_read_b64_tr_b16 v[32:33], v150 offset:4096
    ds_read_b64_tr_b16 v[36:37], v151 offset:4096
    s_waitcnt vmcnt(7)
    s_add_u32 m0, s64, 86016
    s_nop 0
    buffer_load_dwordx4 v2, s[36:39], s68 offen lds
    s_add_u32 m0, s64, 90112
    s_nop 0
    buffer_load_dwordx4 v3, s[36:39], s68 offen lds
    s_add_u32 s68, s68, 14336
    s_waitcnt vmcnt(8)
    s_waitcnt lgkmcnt(0)
    ds_read_b64_tr_b16 v[26:27], v148 offset:12288
    ds_read_b64_tr_b16 v[30:31], v149 offset:12288
    ds_read_b64_tr_b16 v[34:35], v150 offset:12288
    ds_read_b64_tr_b16 v[38:39], v151 offset:12288
    s_waitcnt vmcnt(7)
    s_add_u32 m0, s64, 135168
    s_nop 0
    buffer_load_dwordx4 v2, s[36:39], s68 offen lds
    s_add_u32 m0, s64, 139264
    s_nop 0
    buffer_load_dwordx4 v3, s[36:39], s68 offen lds
    s_add_u32 s68, s68, 14336
    s_waitcnt vmcnt(8)
    s_waitcnt lgkmcnt(0)
    ds_read_b64_tr_b16 v[40:41], v252 offset:16384
    ds_read_b64_tr_b16 v[44:45], v253 offset:16384
    ds_read_b64_tr_b16 v[48:49], v254 offset:16384
    ds_read_b64_tr_b16 v[52:53], v255 offset:16384
    s_waitcnt vmcnt(7)
    s_add_u32 m0, s64, 143360
    s_nop 0
    buffer_load_dwordx4 v2, s[36:39], s68 offen lds
    s_add_u32 m0, s64, 147456
    s_nop 0
    buffer_load_dwordx4 v3, s[36:39], s68 offen lds
    s_add_u32 s68, s68, 14336
    s_waitcnt vmcnt(8)
    s_waitcnt lgkmcnt(0)
    ds_read_b64_tr_b16 v[42:43], v252 offset:24576
    ds_read_b64_tr_b16 v[46:47], v253 offset:24576
    ds_read_b64_tr_b16 v[50:51], v254 offset:24576
    ds_read_b64_tr_b16 v[54:55], v255 offset:24576
    s_waitcnt vmcnt(7)
    s_add_u32 m0, s64, 16384
    s_nop 0
    buffer_load_dwordx4 v2, s[36:39], s68 offen lds
    s_add_u32 m0, s64, 20480
    s_nop 0
    buffer_load_dwordx4 v3, s[36:39], s68 offen lds
    s_add_u32 s68, s68, 14336
    s_waitcnt vmcnt(8)
    s_waitcnt lgkmcnt(0)
    ds_read_b64_tr_b16 v[56:57], v144 offset:12288
    ds_read_b64_tr_b16 v[60:61], v145 offset:12288
    ds_read_b64_tr_b16 v[64:65], v146 offset:12288
    ds_read_b64_tr_b16 v[68:69], v147 offset:12288
    s_waitcnt vmcnt(7)
    s_add_u32 m0, s64, 24576
    s_nop 0
    buffer_load_dwordx4 v2, s[36:39], s68 offen lds
    s_add_u32 m0, s64, 28672
    s_nop 0
    buffer_load_dwordx4 v3, s[36:39], s68 offen lds
    s_add_u32 s68, s68, 14336
    s_waitcnt vmcnt(8)
    s_waitcnt lgkmcnt(0)
    ds_read_b64_tr_b16 v[58:59], v144 offset:20480
    ds_read_b64_tr_b16 v[62:63], v145 offset:20480
    ds_read_b64_tr_b16 v[66:67], v146 offset:20480
    ds_read_b64_tr_b16 v[70:71], v147 offset:20480
    s_waitcnt vmcnt(7)
    ds_read_b128 v[248:251], v244 offset:16
    s_waitcnt lgkmcnt(0)
    v_min3_u32 v248, v248, v249, v250
    v_min_u32 v248, v248, v251
    v_cmp_gt_u32 vcc, 6, v248
    s_nop 0
    s_cbranch_vccz L_Hcp6_ok
L_Hcp6:
    s_add_u32 s3, s3, 1
    s_cmp_gt_u32 s3, 2097152
    s_cbranch_scc1 L_Hcp6_ok
    s_sleep 2
    ds_read_b128 v[248:251], v244 offset:16
    s_waitcnt lgkmcnt(0)
    v_min3_u32 v248, v248, v249, v250
    v_min_u32 v248, v248, v251
    v_cmp_gt_u32 vcc, 6, v248
    s_nop 0
    s_cbranch_vccnz L_Hcp6
L_Hcp6_ok:
    s_add_u32 m0, s64, 32768
    s_nop 0
    buffer_load_dwordx4 v2, s[36:39], s68 offen lds
    s_add_u32 m0, s64, 36864
    s_nop 0
    buffer_load_dwordx4 v3, s[36:39], s68 offen lds
    s_add_u32 s68, s68, 14336
    s_waitcnt vmcnt(8)
    s_waitcnt lgkmcnt(0)
    ds_read_b64_tr_b16 v[72:73], v148 offset:4096
    ds_read_b64_tr_b16 v[76:77], v149 offset:4096
    ds_read_b64_tr_b16 v[80:81], v150 offset:4096
    ds_read_b64_tr_b16 v[84:85], v151 offset:4096
    s_waitcnt vmcnt(6)
    s_waitcnt lgkmcnt(0)
    ds_read_b64_tr_b16 v[74:75], v148 offset:12288
    ds_read_b64_tr_b16 v[78:79], v149 offset:12288
    ds_read_b64_tr_b16 v[82:83], v150 offset:12288
    ds_read_b64_tr_b16 v[86:87], v151 offset:12288
    s_waitcnt vmcnt(4)
    s_waitcnt lgkmcnt(0)
    ds_read_b64_tr_b16 v[88:89], v252 offset:16384
    ds_read_b64_tr_b16 v[92:93], v253 offset:16384
    ds_read_b64_tr_b16 v[96:97], v254 offset:16384
    ds_read_b64_tr_b16 v[100:101], v255 offset:16384
    s_waitcnt vmcnt(3)
    s_add_u32 m0, s64, 40960
    s_nop 0
    buffer_load_dwordx4 v2, s[36:39], s68 offen lds
    s_add_u32 m0, s64, 45056
    s_nop 0
    buffer_load_dwordx4 v3, s[36:39], s68 offen lds
    s_add_u32 s68, s68, 14336
    s_waitcnt vmcnt(4)
    s_waitcnt lgkmcnt(0)
    ds_read_b64_tr_b16 v[90:91], v252 offset:24576
    ds_read_b64_tr_b16 v[94:95], v253 offset:24576
    ds_read_b64_tr_b16 v[98:99], v254 offset:24576
    ds_read_b64_tr_b16 v[102:103], v255 offset:24576
    s_waitcnt vmcnt(3)
    s_waitcnt vmcnt(0)
    s_waitcnt lgkmcnt(0)
    ds_read_b64_tr_b16 v[104:105], v252 offset:32768
    ds_read_b64_tr_b16 v[108:109], v253 offset:32768
    ds_read_b64_tr_b16 v[112:113], v254 offset:32768
    ds_read_b64_tr_b16 v[116:117], v255 offset:32768
    ds_read_b64_tr_b16 v[106:107], v252 offset:40960
    ds_read_b64_tr_b16 v[110:111], v253 offset:40960
    ds_read_b64_tr_b16 v[114:115], v254 offset:40960
    ds_read_b64_tr_b16 v[118:119], v255 offset:40960
    ds_read_b128 v[248:251], v244 offset:16
    s_waitcnt lgkmcnt(0)
    v_min3_u32 v248, v248, v249, v250
    v_min_u32 v248, v248, v251
    v_cmp_gt_u32 vcc, 8, v248
    s_nop 0
    s_cbranch_vccz L_Hcp8_ok
L_Hcp8:
    s_add_u32 s3, s3, 1
    s_cmp_gt_u32 s3, 2097152
    s_cbranch_scc1 L_Hcp8_ok
    s_sleep 2
    ds_read_b128 v[248:251], v244 offset:16
    s_waitcnt lgkmcnt(0)
    v_min3_u32 v248, v248, v249, v250
    v_min_u32 v248, v248, v251
    v_cmp_gt_u32 vcc, 8, v248
    s_nop 0
    s_cbranch_vccnz L_Hcp8
L_Hcp8_ok:
    s_add_u32 m0, s64, 135168
    s_nop 0
    buffer_load_dwordx4 v2, s[36:39], s68 offen lds
    s_add_u32 m0, s64, 139264
    s_nop 0
    buffer_load_dwordx4 v3, s[36:39], s68 offen lds
    s_add_u32 s68, s68, 14336
    s_add_u32 m0, s64, 143360
    s_nop 0
    buffer_load_dwordx4 v2, s[36:39], s68 offen lds
    s_add_u32 m0, s64, 147456
    s_nop 0
    buffer_load_dwordx4 v3, s[36:39], s68 offen lds
    s_add_u32 s68, s68, 14336
    s_add_u32 s58, s69, 372736
    s_add_u32 m0, s64, 131072
    s_nop 0
    buffer_load_dwordx4 v2, s[32:35], s58 offen lds
    s_add_u32 s58, s69, 344064
    s_add_u32 m0, s64, 126976
    s_nop 0
    buffer_load_dwordx4 v2, s[32:35], s58 offen lds
    s_add_u32 s58, s69, 315392
    s_add_u32 m0, s64, 122880
    s_nop 0
    buffer_load_dwordx4 v2, s[32:35], s58 offen lds
    s_add_u32 s58, s69, 286720
    s_add_u32 m0, s64, 118784
    s_nop 0
    buffer_load_dwordx4 v2, s[32:35], s58 offen lds
    s_add_u32 s58, s69, 258048
    s_add_u32 m0, s64, 114688
    s_nop 0
    buffer_load_dwordx4 v2, s[32:35], s58 offen lds
    s_add_u32 s58, s69, 229376
    s_add_u32 m0, s64, 110592
    s_nop 0
    buffer_load_dwordx4 v2, s[32:35], s58 offen lds
    s_add_u32 s58, s69, 200704
    s_add_u32 m0, s64, 106496
    s_nop 0
    buffer_load_dwordx4 v2, s[32:35], s58 offen lds
    s_add_u32 s58, s69, 172032
    s_add_u32 m0, s64, 102400
    s_nop 0
    buffer_load_dwordx4 v2, s[32:35], s58 offen lds
    s_add_u32 s58, s69, 143360
    s_add_u32 m0, s64, 98304
    s_nop 0
    buffer_load_dwordx4 v2, s[32:35], s58 offen lds
    s_waitcnt vmcnt(12)
    s_add_u32 s58, s69, 114688
    s_add_u32 m0, s64, 94208
    s_nop 0
    buffer_load_dwordx4 v2, s[32:35], s58 offen lds
    s_waitcnt vmcnt(12)
    s_waitcnt lgkmcnt(0)
    ds_read_b64_tr_b16 v[120:121], v148 offset:4096
    ds_read_b64_tr_b16 v[124:125], v149 offset:4096
    ds_read_b64_tr_b16 v[128:129], v150 offset:4096
    ds_read_b64_tr_b16 v[132:133], v151 offset:4096
    s_buffer_load_dword s4, s[40:43], s23 offset:0 glc
    s_buffer_load_dword s5, s[40:43], s23 offset:128 glc
    s_buffer_load_dword s6, s[40:43], s23 offset:256 glc
    s_buffer_load_dword s7, s[40:43], s23 offset:384 glc
    s_add_u32 s58, s69, 86016
    s_add_u32 m0, s64, 90112
    s_nop 0
    buffer_load_dwordx4 v2, s[32:35], s58 offen lds
    s_waitcnt vmcnt(12)
    s_add_u32 s58, s69, 57344
    s_add_u32 m0, s64, 86016
    s_nop 0
    buffer_load_dwordx4 v2, s[32:35], s58 offen lds
    s_waitcnt vmcnt(12)
    s_waitcnt lgkmcnt(0)
    ds_read_b64_tr_b16 v[122:123], v148 offset:12288
    ds_read_b64_tr_b16 v[126:127], v149 offset:12288
    ds_read_b64_tr_b16 v[130:131], v150 offset:12288
    ds_read_b64_tr_b16 v[134:135], v151 offset:12288
    s_add_u32 s58, s69, 28672
    s_add_u32 m0, s64, 81920
    s_nop 0
    buffer_load_dwordx4 v2, s[32:35], s58 offen lds
    s_waitcnt vmcnt(12)
    s_add_u32 s58, s69, 0
    s_add_u32 m0, s64, 77824
    s_nop 0
    buffer_load_dwordx4 v2, s[32:35], s58 offen lds
    s_waitcnt vmcnt(12)
    s_waitcnt lgkmcnt(0)
L_P2L:
    v_mov_b32 v243, 8
    ds_write_b32 v245, v243
    v_mov_b32 v247, v245
    v_mov_b32 v246, v244
    s_and_b32 s61, s53, 1
    s_lshl_b32 s61, s61, 2
    s_add_u32 s61, s61, s57
    s_xor_b32 s60, s53, 1
    s_mul_i32 s60, s60, 294912
    s_mul_i32 s61, s61, 7168
    s_add_u32 s61, s61, 262144
    s_add_u32 s12, s60, s61
    s_add_u32 s13, s12, 73728
    s_add_u32 s14, s12, 147456
    s_add_u32 s15, s12, 221184
    s_mul_i32 s62, s53, 294912
    s_mul_i32 s65, s57, 73728
    s_add_u32 s65, s65, s62
    s_add_u32 s65, s65, 319488
    s_add_u32 s62, s62, s61
    v_and_b32 v252, 15, v0
    v_lshrrev_b32 v253, 4, v0
    v_xor_b32 v253, v253, v252
    v_lshlrev_b32 v253, 4, v253
    v_lshl_add_u32 v252, v252, 8, v253
    s_lshl_b32 s59, s57, 14
    v_add_u32 v252, s59, v252
    v_xor_b32 v253, 64, v252
    v_xor_b32 v254, 128, v252
    v_xor_b32 v255, 192, v252
    s_branch L_pb_w
L_pb:
    s_buffer_load_dword s4, s[40:43], s23 offset:0 glc
    s_buffer_load_dword s5, s[40:43], s23 offset:128 glc
    s_buffer_load_dword s6, s[40:43], s23 offset:256 glc
    s_buffer_load_dword s7, s[40:43], s23 offset:384 glc
L_pb_w:
    s_waitcnt lgkmcnt(0)
    s_xor_b32 s4, s4, s56
    s_xor_b32 s5, s5, s56
    s_xor_b32 s6, s6, s56
    s_xor_b32 s7, s7, s56
    s_or_b64 s[4:5], s[4:5], s[6:7]
    s_cbranch_scc0 L_pb_ok
    s_add_u32 s3, s3, 1
    s_cmp_gt_u32 s3, 2097152
    s_cbranch_scc1 L_pb_ok
    s_sleep 1
    s_branch L_pb
L_pb_ok:
    buffer_load_dwordx4 v[200:203], v1, s[40:43], s12 offen offset:0 sc1
    buffer_load_dwordx4 v[204:207], v1, s[40:43], s12 offen offset:1024 sc1
    buffer_load_dwordx4 v[208:211], v1, s[40:43], s12 offen offset:2048 sc1
    buffer_load_dwordx4 v[212:215], v1, s[40:43], s12 offen offset:3072 sc1
    s_add_u32 s12, s12, 4096
    buffer_load_dwordx4 v[216:219], v1, s[40:43], s12 offen offset:0 sc1
    buffer_load_dwordx4 v[220:223], v1, s[40:43], s12 offen offset:1024 sc1
    buffer_load_dwordx4 v[224:227], v1, s[40:43], s12 offen offset:2048 sc1
    buffer_load_dwordx4 v[228:231], v1, s[40:43], s13 offen offset:0 sc1
    buffer_load_dwordx4 v[232:235], v1, s[40:43], s13 offen offset:1024 sc1
    buffer_load_dwordx4 v[236:239], v1, s[40:43], s13 offen offset:2048 sc1
    buffer_load_dwordx4 v[240:243], v1, s[40:43], s13 offen offset:3072 sc1
    s_add_u32 s13, s13, 4096
    buffer_load_dwordx4 v[4:7], v1, s[40:43], s13 offen offset:0 sc1
    buffer_load_dwordx4 v[8:11], v1, s[40:43], s13 offen offset:1024 sc1
    v_bfe_u32 v248, v0, 2, 3
    v_lshlrev_b32 v248, 7, v248
    v_lshrrev_b32 v249, 5, v0
    v_lshl_add_u32 v248, v249, 10, v248
    v_and_b32 v249, 3, v0
    v_lshl_add_u32 v248, v249, 3, v248
    v_bfe_u32 v249, v0, 3, 2
    v_lshl_add_u32 v20, v249, 5, v248
    v_xor_b32 v21, 32, v20
    v_xor_b32 v22, 64, v20
    v_xor_b32 v23, 96, v20
    v_add_u32 v20, 77824, v20
    v_add_u32 v21, 77824, v21
    v_add_u32 v22, 77824, v22
    v_add_u32 v23, 77824, v23
    s_lshr_b32 s66, s53, 1
    s_lshl_b32 s66, s66, 14
    s_and_b32 s58, s53, 1
    s_lshl_b32 s58, s58, 1
    s_lshr_b32 s59, s57, 1
    s_add_u32 s58, s58, s59
    s_lshl_b32 s58, s58, 7
    s_add_u32 s66, s66, s58
    s_add_u32 s66, s66, 9969664
    v_and_b32 v248, 15, v0
    v_lshlrev_b32 v248, 7, v248
    v_lshrrev_b32 v249, 5, v0
    v_xor_b32 v249, v249, v0
    v_and_b32 v249, 7, v249
    v_lshl_add_u32 v248, v249, 4, v248
    v_bfe_u32 v249, v0, 4, 1
    v_lshl_add_u32 v248, v249, 3, v248
    s_lshl_b32 s58, s57, 11
    s_add_u32 s58, s58, 65536
    v_add_u32 v245, s58, v248
    s_waitcnt vmcnt(12)
    v_mfma_f32_16x16x32_bf16 v[136:139], v[24:27], v[200:203], 0
    v_mfma_f32_16x16x32_bf16 v[140:143], v[28:31], v[200:203], 0
    v_mfma_f32_16x16x32_bf16 v[144:147], v[32:35], v[200:203], 0
    v_mfma_f32_16x16x32_bf16 v[148:151], v[36:39], v[200:203], 0
    s_waitcnt vmcnt(11)
    v_mfma_f32_16x16x32_bf16 v[136:139], v[40:43], v[204:207], v[136:139]
    buffer_load_dwordx4 v[16:19], v1, s[40:43], s13 offen offset:2048 sc1
    v_mfma_f32_16x16x32_bf16 v[140:143], v[44:47], v[204:207], v[140:143]
    v_mfma_f32_16x16x32_bf16 v[144:147], v[48:51], v[204:207], v[144:147]
    v_mfma_f32_16x16x32_bf16 v[148:151], v[52:55], v[204:207], v[148:151]
    s_waitcnt vmcnt(11)
    v_mfma_f32_16x16x32_bf16 v[136:139], v[56:59], v[208:211], v[136:139]
    buffer_load_dwordx4 v[200:203], v1, s[40:43], s14 offen offset:0 sc1
    v_mfma_f32_16x16x32_bf16 v[140:143], v[60:63], v[208:211], v[140:143]
    v_mfma_f32_16x16x32_bf16 v[144:147], v[64:67], v[208:211], v[144:147]
    v_mfma_f32_16x16x32_bf16 v[148:151], v[68:71], v[208:211], v[148:151]
    s_waitcnt vmcnt(11)
    v_mfma_f32_16x16x32_bf16 v[136:139], v[72:75], v[212:215], v[136:139]
    buffer_load_dwordx4 v[204:207], v1, s[40:43], s14 offen offset:1024 sc1
    v_mfma_f32_16x16x32_bf16 v[140:143], v[76:79], v[212:215], v[140:143]
    ds_read_b128 v[248:251], v246 offset:16
    ds_read_b128 v[12:15], v246
    v_mfma_f32_16x16x32_bf16 v[144:147], v[80:83], v[212:215], v[144:147]
    v_mfma_f32_16x16x32_bf16 v[148:151], v[84:87], v[212:215], v[148:151]
    s_waitcnt vmcnt(11)
    v_mfma_f32_16x16x32_bf16 v[136:139], v[88:91], v[216:219], v[136:139]
    buffer_load_dwordx4 v[208:211], v1, s[40:43], s14 offen offset:2048 sc1
    v_mfma_f32_16x16x32_bf16 v[140:143], v[92:95], v[216:219], v[140:143]
    v_mfma_f32_16x16x32_bf16 v[144:147], v[96:99], v[216:219], v[144:147]
    v_mfma_f32_16x16x32_bf16 v[148:151], v[100:103], v[216:219], v[148:151]
    s_waitcnt vmcnt(11)
    v_mfma_f32_16x16x32_bf16 v[136:139], v[104:107], v[220:223], v[136:139]
    buffer_load_dwordx4 v[212:215], v1, s[40:43], s14 offen offset:3072 sc1
    s_add_u32 s14, s14, 4096
    v_mfma_f32_16x16x32_bf16 v[140:143], v[108:111], v[220:223], v[140:143]
    s_waitcnt lgkmcnt(0)
    v_min3_u32 v248, v248, v249, v250
    v_mfma_f32_16x16x32_bf16 v[144:147], v[112:115], v[220:223], v[144:147]
    v_min_u32 v248, v248, v251
    v_cmp_gt_u32 vcc, 9, v248
    v_mfma_f32_16x16x32_bf16 v[148:151], v[116:119], v[220:223], v[148:151]
    s_cbranch_vccnz L_d0
L_d0_ok:
    s_waitcnt vmcnt(11)
    v_mfma_f32_16x16x32_bf16 v[136:139], v[120:123], v[224:227], v[136:139]
    buffer_load_dwordx4 v[216:219], v1, s[40:43], s14 offen offset:0 sc1
    v_mfma_f32_16x16x32_bf16 v[140:143], v[124:127], v[224:227], v[140:143]
    v_min3_u32 v12, v12, v13, v14
    v_min_u32 v12, v12, v15
    v_mfma_f32_16x16x32_bf16 v[144:147], v[128:131], v[224:227], v[144:147]
    v_cmp_gt_u32 vcc, 8, v12
    v_mfma_f32_16x16x32_bf16 v[148:151], v[132:135], v[224:227], v[148:151]
    s_cbranch_vccnz L_d1l
L_d1l_ok:
    s_waitcnt vmcnt(11)
    v_mfma_f32_16x16x32_bf16 v[152:155], v[24:27], v[228:231], 0
    buffer_load_dwordx4 v[220:223], v1, s[40:43], s14 offen offset:1024 sc1
    v_mfma_f32_16x16x32_bf16 v[156:159], v[28:31], v[228:231], 0
    ds_write_b128 v252, v[136:139] offset:0
    v_mfma_f32_16x16x32_bf16 v[160:163], v[32:35], v[228:231], 0
    ds_write_b128 v253, v[140:143] offset:0
    v_mfma_f32_16x16x32_bf16 v[164:167], v[36:39], v[228:231], 0
    ds_write_b128 v254, v[144:147] offset:0
    s_waitcnt vmcnt(11)
    v_mfma_f32_16x16x32_bf16 v[152:155], v[40:43], v[232:235], v[152:155]
    buffer_load_dwordx4 v[224:227], v1, s[40:43], s14 offen offset:2048 sc1
    v_mfma_f32_16x16x32_bf16 v[156:159], v[44:47], v[232:235], v[156:159]
    ds_write_b128 v255, v[148:151] offset:0
    v_mfma_f32_16x16x32_bf16 v[160:163], v[48:51], v[232:235], v[160:163]
    v_mfma_f32_16x16x32_bf16 v[164:167], v[52:55], v[232:235], v[164:167]
    s_waitcnt vmcnt(11)
    v_mfma_f32_16x16x32_bf16 v[152:155], v[56:59], v[236:239], v[152:155]
    buffer_load_dwordx4 v[228:231], v1, s[40:43], s15 offen offset:0 sc1
    v_mfma_f32_16x16x32_bf16 v[156:159], v[60:63], v[236:239], v[156:159]
    s_waitcnt lgkmcnt(0)
    v_mfma_f32_16x16x32_bf16 v[160:163], v[64:67], v[236:239], v[160:163]
    v_mfma_f32_16x16x32_bf16 v[164:167], v[68:71], v[236:239], v[164:167]
    s_waitcnt vmcnt(11)
    v_mfma_f32_16x16x32_bf16 v[152:155], v[72:75], v[240:243], v[152:155]
    buffer_load_dwordx4 v[232:235], v1, s[40:43], s15 offen offset:1024 sc1
    v_mfma_f32_16x16x32_bf16 v[156:159], v[76:79], v[240:243], v[156:159]
    v_mfma_f32_16x16x32_bf16 v[160:163], v[80:83], v[240:243], v[160:163]
    v_mfma_f32_16x16x32_bf16 v[164:167], v[84:87], v[240:243], v[164:167]
    s_waitcnt vmcnt(11)
    v_mfma_f32_16x16x32_bf16 v[152:155], v[88:91], v[4:7], v[152:155]
    buffer_load_dwordx4 v[236:239], v1, s[40:43], s15 offen offset:2048 sc1
    v_mfma_f32_16x16x32_bf16 v[156:159], v[92:95], v[4:7], v[156:159]
    v_mfma_f32_16x16x32_bf16 v[160:163], v[96:99], v[4:7], v[160:163]
    v_mfma_f32_16x16x32_bf16 v[164:167], v[100:103], v[4:7], v[164:167]
    s_waitcnt vmcnt(11)
    v_mfma_f32_16x16x32_bf16 v[152:155], v[104:107], v[8:11], v[152:155]
    buffer_load_dwordx4 v[240:243], v1, s[40:43], s15 offen offset:3072 sc1
    s_add_u32 s15, s15, 4096
    v_mfma_f32_16x16x32_bf16 v[156:159], v[108:111], v[8:11], v[156:159]
    v_mfma_f32_16x16x32_bf16 v[160:163], v[112:115], v[8:11], v[160:163]
    v_mfma_f32_16x16x32_bf16 v[164:167], v[116:119], v[8:11], v[164:167]
    s_waitcnt vmcnt(11)
    v_mfma_f32_16x16x32_bf16 v[152:155], v[120:123], v[16:19], v[152:155]
    buffer_load_dwordx4 v[4:7], v1, s[40:43], s15 offen offset:0 sc1
    v_mfma_f32_16x16x32_bf16 v[156:159], v[124:127], v[16:19], v[156:159]
    v_mfma_f32_16x16x32_bf16 v[160:163], v[128:131], v[16:19], v[160:163]
    v_mfma_f32_16x16x32_bf16 v[164:167], v[132:135], v[16:19], v[164:167]
    s_waitcnt vmcnt(11)
    v_mfma_f32_16x16x32_bf16 v[136:139], v[24:27], v[200:203], 0
    buffer_load_dwordx4 v[8:11], v1, s[40:43], s15 offen offset:1024 sc1
    v_mfma_f32_16x16x32_bf16 v[140:143], v[28:31], v[200:203], 0
    ds_write_b128 v252, v[152:155] offset:4096
    v_mfma_f32_16x16x32_bf16 v[144:147], v[32:35], v[200:203], 0
    ds_write_b128 v253, v[156:159] offset:4096
    v_mfma_f32_16x16x32_bf16 v[148:151], v[36:39], v[200:203], 0
    ds_write_b128 v254, v[160:163] offset:4096
    s_waitcnt vmcnt(11)
    v_mfma_f32_16x16x32_bf16 v[136:139], v[40:43], v[204:207], v[136:139]
    buffer_load_dwordx4 v[16:19], v1, s[40:43], s15 offen offset:2048 sc1
    v_mfma_f32_16x16x32_bf16 v[140:143], v[44:47], v[204:207], v[140:143]
    ds_write_b128 v255, v[164:167] offset:4096
    v_mfma_f32_16x16x32_bf16 v[144:147], v[48:51], v[204:207], v[144:147]
    v_mfma_f32_16x16x32_bf16 v[148:151], v[52:55], v[204:207], v[148:151]
    s_waitcnt vmcnt(11)
    v_mfma_f32_16x16x32_bf16 v[136:139], v[56:59], v[208:211], v[136:139]
    buffer_load_dwordx4 v[200:203], v1, s[40:43], s62 offen offset:0 sc1
    v_mfma_f32_16x16x32_bf16 v[140:143], v[60:63], v[208:211], v[140:143]
    s_waitcnt lgkmcnt(0)
    v_mov_b32 v244, 11
    v_mfma_f32_16x16x32_bf16 v[144:147], v[64:67], v[208:211], v[144:147]
    ds_write_b32 v247, v244
    v_mfma_f32_16x16x32_bf16 v[148:151], v[68:71], v[208:211], v[148:151]
    s_waitcnt vmcnt(11)
    v_mfma_f32_16x16x32_bf16 v[136:139], v[72:75], v[212:215], v[136:139]
    buffer_load_dwordx4 v[204:207], v1, s[40:43], s62 offen offset:1024 sc1
    v_mfma_f32_16x16x32_bf16 v[140:143], v[76:79], v[212:215], v[140:143]
    v_mfma_f32_16x16x32_bf16 v[144:147], v[80:83], v[212:215], v[144:147]
    v_mfma_f32_16x16x32_bf16 v[148:151], v[84:87], v[212:215], v[148:151]
    s_waitcnt vmcnt(11)
    v_mfma_f32_16x16x32_bf16 v[136:139], v[88:91], v[216:219], v[136:139]
    buffer_load_dwordx4 v[208:211], v1, s[40:43], s62 offen offset:2048 sc1
    v_mfma_f32_16x16x32_bf16 v[140:143], v[92:95], v[216:219], v[140:143]
    v_mfma_f32_16x16x32_bf16 v[144:147], v[96:99], v[216:219], v[144:147]
    v_mfma_f32_16x16x32_bf16 v[148:151], v[100:103], v[216:219], v[148:151]
    s_waitcnt vmcnt(11)
    v_mfma_f32_16x16x32_bf16 v[136:139], v[104:107], v[220:223], v[136:139]
    buffer_load_dwordx4 v[212:215], v1, s[40:43], s62 offen offset:3072 sc1
    s_add_u32 s62, s62, 4096
    v_mfma_f32_16x16x32_bf16 v[140:143], v[108:111], v[220:223], v[140:143]
    v_mfma_f32_16x16x32_bf16 v[144:147], v[112:115], v[220:223], v[144:147]
    v_mfma_f32_16x16x32_bf16 v[148:151], v[116:119], v[220:223], v[148:151]
    s_waitcnt vmcnt(11)
    v_mfma_f32_16x16x32_bf16 v[136:139], v[120:123], v[224:227], v[136:139]
    buffer_load_dwordx4 v[216:219], v1, s[40:43], s62 offen offset:0 sc1
    v_mfma_f32_16x16x32_bf16 v[140:143], v[124:127], v[224:227], v[140:143]
    v_mfma_f32_16x16x32_bf16 v[144:147], v[128:131], v[224:227], v[144:147]
    v_mfma_f32_16x16x32_bf16 v[148:151], v[132:135], v[224:227], v[148:151]
    s_waitcnt vmcnt(11)
    v_mfma_f32_16x16x32_bf16 v[152:155], v[24:27], v[228:231], 0
    buffer_load_dwordx4 v[220:223], v1, s[40:43], s62 offen offset:1024 sc1
    v_mfma_f32_16x16x32_bf16 v[156:159], v[28:31], v[228:231], 0
    ds_write_b128 v252, v[136:139] offset:8192
    v_mfma_f32_16x16x32_bf16 v[160:163], v[32:35], v[228:231], 0
    ds_write_b128 v253, v[140:143] offset:8192
    v_mfma_f32_16x16x32_bf16 v[164:167], v[36:39], v[228:231], 0
    ds_write_b128 v254, v[144:147] offset:8192
    s_waitcnt vmcnt(11)
    v_mfma_f32_16x16x32_bf16 v[152:155], v[40:43], v[232:235], v[152:155]
    buffer_load_dwordx4 v[224:227], v1, s[40:43], s62 offen offset:2048 sc1
    s_add_u32 s62, s62, 69632
    v_mfma_f32_16x16x32_bf16 v[156:159], v[44:47], v[232:235], v[156:159]
    ds_write_b128 v255, v[148:151] offset:8192
    v_mfma_f32_16x16x32_bf16 v[160:163], v[48:51], v[232:235], v[160:163]
    v_mfma_f32_16x16x32_bf16 v[164:167], v[52:55], v[232:235], v[164:167]
    s_waitcnt vmcnt(11)
    v_mfma_f32_16x16x32_bf16 v[152:155], v[56:59], v[236:239], v[152:155]
    buffer_load_dwordx4 v[228:231], v1, s[40:43], s62 offen offset:0 sc1
    v_mfma_f32_16x16x32_bf16 v[156:159], v[60:63], v[236:239], v[156:159]
    s_waitcnt lgkmcnt(0)
    v_mfma_f32_16x16x32_bf16 v[160:163], v[64:67], v[236:239], v[160:163]
    v_mfma_f32_16x16x32_bf16 v[164:167], v[68:71], v[236:239], v[164:167]
    s_waitcnt vmcnt(11)
    v_mfma_f32_16x16x32_bf16 v[152:155], v[72:75], v[240:243], v[152:155]
    buffer_load_dwordx4 v[232:235], v1, s[40:43], s62 offen offset:1024 sc1
    v_mfma_f32_16x16x32_bf16 v[156:159], v[76:79], v[240:243], v[156:159]
    v_mfma_f32_16x16x32_bf16 v[160:163], v[80:83], v[240:243], v[160:163]
    v_mfma_f32_16x16x32_bf16 v[164:167], v[84:87], v[240:243], v[164:167]
    s_waitcnt vmcnt(11)
    v_mfma_f32_16x16x32_bf16 v[152:155], v[88:91], v[4:7], v[152:155]
    buffer_load_dwordx4 v[236:239], v1, s[40:43], s62 offen offset:2048 sc1
    v_mfma_f32_16x16x32_bf16 v[156:159], v[92:95], v[4:7], v[156:159]
    v_mfma_f32_16x16x32_bf16 v[160:163], v[96:99], v[4:7], v[160:163]
    v_mfma_f32_16x16x32_bf16 v[164:167], v[100:103], v[4:7], v[164:167]
    s_waitcnt vmcnt(11)
    v_mfma_f32_16x16x32_bf16 v[152:155], v[104:107], v[8:11], v[152:155]
    buffer_load_dwordx4 v[240:243], v1, s[40:43], s62 offen offset:3072 sc1
    s_add_u32 s62, s62, 4096
    v_mfma_f32_16x16x32_bf16 v[156:159], v[108:111], v[8:11], v[156:159]
    s_buffer_load_dword s4, s[40:43], s66 offset:0 glc
    s_buffer_load_dword s5, s[40:43], s66 offset:1024 glc
    v_mfma_f32_16x16x32_bf16 v[160:163], v[112:115], v[8:11], v[160:163]
    s_buffer_load_dword s6, s[40:43], s66 offset:2048 glc
    s_buffer_load_dword s7, s[40:43], s66 offset:3072 glc
    v_mfma_f32_16x16x32_bf16 v[164:167], v[116:119], v[8:11], v[164:167]
    s_buffer_load_dword s8, s[40:43], s66 offset:4096 glc
    s_waitcnt vmcnt(11)
    v_mfma_f32_16x16x32_bf16 v[152:155], v[120:123], v[16:19], v[152:155]
    buffer_load_dwordx4 v[4:7], v1, s[40:43], s62 offen offset:0 sc1
    v_mfma_f32_16x16x32_bf16 v[156:159], v[124:127], v[16:19], v[156:159]
    s_buffer_load_dword s9, s[40:43], s66 offset:5120 glc
    s_buffer_load_dword s10, s[40:43], s66 offset:6144 glc
    v_mfma_f32_16x16x32_bf16 v[160:163], v[128:131], v[16:19], v[160:163]
    s_buffer_load_dword s11, s[40:43], s66 offset:7168 glc
    v_mfma_f32_16x16x32_bf16 v[164:167], v[132:135], v[16:19], v[164:167]
    s_waitcnt vmcnt(11)
    v_mfma_f32_16x16x32_bf16 v[136:139], v[24:27], v[200:203], 0
    buffer_load_dwordx4 v[8:11], v1, s[40:43], s62 offen offset:1024 sc1
    v_mfma_f32_16x16x32_bf16 v[140:143], v[28:31], v[200:203], 0
    ds_write_b128 v252, v[152:155] offset:12288
    v_mfma_f32_16x16x32_bf16 v[144:147], v[32:35], v[200:203], 0
    ds_write_b128 v253, v[156:159] offset:12288
    v_mfma_f32_16x16x32_bf16 v[148:151], v[36:39], v[200:203], 0
    ds_write_b128 v254, v[160:163] offset:12288
    s_waitcnt vmcnt(11)
    v_mfma_f32_16x16x32_bf16 v[136:139], v[40:43], v[204:207], v[136:139]
    buffer_load_dwordx4 v[16:19], v1, s[40:43], s62 offen offset:2048 sc1
    s_add_u32 s62, s62, 69632
    v_mfma_f32_16x16x32_bf16 v[140:143], v[44:47], v[204:207], v[140:143]
    ds_write_b128 v255, v[164:167] offset:12288
    v_mfma_f32_16x16x32_bf16 v[144:147], v[48:51], v[204:207], v[144:147]
    v_mfma_f32_16x16x32_bf16 v[148:151], v[52:55], v[204:207], v[148:151]
    s_waitcnt vmcnt(11)
    v_mfma_f32_16x16x32_bf16 v[136:139], v[56:59], v[208:211], v[136:139]
    buffer_load_dwordx4 v[200:203], v1, s[40:43], s62 offen offset:0 sc1
    v_mfma_f32_16x16x32_bf16 v[140:143], v[60:63], v[208:211], v[140:143]
    s_waitcnt lgkmcnt(0)
    v_mov_b32 v244, 13
    v_mfma_f32_16x16x32_bf16 v[144:147], v[64:67], v[208:211], v[144:147]
    ds_write_b32 v247, v244
    v_mfma_f32_16x16x32_bf16 v[148:151], v[68:71], v[208:211], v[148:151]
    s_waitcnt vmcnt(11)
    v_mfma_f32_16x16x32_bf16 v[136:139], v[72:75], v[212:215], v[136:139]
    buffer_load_dwordx4 v[204:207], v1, s[40:43], s62 offen offset:1024 sc1
    v_mfma_f32_16x16x32_bf16 v[140:143], v[76:79], v[212:215], v[140:143]
    ds_read_b128 v[248:251], v246 offset:16
    v_mfma_f32_16x16x32_bf16 v[144:147], v[80:83], v[212:215], v[144:147]
    v_mfma_f32_16x16x32_bf16 v[148:151], v[84:87], v[212:215], v[148:151]
    s_waitcnt vmcnt(11)
    v_mfma_f32_16x16x32_bf16 v[136:139], v[88:91], v[216:219], v[136:139]
    buffer_load_dwordx4 v[208:211], v1, s[40:43], s62 offen offset:2048 sc1
    v_mfma_f32_16x16x32_bf16 v[140:143], v[92:95], v[216:219], v[140:143]
    v_mfma_f32_16x16x32_bf16 v[144:147], v[96:99], v[216:219], v[144:147]
    v_mfma_f32_16x16x32_bf16 v[148:151], v[100:103], v[216:219], v[148:151]
    s_waitcnt vmcnt(11)
    v_mfma_f32_16x16x32_bf16 v[136:139], v[104:107], v[220:223], v[136:139]
    buffer_load_dwordx4 v[212:215], v1, s[40:43], s62 offen offset:3072 sc1
    s_add_u32 s62, s62, 4096
    v_mfma_f32_16x16x32_bf16 v[140:143], v[108:111], v[220:223], v[140:143]
    s_waitcnt lgkmcnt(0)
    v_min3_u32 v248, v248, v249, v250
    v_mfma_f32_16x16x32_bf16 v[144:147], v[112:115], v[220:223], v[144:147]
    v_min_u32 v248, v248, v251
    v_cmp_gt_u32 vcc, 11, v248
    v_mfma_f32_16x16x32_bf16 v[148:151], v[116:119], v[220:223], v[148:151]
    s_cbranch_vccnz L_d4
L_d4_ok:
    s_waitcnt vmcnt(11)
    v_mfma_f32_16x16x32_bf16 v[136:139], v[120:123], v[224:227], v[136:139]
    buffer_load_dwordx4 v[216:219], v1, s[40:43], s62 offen offset:0 sc1
    v_mfma_f32_16x16x32_bf16 v[140:143], v[124:127], v[224:227], v[140:143]
    s_waitcnt lgkmcnt(0)
    s_xor_b32 s4, s4, s56
    v_mfma_f32_16x16x32_bf16 v[144:147], v[128:131], v[224:227], v[144:147]
    s_xor_b32 s5, s5, s56
    s_xor_b32 s6, s6, s56
    v_mfma_f32_16x16x32_bf16 v[148:151], v[132:135], v[224:227], v[148:151]
    s_xor_b32 s7, s7, s56
    s_waitcnt vmcnt(11)
    v_mfma_f32_16x16x32_bf16 v[152:155], v[24:27], v[228:231], 0
    buffer_load_dwordx4 v[220:223], v1, s[40:43], s62 offen offset:1024 sc1
    v_mfma_f32_16x16x32_bf16 v[156:159], v[28:31], v[228:231], 0
    s_xor_b32 s8, s8, s56
    s_xor_b32 s9, s9, s56
    v_mfma_f32_16x16x32_bf16 v[160:163], v[32:35], v[228:231], 0
    s_xor_b32 s10, s10, s56
    s_xor_b32 s11, s11, s56
    v_mfma_f32_16x16x32_bf16 v[164:167], v[36:39], v[228:231], 0
    s_or_b64 s[4:5], s[4:5], s[6:7]
    s_waitcnt vmcnt(11)
    v_mfma_f32_16x16x32_bf16 v[152:155], v[40:43], v[232:235], v[152:155]
    buffer_load_dwordx4 v[224:227], v1, s[40:43], s62 offen offset:2048 sc1
    s_add_u32 s62, s62, 69632
    v_mfma_f32_16x16x32_bf16 v[156:159], v[44:47], v[232:235], v[156:159]
    s_or_b64 s[6:7], s[8:9], s[10:11]
    s_or_b64 s[4:5], s[4:5], s[6:7]
    s_cbranch_scc1 L_po
L_po_bk:
    v_mfma_f32_16x16x32_bf16 v[160:163], v[48:51], v[232:235], v[160:163]
    ds_write_b128 v252, v[136:139] offset:0
    v_mfma_f32_16x16x32_bf16 v[164:167], v[52:55], v[232:235], v[164:167]
    ds_write_b128 v253, v[140:143] offset:0
    s_waitcnt vmcnt(11)
    v_mfma_f32_16x16x32_bf16 v[152:155], v[56:59], v[236:239], v[152:155]
    buffer_load_dwordx4 v[228:231], v1, s[40:43], s62 offen offset:0 sc1
    v_mfma_f32_16x16x32_bf16 v[156:159], v[60:63], v[236:239], v[156:159]
    ds_write_b128 v254, v[144:147] offset:0
    v_mfma_f32_16x16x32_bf16 v[160:163], v[64:67], v[236:239], v[160:163]
    ds_write_b128 v255, v[148:151] offset:0
    v_mfma_f32_16x16x32_bf16 v[164:167], v[68:71], v[236:239], v[164:167]
    s_waitcnt lgkmcnt(0)
    s_waitcnt vmcnt(11)
    v_mfma_f32_16x16x32_bf16 v[152:155], v[72:75], v[240:243], v[152:155]
    buffer_load_dwordx4 v[232:235], v1, s[40:43], s62 offen offset:1024 sc1
    v_mfma_f32_16x16x32_bf16 v[156:159], v[76:79], v[240:243], v[156:159]
    ds_read_b64_tr_b16 v[12:13], v20 offset:0
    ds_read_b64_tr_b16 v[14:15], v20 offset:2048
    v_mfma_f32_16x16x32_bf16 v[160:163], v[80:83], v[240:243], v[160:163]
    ds_read_b64_tr_b16 v[168:169], v21 offset:0
    ds_read_b64_tr_b16 v[170:171], v21 offset:2048
    v_mfma_f32_16x16x32_bf16 v[164:167], v[84:87], v[240:243], v[164:167]
    ds_read_b64_tr_b16 v[172:173], v22 offset:0
    s_waitcnt vmcnt(11)
    v_mfma_f32_16x16x32_bf16 v[152:155], v[88:91], v[4:7], v[152:155]
    buffer_load_dwordx4 v[236:239], v1, s[40:43], s62 offen offset:2048 sc1
    v_mfma_f32_16x16x32_bf16 v[156:159], v[92:95], v[4:7], v[156:159]
    ds_read_b64_tr_b16 v[174:175], v22 offset:2048
    ds_read_b64_tr_b16 v[176:177], v23 offset:0
    v_mfma_f32_16x16x32_bf16 v[160:163], v[96:99], v[4:7], v[160:163]
    ds_read_b64_tr_b16 v[178:179], v23 offset:2048
    ds_read_b64_tr_b16 v[180:181], v22 offset:3584
    v_mfma_f32_16x16x32_bf16 v[164:167], v[100:103], v[4:7], v[164:167]
    ds_read_b64_tr_b16 v[182:183], v22 offset:5632
    s_waitcnt vmcnt(11)
    v_mfma_f32_16x16x32_bf16 v[152:155], v[104:107], v[8:11], v[152:155]
    buffer_load_dwordx4 v[240:243], v1, s[40:43], s62 offen offset:3072 sc1
    s_add_u32 s62, s62, 4096
    v_mfma_f32_16x16x32_bf16 v[156:159], v[108:111], v[8:11], v[156:159]
    ds_read_b64_tr_b16 v[184:185], v23 offset:3584
    ds_read_b64_tr_b16 v[186:187], v23 offset:5632
    v_mfma_f32_16x16x32_bf16 v[160:163], v[112:115], v[8:11], v[160:163]
    ds_read_b64_tr_b16 v[188:189], v20 offset:3584
    ds_read_b64_tr_b16 v[190:191], v20 offset:5632
    v_mfma_f32_16x16x32_bf16 v[164:167], v[116:119], v[8:11], v[164:167]
    ds_read_b64_tr_b16 v[192:193], v21 offset:3584
    s_waitcnt vmcnt(11)
    v_mfma_f32_16x16x32_bf16 v[152:155], v[120:123], v[16:19], v[152:155]
    buffer_load_dwordx4 v[4:7], v1, s[40:43], s62 offen offset:0 sc1
    v_mfma_f32_16x16x32_bf16 v[156:159], v[124:127], v[16:19], v[156:159]
    ds_read_b64_tr_b16 v[194:195], v21 offset:5632
    ds_read_b64_tr_b16 v[196:197], v20 offset:7168
    v_mfma_f32_16x16x32_bf16 v[160:163], v[128:131], v[16:19], v[160:163]
    ds_read_b64_tr_b16 v[198:199], v20 offset:9216
    v_mfma_f32_16x16x32_bf16 v[164:167], v[132:135], v[16:19], v[164:167]
    s_waitcnt vmcnt(11)
    v_mfma_f32_16x16x32_bf16 v[136:139], v[24:27], v[200:203], 0
    buffer_load_dwordx4 v[8:11], v1, s[40:43], s62 offen offset:1024 sc1
    v_mfma_f32_16x16x32_bf16 v[140:143], v[28:31], v[200:203], 0
    ds_write_b128 v252, v[152:155] offset:4096
    v_mfma_f32_16x16x32_bf16 v[144:147], v[32:35], v[200:203], 0
    ds_write_b128 v253, v[156:159] offset:4096
    v_mfma_f32_16x16x32_bf16 v[148:151], v[36:39], v[200:203], 0
    ds_write_b128 v254, v[160:163] offset:4096
    s_waitcnt vmcnt(11)
    v_mfma_f32_16x16x32_bf16 v[136:139], v[40:43], v[204:207], v[136:139]
    buffer_load_dwordx4 v[16:19], v1, s[40:43], s62 offen offset:2048 sc1
    s_mov_b32 s62, s65
    v_mfma_f32_16x16x32_bf16 v[140:143], v[44:47], v[204:207], v[140:143]
    ds_write_b128 v255, v[164:167] offset:4096
    v_mfma_f32_16x16x32_bf16 v[144:147], v[48:51], v[204:207], v[144:147]
    v_mfma_f32_16x16x32_bf16 v[148:151], v[52:55], v[204:207], v[148:151]
    s_waitcnt vmcnt(11)
    v_mfma_f32_16x16x32_bf16 v[136:139], v[56:59], v[208:211], v[136:139]
    buffer_load_dwordx4 v[200:203], v1, s[40:43], s62 offen offset:0 sc1
    v_mfma_f32_16x16x32_bf16 v[140:143], v[60:63], v[208:211], v[140:143]
    s_waitcnt lgkmcnt(0)
    v_mov_b32 v244, 15
    v_mfma_f32_16x16x32_bf16 v[144:147], v[64:67], v[208:211], v[144:147]
    ds_write_b32 v247, v244
    v_mfma_f32_16x16x32_bf16 v[148:151], v[68:71], v[208:211], v[148:151]
    s_waitcnt vmcnt(11)
    v_mfma_f32_16x16x32_bf16 v[136:139], v[72:75], v[212:215], v[136:139]
    buffer_load_dwordx4 v[204:207], v1, s[40:43], s62 offen offset:1024 sc1
    v_mfma_f32_16x16x32_bf16 v[140:143], v[76:79], v[212:215], v[140:143]
    ds_read_b128 v[248:251], v246 offset:16
    v_mfma_f32_16x16x32_bf16 v[144:147], v[80:83], v[212:215], v[144:147]
    v_mfma_f32_16x16x32_bf16 v[148:151], v[84:87], v[212:215], v[148:151]
    s_waitcnt vmcnt(11)
    v_mfma_f32_16x16x32_bf16 v[136:139], v[88:91], v[216:219], v[136:139]
    buffer_load_dwordx4 v[208:211], v1, s[40:43], s62 offen offset:2048 sc1
    v_mfma_f32_16x16x32_bf16 v[140:143], v[92:95], v[216:219], v[140:143]
    v_mfma_f32_16x16x32_bf16 v[144:147], v[96:99], v[216:219], v[144:147]
    v_mfma_f32_16x16x32_bf16 v[148:151], v[100:103], v[216:219], v[148:151]
    s_waitcnt vmcnt(11)
    v_mfma_f32_16x16x32_bf16 v[136:139], v[104:107], v[220:223], v[136:139]
    buffer_load_dwordx4 v[212:215], v1, s[40:43], s62 offen offset:3072 sc1
    s_add_u32 s62, s62, 4096
    v_mfma_f32_16x16x32_bf16 v[140:143], v[108:111], v[220:223], v[140:143]
    s_waitcnt lgkmcnt(0)
    v_min3_u32 v248, v248, v249, v250
    v_mfma_f32_16x16x32_bf16 v[144:147], v[112:115], v[220:223], v[144:147]
    v_min_u32 v248, v248, v251
    v_cmp_gt_u32 vcc, 12, v248
    v_mfma_f32_16x16x32_bf16 v[148:151], v[116:119], v[220:223], v[148:151]
    s_cbranch_vccnz L_d6
L_d6_ok:
    s_waitcnt vmcnt(11)
    v_mfma_f32_16x16x32_bf16 v[136:139], v[120:123], v[224:227], v[136:139]
    buffer_load_dwordx4 v[216:219], v1, s[40:43], s62 offen offset:0 sc1
    v_mfma_f32_16x16x32_bf16 v[140:143], v[124:127], v[224:227], v[140:143]
    v_mfma_f32_16x16x32_bf16 v[144:147], v[128:131], v[224:227], v[144:147]
    v_mfma_f32_16x16x32_bf16 v[148:151], v[132:135], v[224:227], v[148:151]
    s_waitcnt vmcnt(11)
    v_mfma_f32_16x16x32_bf16 v[152:155], v[24:27], v[228:231], 0
    buffer_load_dwordx4 v[220:223], v1, s[40:43], s62 offen offset:1024 sc1
    v_mfma_f32_16x16x32_bf16 v[156:159], v[28:31], v[228:231], 0
    ds_write_b128 v252, v[136:139] offset:8192
    v_mfma_f32_16x16x32_bf16 v[160:163], v[32:35], v[228:231], 0
    ds_write_b128 v253, v[140:143] offset:8192
    v_mfma_f32_16x16x32_bf16 v[164:167], v[36:39], v[228:231], 0
    ds_write_b128 v254, v[144:147] offset:8192
    s_waitcnt vmcnt(11)
    v_mfma_f32_16x16x32_bf16 v[152:155], v[40:43], v[232:235], v[152:155]
    buffer_load_dwordx4 v[224:227], v1, s[40:43], s62 offen offset:2048 sc1
    v_mfma_f32_16x16x32_bf16 v[156:159], v[44:47], v[232:235], v[156:159]
    ds_write_b128 v255, v[148:151] offset:8192
    v_mfma_f32_16x16x32_bf16 v[160:163], v[48:51], v[232:235], v[160:163]
    ds_read_b64_tr_b16 v[24:25], v21 offset:7168
    ds_read_b64_tr_b16 v[26:27], v21 offset:9216
    v_mfma_f32_16x16x32_bf16 v[164:167], v[52:55], v[232:235], v[164:167]
    ds_read_b64_tr_b16 v[28:29], v22 offset:7168
    s_waitcnt vmcnt(11)
    v_mfma_f32_16x16x32_bf16 v[152:155], v[56:59], v[236:239], v[152:155]
    buffer_load_dwordx4 v[228:231], v1, s[40:43], s62 offen offset:3072 sc1
    s_add_u32 s62, s62, 4096
    v_mfma_f32_16x16x32_bf16 v[156:159], v[60:63], v[236:239], v[156:159]
    s_waitcnt lgkmcnt(3)
    ds_read_b64_tr_b16 v[30:31], v22 offset:9216
    v_mfma_f32_16x16x32_bf16 v[160:163], v[64:67], v[236:239], v[160:163]
    ds_read_b64_tr_b16 v[32:33], v23 offset:7168
    ds_read_b64_tr_b16 v[34:35], v23 offset:9216
    v_mfma_f32_16x16x32_bf16 v[164:167], v[68:71], v[236:239], v[164:167]
    ds_read_b64_tr_b16 v[36:37], v22 offset:10752
    s_waitcnt vmcnt(11)
    v_mfma_f32_16x16x32_bf16 v[152:155], v[72:75], v[240:243], v[152:155]
    buffer_load_dwordx4 v[232:235], v1, s[40:43], s62 offen offset:0 sc1
    v_mfma_f32_16x16x32_bf16 v[156:159], v[76:79], v[240:243], v[156:159]
    ds_read_b64_tr_b16 v[38:39], v22 offset:12800
    ds_read_b64_tr_b16 v[40:41], v23 offset:10752
    v_mfma_f32_16x16x32_bf16 v[160:163], v[80:83], v[240:243], v[160:163]
    ds_read_b64_tr_b16 v[42:43], v23 offset:12800
    ds_read_b64_tr_b16 v[44:45], v20 offset:10752
    v_mfma_f32_16x16x32_bf16 v[164:167], v[84:87], v[240:243], v[164:167]
    ds_read_b64_tr_b16 v[46:47], v20 offset:12800
    s_waitcnt vmcnt(11)
    v_mfma_f32_16x16x32_bf16 v[152:155], v[88:91], v[4:7], v[152:155]
    buffer_load_dwordx4 v[236:239], v1, s[40:43], s62 offen offset:1024 sc1
    v_mfma_f32_16x16x32_bf16 v[156:159], v[92:95], v[4:7], v[156:159]
    ds_read_b64_tr_b16 v[48:49], v21 offset:10752
    ds_read_b64_tr_b16 v[50:51], v21 offset:12800
    v_mfma_f32_16x16x32_bf16 v[160:163], v[96:99], v[4:7], v[160:163]
    ds_read_b64_tr_b16 v[52:53], v20 offset:14336
    ds_read_b64_tr_b16 v[54:55], v20 offset:16384
    v_mfma_f32_16x16x32_bf16 v[164:167], v[100:103], v[4:7], v[164:167]
    ds_read_b64_tr_b16 v[56:57], v21 offset:14336
    s_waitcnt vmcnt(11)
    v_mfma_f32_16x16x32_bf16 v[152:155], v[104:107], v[8:11], v[152:155]
    buffer_load_dwordx4 v[240:243], v1, s[40:43], s62 offen offset:2048 sc1
    v_mfma_f32_16x16x32_bf16 v[156:159], v[108:111], v[8:11], v[156:159]
    ds_read_b64_tr_b16 v[58:59], v21 offset:16384
    ds_read_b64_tr_b16 v[60:61], v22 offset:14336
    v_mfma_f32_16x16x32_bf16 v[160:163], v[112:115], v[8:11], v[160:163]
    ds_read_b64_tr_b16 v[62:63], v22 offset:16384
    ds_read_b64_tr_b16 v[64:65], v23 offset:14336
    v_mfma_f32_16x16x32_bf16 v[164:167], v[116:119], v[8:11], v[164:167]
    ds_read_b64_tr_b16 v[66:67], v23 offset:16384
    s_waitcnt vmcnt(11)
    v_mfma_f32_16x16x32_bf16 v[152:155], v[120:123], v[16:19], v[152:155]
    buffer_load_dwordx4 v[4:7], v1, s[40:43], s62 offen offset:3072 sc1
    s_add_u32 s62, s62, 4096
    v_mfma_f32_16x16x32_bf16 v[156:159], v[124:127], v[16:19], v[156:159]
    ds_read_b64_tr_b16 v[68:69], v22 offset:17920
    ds_read_b64_tr_b16 v[70:71], v22 offset:19968
    v_mfma_f32_16x16x32_bf16 v[160:163], v[128:131], v[16:19], v[160:163]
    ds_read_b64_tr_b16 v[72:73], v23 offset:17920
    ds_read_b64_tr_b16 v[74:75], v23 offset:19968
    v_mfma_f32_16x16x32_bf16 v[164:167], v[132:135], v[16:19], v[164:167]
    ds_read_b64_tr_b16 v[76:77], v20 offset:17920
    s_waitcnt vmcnt(11)
    v_mfma_f32_16x16x32_bf16 v[136:139], v[12:15], v[200:203], 0
    buffer_load_dwordx4 v[8:11], v1, s[40:43], s62 offen offset:0 sc1
    ds_write_b128 v252, v[152:155] offset:12288
    v_mfma_f32_16x16x32_bf16 v[140:143], v[168:171], v[200:203], 0
    ds_write_b128 v253, v[156:159] offset:12288
    v_mfma_f32_16x16x32_bf16 v[144:147], v[172:175], v[200:203], 0
    ds_write_b128 v254, v[160:163] offset:12288
    v_mfma_f32_16x16x32_bf16 v[148:151], v[176:179], v[200:203], 0
    ds_write_b128 v255, v[164:167] offset:12288
    s_waitcnt vmcnt(11)
    v_mfma_f32_16x16x32_bf16 v[136:139], v[180:183], v[204:207], v[136:139]
    buffer_load_dwordx4 v[16:19], v1, s[40:43], s62 offen offset:1024 sc1
    v_mfma_f32_16x16x32_bf16 v[140:143], v[184:187], v[204:207], v[140:143]
    ds_read_b64_tr_b16 v[78:79], v20 offset:19968
    v_mfma_f32_16x16x32_bf16 v[144:147], v[188:191], v[204:207], v[144:147]
    ds_read_b64_tr_b16 v[80:81], v21 offset:17920
    ds_read_b64_tr_b16 v[82:83], v21 offset:19968
    v_mfma_f32_16x16x32_bf16 v[148:151], v[192:195], v[204:207], v[148:151]
    ds_read_b64_tr_b16 v[84:85], v20 offset:21504
    s_waitcnt vmcnt(11)
    s_waitcnt lgkmcnt(15)
    v_mfma_f32_16x16x32_bf16 v[136:139], v[196:199], v[208:211], v[136:139]
    buffer_load_dwordx4 v[200:203], v1, s[40:43], s62 offen offset:2048 sc1
    s_waitcnt lgkmcnt(4)
    v_mfma_f32_16x16x32_bf16 v[140:143], v[24:27], v[208:211], v[140:143]
    v_mov_b32 v244, 17
    v_mfma_f32_16x16x32_bf16 v[144:147], v[28:31], v[208:211], v[144:147]
    ds_write_b32 v247, v244
    ds_read_b64_tr_b16 v[86:87], v20 offset:23552
    v_mfma_f32_16x16x32_bf16 v[148:151], v[32:35], v[208:211], v[148:151]
    ds_read_b64_tr_b16 v[88:89], v21 offset:21504
    s_waitcnt vmcnt(11)
    v_mfma_f32_16x16x32_bf16 v[136:139], v[36:39], v[212:215], v[136:139]
    buffer_load_dwordx4 v[204:207], v1, s[40:43], s62 offen offset:3072 sc1
    s_add_u32 s62, s62, 4096
    ds_read_b64_tr_b16 v[90:91], v21 offset:23552
    v_mfma_f32_16x16x32_bf16 v[140:143], v[40:43], v[212:215], v[140:143]
    ds_read_b64_tr_b16 v[92:93], v22 offset:21504
    ds_read_b64_tr_b16 v[94:95], v22 offset:23552
    v_mfma_f32_16x16x32_bf16 v[144:147], v[44:47], v[212:215], v[144:147]
    ds_read_b64_tr_b16 v[96:97], v23 offset:21504
    ds_read_b64_tr_b16 v[98:99], v23 offset:23552
    v_mfma_f32_16x16x32_bf16 v[148:151], v[48:51], v[212:215], v[148:151]
    ds_read_b64_tr_b16 v[100:101], v22 offset:25088
    ds_read_b64_tr_b16 v[102:103], v22 offset:27136
    s_waitcnt vmcnt(11)
    v_mfma_f32_16x16x32_bf16 v[136:139], v[52:55], v[216:219], v[136:139]
    ds_read_b64_tr_b16 v[104:105], v23 offset:25088
    ds_read_b64_tr_b16 v[106:107], v23 offset:27136
    v_mfma_f32_16x16x32_bf16 v[140:143], v[56:59], v[216:219], v[140:143]
    ds_read_b64_tr_b16 v[108:109], v20 offset:25088
    ds_read_b64_tr_b16 v[110:111], v20 offset:27136
    v_mfma_f32_16x16x32_bf16 v[144:147], v[60:63], v[216:219], v[144:147]
    ds_read_b64_tr_b16 v[112:113], v21 offset:25088
    ds_read_b64_tr_b16 v[114:115], v21 offset:27136
    v_mfma_f32_16x16x32_bf16 v[148:151], v[64:67], v[216:219], v[148:151]
    ds_read_b64_tr_b16 v[116:117], v20 offset:28672
    ds_read_b64_tr_b16 v[118:119], v20 offset:30720
    s_waitcnt vmcnt(10)
    v_mfma_f32_16x16x32_bf16 v[136:139], v[68:71], v[220:223], v[136:139]
    ds_read_b64_tr_b16 v[120:121], v21 offset:28672
    ds_read_b64_tr_b16 v[122:123], v21 offset:30720
    v_mfma_f32_16x16x32_bf16 v[140:143], v[72:75], v[220:223], v[140:143]
    ds_read_b64_tr_b16 v[124:125], v22 offset:28672
    ds_read_b64_tr_b16 v[126:127], v22 offset:30720
    s_waitcnt lgkmcnt(15)
    v_mfma_f32_16x16x32_bf16 v[144:147], v[76:79], v[220:223], v[144:147]
    ds_read_b64_tr_b16 v[128:129], v23 offset:28672
    ds_read_b64_tr_b16 v[130:131], v23 offset:30720
    v_mfma_f32_16x16x32_bf16 v[148:151], v[80:83], v[220:223], v[148:151]
    ds_read_b64_tr_b16 v[12:13], v22 offset:32256
    ds_read_b64_tr_b16 v[14:15], v22 offset:34304
    s_waitcnt vmcnt(9)
    v_mfma_f32_16x16x32_bf16 v[136:139], v[84:87], v[224:227], v[136:139]
    ds_read_b64_tr_b16 v[168:169], v23 offset:32256
    ds_read_b64_tr_b16 v[170:171], v23 offset:34304
    v_mfma_f32_16x16x32_bf16 v[140:143], v[88:91], v[224:227], v[140:143]
    ds_read_b64_tr_b16 v[172:173], v20 offset:32256
    ds_read_b64_tr_b16 v[174:175], v20 offset:34304
    s_waitcnt lgkmcnt(15)
    v_mfma_f32_16x16x32_bf16 v[144:147], v[92:95], v[224:227], v[144:147]
    ds_read_b64_tr_b16 v[176:177], v21 offset:32256
    ds_read_b64_tr_b16 v[178:179], v21 offset:34304
    v_mfma_f32_16x16x32_bf16 v[148:151], v[96:99], v[224:227], v[148:151]
    ds_read_b64_tr_b16 v[180:181], v20 offset:35840
    ds_read_b64_tr_b16 v[182:183], v20 offset:37888
    s_waitcnt vmcnt(8)
    v_mfma_f32_16x16x32_bf16 v[136:139], v[100:103], v[228:231], v[136:139]
    ds_read_b64_tr_b16 v[184:185], v21 offset:35840
    ds_read_b64_tr_b16 v[186:187], v21 offset:37888
    v_mfma_f32_16x16x32_bf16 v[140:143], v[104:107], v[228:231], v[140:143]
    ds_read_b64_tr_b16 v[188:189], v22 offset:35840
    ds_read_b64_tr_b16 v[190:191], v22 offset:37888
    s_waitcnt lgkmcnt(15)
    v_mfma_f32_16x16x32_bf16 v[144:147], v[108:111], v[228:231], v[144:147]
    ds_read_b64_tr_b16 v[192:193], v23 offset:35840
    ds_read_b64_tr_b16 v[194:195], v23 offset:37888
    v_mfma_f32_16x16x32_bf16 v[148:151], v[112:115], v[228:231], v[148:151]
    ds_read_b64_tr_b16 v[196:197], v22 offset:39424
    ds_read_b64_tr_b16 v[198:199], v22 offset:41472
    s_waitcnt vmcnt(7)
    v_mfma_f32_16x16x32_bf16 v[136:139], v[116:119], v[232:235], v[136:139]
    ds_read_b64_tr_b16 v[24:25], v23 offset:39424
    ds_read_b64_tr_b16 v[26:27], v23 offset:41472
    v_mfma_f32_16x16x32_bf16 v[140:143], v[120:123], v[232:235], v[140:143]
    ds_read_b64_tr_b16 v[28:29], v20 offset:39424
    ds_read_b64_tr_b16 v[30:31], v20 offset:41472
    s_waitcnt lgkmcnt(15)
    v_mfma_f32_16x16x32_bf16 v[144:147], v[124:127], v[232:235], v[144:147]
    ds_read_b64_tr_b16 v[32:33], v21 offset:39424
    ds_read_b64_tr_b16 v[34:35], v21 offset:41472
    v_mfma_f32_16x16x32_bf16 v[148:151], v[128:131], v[232:235], v[148:151]
    ds_read_b64_tr_b16 v[36:37], v20 offset:43008
    ds_read_b64_tr_b16 v[38:39], v20 offset:45056
    s_waitcnt vmcnt(6)
    v_mfma_f32_16x16x32_bf16 v[136:139], v[12:15], v[236:239], v[136:139]
    ds_read_b64_tr_b16 v[40:41], v21 offset:43008
    ds_read_b64_tr_b16 v[42:43], v21 offset:45056
    v_mfma_f32_16x16x32_bf16 v[140:143], v[168:171], v[236:239], v[140:143]
    ds_read_b64_tr_b16 v[44:45], v22 offset:43008
    ds_read_b64_tr_b16 v[46:47], v22 offset:45056
    s_waitcnt lgkmcnt(15)
    v_mfma_f32_16x16x32_bf16 v[144:147], v[172:175], v[236:239], v[144:147]
    ds_read_b64_tr_b16 v[212:213], v23 offset:43008
    ds_read_b64_tr_b16 v[214:215], v23 offset:45056
    v_mfma_f32_16x16x32_bf16 v[148:151], v[176:179], v[236:239], v[148:151]
    ds_read_b64_tr_b16 v[48:49], v22 offset:46592
    ds_read_b64_tr_b16 v[50:51], v22 offset:48640
    s_waitcnt vmcnt(5)
    v_mfma_f32_16x16x32_bf16 v[136:139], v[180:183], v[240:243], v[136:139]
    ds_read_b64_tr_b16 v[52:53], v23 offset:46592
    ds_read_b64_tr_b16 v[54:55], v23 offset:48640
    v_mfma_f32_16x16x32_bf16 v[140:143], v[184:187], v[240:243], v[140:143]
    ds_read_b64_tr_b16 v[56:57], v20 offset:46592
    ds_read_b64_tr_b16 v[58:59], v20 offset:48640
    s_waitcnt lgkmcnt(15)
    v_mfma_f32_16x16x32_bf16 v[144:147], v[188:191], v[240:243], v[144:147]
    ds_read_b64_tr_b16 v[60:61], v21 offset:46592
    ds_read_b64_tr_b16 v[62:63], v21 offset:48640
    v_mfma_f32_16x16x32_bf16 v[148:151], v[192:195], v[240:243], v[148:151]
    ds_read_b64_tr_b16 v[216:217], v20 offset:50176
    ds_read_b64_tr_b16 v[218:219], v20 offset:52224
    s_waitcnt vmcnt(4)
    v_mfma_f32_16x16x32_bf16 v[136:139], v[196:199], v[4:7], v[136:139]
    ds_read_b64_tr_b16 v[64:65], v21 offset:50176
    ds_read_b64_tr_b16 v[66:67], v21 offset:52224
    v_mfma_f32_16x16x32_bf16 v[140:143], v[24:27], v[4:7], v[140:143]
    ds_read_b64_tr_b16 v[68:69], v22 offset:50176
    ds_read_b64_tr_b16 v[70:71], v22 offset:52224
    s_waitcnt lgkmcnt(15)
    v_mfma_f32_16x16x32_bf16 v[144:147], v[28:31], v[4:7], v[144:147]
    ds_read_b64_tr_b16 v[72:73], v23 offset:50176
    ds_read_b64_tr_b16 v[74:75], v23 offset:52224
    v_mfma_f32_16x16x32_bf16 v[148:151], v[32:35], v[4:7], v[148:151]
    ds_read_b64_tr_b16 v[76:77], v22 offset:53760
    ds_read_b64_tr_b16 v[78:79], v22 offset:55808
    s_waitcnt vmcnt(3)
    v_mfma_f32_16x16x32_bf16 v[136:139], v[36:39], v[8:11], v[136:139]
    ds_read_b64_tr_b16 v[220:221], v23 offset:53760
    ds_read_b64_tr_b16 v[222:223], v23 offset:55808
    v_mfma_f32_16x16x32_bf16 v[140:143], v[40:43], v[8:11], v[140:143]
    ds_read_b64_tr_b16 v[80:81], v20 offset:53760
    ds_read_b64_tr_b16 v[82:83], v20 offset:55808
    s_waitcnt lgkmcnt(15)
    v_mfma_f32_16x16x32_bf16 v[144:147], v[44:47], v[8:11], v[144:147]
    ds_read_b64_tr_b16 v[84:85], v21 offset:53760
    ds_read_b64_tr_b16 v[86:87], v21 offset:55808
    v_mfma_f32_16x16x32_bf16 v[148:151], v[212:215], v[8:11], v[148:151]
    s_waitcnt vmcnt(2)
    v_mfma_f32_16x16x32_bf16 v[136:139], v[48:51], v[16:19], v[136:139]
    v_xor_b32 v252, 0, v245
    v_xor_b32 v253, 32, v245
    v_mfma_f32_16x16x32_bf16 v[140:143], v[52:55], v[16:19], v[140:143]
    v_xor_b32 v254, 64, v245
    s_waitcnt lgkmcnt(15)
    v_mfma_f32_16x16x32_bf16 v[144:147], v[56:59], v[16:19], v[144:147]
    v_xor_b32 v255, 96, v245
    v_mfma_f32_16x16x32_bf16 v[148:151], v[60:63], v[16:19], v[148:151]
    s_waitcnt vmcnt(1)
    s_waitcnt lgkmcnt(12)
    v_mfma_f32_16x16x32_bf16 v[136:139], v[216:219], v[200:203], v[136:139]
    v_mfma_f32_16x16x32_bf16 v[140:143], v[64:67], v[200:203], v[140:143]
    s_waitcnt lgkmcnt(8)
    v_mfma_f32_16x16x32_bf16 v[144:147], v[68:71], v[200:203], v[144:147]
    v_mfma_f32_16x16x32_bf16 v[148:151], v[72:75], v[200:203], v[148:151]
    s_waitcnt vmcnt(0)
    s_waitcnt lgkmcnt(4)
    v_mfma_f32_16x16x32_bf16 v[136:139], v[76:79], v[204:207], v[136:139]
    v_mfma_f32_16x16x32_bf16 v[140:143], v[220:223], v[204:207], v[140:143]
    s_waitcnt lgkmcnt(0)
    v_mfma_f32_16x16x32_bf16 v[144:147], v[80:83], v[204:207], v[144:147]
    v_mfma_f32_16x16x32_bf16 v[148:151], v[84:87], v[204:207], v[148:151]
    s_setprio 2
    s_nop 2
    v_cvt_pk_bf16_f32 v136, v136, v137
    v_cvt_pk_bf16_f32 v137, v138, v139
    ds_write_b64 v252, v[136:137]
    v_cvt_pk_bf16_f32 v138, v140, v141
    v_cvt_pk_bf16_f32 v139, v142, v143
    ds_write_b64 v253, v[138:139]
    v_cvt_pk_bf16_f32 v140, v144, v145
    v_cvt_pk_bf16_f32 v141, v146, v147
    ds_write_b64 v254, v[140:141]
    v_cvt_pk_bf16_f32 v142, v148, v149
    v_cvt_pk_bf16_f32 v143, v150, v151
    ds_write_b64 v255, v[142:143]
    s_waitcnt lgkmcnt(0)
    s_barrier
    s_branch L_EXIT
L_d0:
    s_add_u32 s3, s3, 1
    s_cmp_gt_u32 s3, 2097152
    s_cbranch_scc1 L_d0_ok
    ds_read_b128 v[248:251], v246 offset:16
    s_waitcnt lgkmcnt(0)
    v_min3_u32 v248, v248, v249, v250
    v_min_u32 v248, v248, v251
    v_cmp_gt_u32 vcc, 9, v248
    s_nop 0
    s_cbranch_vccnz L_d0
    s_branch L_d0_ok
L_d1l:
    s_add_u32 s3, s3, 1
    s_cmp_gt_u32 s3, 2097152
    s_cbranch_scc1 L_d1l_ok
    ds_read_b128 v[12:15], v246 offset:0
    s_waitcnt lgkmcnt(0)
    v_min3_u32 v12, v12, v13, v14
    v_min_u32 v12, v12, v15
    v_cmp_gt_u32 vcc, 8, v12
    s_nop 0
    s_cbranch_vccnz L_d1l
    s_branch L_d1l_ok
L_d4:
    s_add_u32 s3, s3, 1
    s_cmp_gt_u32 s3, 2097152
    s_cbranch_scc1 L_d4_ok
    ds_read_b128 v[248:251], v246 offset:16
    s_waitcnt lgkmcnt(0)
    v_min3_u32 v248, v248, v249, v250
    v_min_u32 v248, v248, v251
    v_cmp_gt_u32 vcc, 11, v248
    s_nop 0
    s_cbranch_vccnz L_d4
    s_branch L_d4_ok
L_po:
    s_buffer_load_dword s4, s[40:43], s66 offset:0 glc
    s_buffer_load_dword s5, s[40:43], s66 offset:1024 glc
    s_buffer_load_dword s6, s[40:43], s66 offset:2048 glc
    s_buffer_load_dword s7, s[40:43], s66 offset:3072 glc
    s_buffer_load_dword s8, s[40:43], s66 offset:4096 glc
    s_buffer_load_dword s9, s[40:43], s66 offset:5120 glc
    s_buffer_load_dword s10, s[40:43], s66 offset:6144 glc
    s_buffer_load_dword s11, s[40:43], s66 offset:7168 glc
L_po_w:
    s_waitcnt lgkmcnt(0)
    s_xor_b32 s4, s4, s56
    s_xor_b32 s5, s5, s56
    s_xor_b32 s6, s6, s56
    s_xor_b32 s7, s7, s56
    s_xor_b32 s8, s8, s56
    s_xor_b32 s9, s9, s56
    s_xor_b32 s10, s10, s56
    s_xor_b32 s11, s11, s56
    s_or_b64 s[4:5], s[4:5], s[6:7]
    s_or_b64 s[8:9], s[8:9], s[10:11]
    s_or_b64 s[4:5], s[4:5], s[8:9]
    s_cbranch_scc0 L_po_ok
    s_add_u32 s3, s3, 1
    s_cmp_gt_u32 s3, 2097152
    s_cbranch_scc1 L_po_ok
    s_sleep 1
    s_branch L_po
L_po_ok:
    s_branch L_po_bk
L_d6:
    s_add_u32 s3, s3, 1
    s_cmp_gt_u32 s3, 2097152
    s_cbranch_scc1 L_d6_ok
    ds_read_b128 v[248:251], v246 offset:16
    s_waitcnt lgkmcnt(0)
    v_min3_u32 v248, v248, v249, v250
    v_min_u32 v248, v248, v251
    v_cmp_gt_u32 vcc, 12, v248
    s_nop 0
    s_cbranch_vccnz L_d6
    s_branch L_d6_ok
L_IDLE:
    s_branch L_EXIT
    .p2align 12
L_C:
    s_setprio 1
    v_and_b32 v16, 31, v0
    v_lshrrev_b32 v17, 5, v0
    v_mul_u32_u24 v18, 896, v17
    v_lshl_add_u32 v18, v16, 4, v18
    v_cmp_gt_u32 vcc, 28, v16
    v_mov_b32 v19, 0x10000000
    s_nop 0
    v_cndmask_b32 v18, v19, v18, vcc
    v_cndmask_b32 v19, 0, 1.0, vcc
    s_lshl_b32 s58, s49, 7
    s_lshl_b32 s59, s52, 3
    s_add_u32 s58, s58, s59
    s_lshl_b32 s59, s57, 1
    s_add_u32 s61, s58, s59
    s_mul_i32 s60, s61, 896
    s_waitcnt lgkmcnt(0)
    s_mov_b32 s24, s4
    s_mov_b32 s25, s5
    s_mov_b32 s26, 0x1c0000
    s_mov_b32 s27, 0x20000
    buffer_load_dwordx4 v[20:23], v18, s[24:27], s60 offen offset:0
    buffer_load_dwordx4 v[24:27], v18, s[24:27], s60 offen offset:448
    s_lshl_b32 s58, s61, 4
    s_and_b32 s58, s58, 0xffffff80
    s_add_u32 s58, s58, 16384
    s_load_dword s10, s[20:21], s58
    s_load_dword s11, s[20:21], s58 offset:64
    s_load_dword s56, s[20:21], 0
    v_mov_b32 v230, 163584
    v_lshl_add_u32 v231, s57, 2, v230
    v_add_u32 v231, 16, v231
    v_mov_b32 v12, 0
    v_lshlrev_b32 v13, 2, v0
    v_add_u32 v13, 163584, v13
    ds_write_b32 v13, v12
    v_lshlrev_b32 v223, 4, v0
    v_and_b32 v11, 15, v0
    v_lshrrev_b32 v10, 4, v0
    v_lshrrev_b32 v13, 1, v11
    v_xor_b32 v13, v13, v10
    v_lshlrev_b32 v13, 4, v13
    v_lshl_add_u32 v13, v11, 7, v13
    s_lshl_b32 s58, s57, 12
    v_add_u32 v180, s58, v13
    v_xor_b32 v181, 64, v180
    v_add_u32 v182, 135168, v13
    v_xor_b32 v183, 64, v182
    v_and_b32 v12, 1, v10
    v_mul_u32_u24 v12, 1792, v12
    v_lshl_add_u32 v12, v11, 3, v12
    s_mul_i32 s58, s51, 77824
    s_add_u32 s58, s58, 8448
    v_lshrrev_b32 v14, 1, v10
    v_mul_lo_u32 v14, s58, v14
    v_sub_u32 v12, v12, v14
    v_add_u32 v224, 160000, v12
    v_lshlrev_b32 v12, 4, v11
    v_add_u32 v203, 157696, v12
    s_lshl_b32 s58, s57, 9
    v_add_u32 v202, s58, v203
    v_mov_b32 v205, 0
    v_mov_b32 v209, 0
    v_mov_b32 v213, 0
    v_mov_b32 v206, 0
    v_mov_b32 v207, 0
    v_mov_b32 v210, 0
    v_mov_b32 v211, 0
    v_mov_b32 v214, 0
    v_mov_b32 v215, 0
    s_lshl_b32 s62, s49, 2
    s_add_u32 s62, s62, s57
    s_mul_i32 s68, s62, 147456
    s_add_u32 s68, s68, 262144
    s_lshl_b32 s69, s49, 4
    s_add_u32 s69, s69, s52
    s_lshl_b32 s69, s69, 10
    s_lshl_b32 s59, s57, 7
    s_add_u32 s69, s69, s59
    s_add_u32 s69, s69, 9961472
    s_mov_b32 s40, s20
    s_mov_b32 s41, s21
    s_mov_b32 s42, 0xf00000
    s_mov_b32 s43, 0x20000
    s_mov_b32 s44, s16
    s_mov_b32 s45, s17
    s_mov_b32 s46, 0x1c0000
    s_mov_b32 s47, 0x20000
    s_cmp_eq_u32 s51, 1
    s_cbranch_scc1 L_CQ
    v_lshrrev_b32 v12, 4, v0
    v_lshlrev_b32 v12, 3, v12
    v_bfe_u32 v13, v0, 2, 2
    v_add_u32 v12, v12, v13
    v_mul_u32_u24 v12, 448, v12
    v_bfe_u32 v13, v0, 4, 1
    v_lshl_add_u32 v12, v13, 5, v12
    v_and_b32 v13, 3, v0
    v_lshl_add_u32 v190, v13, 3, v12
    v_xor_b32 v191, 32, v190
    v_add_u32 v184, 49152, v190
    v_add_u32 v185, 49152, v191
    s_waitcnt lgkmcnt(0)
    s_mul_i32 s56, s56, 0x9e3779b1
    s_add_u32 s56, s56, 0x7f4a7c15
    s_waitcnt vmcnt(0)
    v_lshlrev_b32 v32, 16, v20
    v_and_b32 v33, 0xffff0000, v20
    v_lshlrev_b32 v34, 16, v21
    v_and_b32 v35, 0xffff0000, v21
    v_lshlrev_b32 v36, 16, v22
    v_and_b32 v37, 0xffff0000, v22
    v_lshlrev_b32 v38, 16, v23
    v_and_b32 v39, 0xffff0000, v23
    v_lshlrev_b32 v40, 16, v24
    v_and_b32 v41, 0xffff0000, v24
    v_lshlrev_b32 v42, 16, v25
    v_and_b32 v43, 0xffff0000, v25
    v_lshlrev_b32 v44, 16, v26
    v_and_b32 v45, 0xffff0000, v26
    v_lshlrev_b32 v46, 16, v27
    v_and_b32 v47, 0xffff0000, v27
    v_add_f32 v28, v32, v33
    v_add_f32 v29, v34, v35
    v_add_f32 v28, v28, v36
    v_add_f32 v29, v29, v37
    v_add_f32 v28, v28, v38
    v_add_f32 v29, v29, v39
    v_add_f32 v28, v28, v40
    v_add_f32 v29, v29, v41
    v_add_f32 v28, v28, v42
    v_add_f32 v29, v29, v43
    v_add_f32 v28, v28, v44
    v_add_f32 v29, v29, v45
    v_add_f32 v28, v28, v46
    v_add_f32 v29, v29, v47
    v_add_f32 v28, v28, v29
    s_nop 1
    v_add_f32_dpp v28, v28, v28 row_ror:8 row_mask:0xf bank_mask:0xf
    s_nop 1
    v_add_f32_dpp v28, v28, v28 row_ror:4 row_mask:0xf bank_mask:0xf
    s_nop 1
    v_add_f32_dpp v28, v28, v28 row_ror:2 row_mask:0xf bank_mask:0xf
    s_nop 1
    v_add_f32_dpp v28, v28, v28 row_ror:1 row_mask:0xf bank_mask:0xf
    v_mov_b32 v29, v28
    s_nop 1
    v_permlane16_swap_b32 v29, v28
    v_add_f32 v28, v28, v29
    v_mul_f32 v28, 0x3b124925, v28
    v_sub_f32 v32, v32, v28
    v_sub_f32 v33, v33, v28
    v_sub_f32 v34, v34, v28
    v_sub_f32 v35, v35, v28
    v_sub_f32 v36, v36, v28
    v_sub_f32 v37, v37, v28
    v_sub_f32 v38, v38, v28
    v_sub_f32 v39, v39, v28
    v_sub_f32 v40, v40, v28
    v_sub_f32 v41, v41, v28
    v_sub_f32 v42, v42, v28
    v_sub_f32 v43, v43, v28
    v_sub_f32 v44, v44, v28
    v_sub_f32 v45, v45, v28
    v_sub_f32 v46, v46, v28
    v_sub_f32 v47, v47, v28
    v_mul_f32 v30, v32, v32
    v_mul_f32 v31, v33, v33
    v_fmac_f32 v30, v34, v34
    v_fmac_f32 v31, v35, v35
    v_fmac_f32 v30, v36, v36
    v_fmac_f32 v31, v37, v37
    v_fmac_f32 v30, v38, v38
    v_fmac_f32 v31, v39, v39
    v_fmac_f32 v30, v40, v40
    v_fmac_f32 v31, v41, v41
    v_fmac_f32 v30, v42, v42
    v_fmac_f32 v31, v43, v43
    v_fmac_f32 v30, v44, v44
    v_fmac_f32 v31, v45, v45
    v_fmac_f32 v30, v46, v46
    v_fmac_f32 v31, v47, v47
    v_add_f32 v30, v30, v31
    v_mul_f32 v30, v30, v19
    s_nop 1
    v_add_f32_dpp v30, v30, v30 row_ror:8 row_mask:0xf bank_mask:0xf
    s_nop 1
    v_add_f32_dpp v30, v30, v30 row_ror:4 row_mask:0xf bank_mask:0xf
    s_nop 1
    v_add_f32_dpp v30, v30, v30 row_ror:2 row_mask:0xf bank_mask:0xf
    s_nop 1
    v_add_f32_dpp v30, v30, v30 row_ror:1 row_mask:0xf bank_mask:0xf
    v_mov_b32 v29, v30
    s_nop 1
    v_permlane16_swap_b32 v29, v30
    v_add_f32 v30, v30, v29
    v_mul_f32 v30, 0x3b124925, v30
    v_cvt_pk_bf16_f32 v30, 0, v30
    v_add_f32 v30, 0x3727c5ac, v30
    v_cvt_pk_bf16_f32 v30, 0, v30
    v_sqrt_f32 v30, v30
    v_cvt_pk_bf16_f32 v28, -v28, -v28
    v_cvt_pk_bf16_f32 v30, 0, v30
    v_mov_b32 v29, s56
    v_mov_b32 v31, s56
    v_lshlrev_b32 v32, 4, v17
    s_lshl_b32 s61, s61, 4
    s_add_u32 s61, s61, 16384
    s_mov_b32 exec_lo, 1
    s_mov_b32 exec_hi, 1
    buffer_store_dwordx4 v[28:31], v32, s[40:43], s61 offen sc1
    s_mov_b64 exec, -1
    s_setprio 0
    s_mul_i32 s60, s50, 7168
    s_add_u32 s60, s60, s68
    s_add_u32 s61, s60, 73728
    v_mov_b32 v246, s56
    v_lshrrev_b32 v247, 2, v223
    s_barrier
    ds_read_b128 v[144:147], v180 offset:0
    ds_read_b128 v[148:151], v180 offset:2048
    ds_read_b64_tr_b16 v[112:113], v184 offset:0
    ds_read_b64_tr_b16 v[114:115], v184 offset:1792
    ds_read_b64_tr_b16 v[116:117], v185 offset:0
    ds_read_b64_tr_b16 v[118:119], v185 offset:1792
    ds_read_b64_tr_b16 v[120:121], v184 offset:64
    ds_read_b64_tr_b16 v[122:123], v184 offset:1856
    ds_read_b64_tr_b16 v[124:125], v185 offset:64
    ds_read_b64_tr_b16 v[126:127], v185 offset:1856
    ds_read_b64_tr_b16 v[128:129], v184 offset:128
    ds_read_b64_tr_b16 v[130:131], v184 offset:1920
    s_waitcnt lgkmcnt(6)
    v_mfma_f32_16x16x32_bf16 v[0:3], v[112:115], v[144:147], 0
    ds_read_b64_tr_b16 v[132:133], v185 offset:128
    v_mfma_f32_16x16x32_bf16 v[8:11], v[112:115], v[148:151], 0
    ds_read_b64_tr_b16 v[134:135], v185 offset:1920
    v_mfma_f32_16x16x32_bf16 v[4:7], v[116:119], v[144:147], 0
    ds_read_b64_tr_b16 v[136:137], v184 offset:192
    v_mfma_f32_16x16x32_bf16 v[12:15], v[116:119], v[148:151], 0
    ds_read_b64_tr_b16 v[138:139], v184 offset:1984
    s_waitcnt lgkmcnt(6)
    v_mfma_f32_16x16x32_bf16 v[16:19], v[120:123], v[144:147], 0
    ds_read_b64_tr_b16 v[140:141], v185 offset:192
    v_mfma_f32_16x16x32_bf16 v[24:27], v[120:123], v[148:151], 0
    ds_read_b64_tr_b16 v[142:143], v185 offset:1984
    v_mfma_f32_16x16x32_bf16 v[20:23], v[124:127], v[144:147], 0
    ds_read_b64_tr_b16 v[112:113], v184 offset:256
    v_mfma_f32_16x16x32_bf16 v[28:31], v[124:127], v[148:151], 0
    ds_read_b64_tr_b16 v[114:115], v184 offset:2048
    s_waitcnt lgkmcnt(6)
    v_mfma_f32_16x16x32_bf16 v[32:35], v[128:131], v[144:147], 0
    ds_read_b64_tr_b16 v[116:117], v185 offset:256
    v_mfma_f32_16x16x32_bf16 v[40:43], v[128:131], v[148:151], 0
    ds_read_b64_tr_b16 v[118:119], v185 offset:2048
    v_mfma_f32_16x16x32_bf16 v[36:39], v[132:135], v[144:147], 0
    ds_read_b64_tr_b16 v[120:121], v184 offset:320
    v_mfma_f32_16x16x32_bf16 v[44:47], v[132:135], v[148:151], 0
    ds_read_b64_tr_b16 v[122:123], v184 offset:2112
    s_waitcnt lgkmcnt(6)
    v_mfma_f32_16x16x32_bf16 v[48:51], v[136:139], v[144:147], 0
    ds_read_b64_tr_b16 v[124:125], v185 offset:320
    v_mfma_f32_16x16x32_bf16 v[56:59], v[136:139], v[148:151], 0
    ds_read_b64_tr_b16 v[126:127], v185 offset:2112
    v_mfma_f32_16x16x32_bf16 v[52:55], v[140:143], v[144:147], 0
    ds_read_b64_tr_b16 v[128:129], v184 offset:384
    v_mfma_f32_16x16x32_bf16 v[60:63], v[140:143], v[148:151], 0
    ds_read_b64_tr_b16 v[130:131], v184 offset:2176
    s_waitcnt lgkmcnt(6)
    v_mfma_f32_16x16x32_bf16 v[64:67], v[112:115], v[144:147], 0
    ds_read_b64_tr_b16 v[132:133], v185 offset:384
    v_mfma_f32_16x16x32_bf16 v[72:75], v[112:115], v[148:151], 0
    ds_read_b64_tr_b16 v[134:135], v185 offset:2176
    v_mfma_f32_16x16x32_bf16 v[68:71], v[116:119], v[144:147], 0
    ds_read_b128 v[152:155], v181 offset:0
    ds_read_b128 v[156:159], v181 offset:2048
    v_mfma_f32_16x16x32_bf16 v[76:79], v[116:119], v[148:151], 0
    ds_read_b64_tr_b16 v[136:137], v184 offset:14336
    ds_read_b64_tr_b16 v[138:139], v184 offset:16128
    s_waitcnt lgkmcnt(8)
    v_mfma_f32_16x16x32_bf16 v[80:83], v[120:123], v[144:147], 0
    ds_read_b64_tr_b16 v[140:141], v185 offset:14336
    v_mfma_f32_16x16x32_bf16 v[88:91], v[120:123], v[148:151], 0
    ds_read_b64_tr_b16 v[142:143], v185 offset:16128
    v_mfma_f32_16x16x32_bf16 v[84:87], v[124:127], v[144:147], 0
    ds_read_b64_tr_b16 v[112:113], v184 offset:14400
    v_mfma_f32_16x16x32_bf16 v[92:95], v[124:127], v[148:151], 0
    ds_read_b64_tr_b16 v[114:115], v184 offset:16192
    s_waitcnt lgkmcnt(8)
    v_mfma_f32_16x16x32_bf16 v[96:99], v[128:131], v[144:147], 0
    ds_read_b64_tr_b16 v[116:117], v185 offset:14400
    v_mfma_f32_16x16x32_bf16 v[104:107], v[128:131], v[148:151], 0
    ds_read_b64_tr_b16 v[118:119], v185 offset:16192
    v_mfma_f32_16x16x32_bf16 v[100:103], v[132:135], v[144:147], 0
    ds_read_b64_tr_b16 v[120:121], v184 offset:14464
    v_mfma_f32_16x16x32_bf16 v[108:111], v[132:135], v[148:151], 0
    ds_read_b64_tr_b16 v[122:123], v184 offset:16256
    s_waitcnt lgkmcnt(6)
    v_mfma_f32_16x16x32_bf16 v[0:3], v[136:139], v[152:155], v[0:3]
    ds_read_b64_tr_b16 v[124:125], v185 offset:14464
    v_mfma_f32_16x16x32_bf16 v[8:11], v[136:139], v[156:159], v[8:11]
    ds_read_b64_tr_b16 v[126:127], v185 offset:16256
    v_mfma_f32_16x16x32_bf16 v[4:7], v[140:143], v[152:155], v[4:7]
    ds_read_b64_tr_b16 v[128:129], v184 offset:14528
    v_mfma_f32_16x16x32_bf16 v[12:15], v[140:143], v[156:159], v[12:15]
    ds_read_b64_tr_b16 v[130:131], v184 offset:16320
    s_waitcnt lgkmcnt(6)
    v_mfma_f32_16x16x32_bf16 v[16:19], v[112:115], v[152:155], v[16:19]
    ds_read_b64_tr_b16 v[132:133], v185 offset:14528
    v_mfma_f32_16x16x32_bf16 v[24:27], v[112:115], v[156:159], v[24:27]
    ds_read_b64_tr_b16 v[134:135], v185 offset:16320
    v_mfma_f32_16x16x32_bf16 v[20:23], v[116:119], v[152:155], v[20:23]
    ds_read_b64_tr_b16 v[136:137], v184 offset:14592
    v_mfma_f32_16x16x32_bf16 v[28:31], v[116:119], v[156:159], v[28:31]
    ds_read_b64_tr_b16 v[138:139], v184 offset:16384
    s_waitcnt lgkmcnt(6)
    v_mfma_f32_16x16x32_bf16 v[32:35], v[120:123], v[152:155], v[32:35]
    ds_read_b64_tr_b16 v[140:141], v185 offset:14592
    v_mfma_f32_16x16x32_bf16 v[40:43], v[120:123], v[156:159], v[40:43]
    ds_read_b64_tr_b16 v[142:143], v185 offset:16384
    v_mfma_f32_16x16x32_bf16 v[36:39], v[124:127], v[152:155], v[36:39]
    ds_read_b64_tr_b16 v[112:113], v184 offset:14656
    v_mfma_f32_16x16x32_bf16 v[44:47], v[124:127], v[156:159], v[44:47]
    ds_read_b64_tr_b16 v[114:115], v184 offset:16448
    s_waitcnt lgkmcnt(6)
    v_mfma_f32_16x16x32_bf16 v[48:51], v[128:131], v[152:155], v[48:51]
    ds_read_b64_tr_b16 v[116:117], v185 offset:14656
    v_mfma_f32_16x16x32_bf16 v[56:59], v[128:131], v[156:159], v[56:59]
    ds_read_b64_tr_b16 v[118:119], v185 offset:16448
    v_mfma_f32_16x16x32_bf16 v[52:55], v[132:135], v[152:155], v[52:55]
    ds_read_b64_tr_b16 v[120:121], v184 offset:14720
    v_mfma_f32_16x16x32_bf16 v[60:63], v[132:135], v[156:159], v[60:63]
    ds_read_b64_tr_b16 v[122:123], v184 offset:16512
    s_waitcnt lgkmcnt(6)
    v_mfma_f32_16x16x32_bf16 v[64:67], v[136:139], v[152:155], v[64:67]
    ds_read_b64_tr_b16 v[124:125], v185 offset:14720
    v_mfma_f32_16x16x32_bf16 v[72:75], v[136:139], v[156:159], v[72:75]
    ds_read_b64_tr_b16 v[126:127], v185 offset:16512
    v_mfma_f32_16x16x32_bf16 v[68:71], v[140:143], v[152:155], v[68:71]
    v_mfma_f32_16x16x32_bf16 v[76:79], v[140:143], v[156:159], v[76:79]
    s_waitcnt lgkmcnt(4)
    v_mfma_f32_16x16x32_bf16 v[80:83], v[112:115], v[152:155], v[80:83]
    v_mfma_f32_16x16x32_bf16 v[88:91], v[112:115], v[156:159], v[88:91]
    v_mfma_f32_16x16x32_bf16 v[84:87], v[116:119], v[152:155], v[84:87]
    v_add_u32 v184, 77824, v190
    v_add_u32 v185, 77824, v191
    s_waitcnt lgkmcnt(0)
    s_barrier
    ds_read_b128 v[144:147], v180 offset:16384
    ds_read_b128 v[148:151], v180 offset:18432
    ds_read_b64_tr_b16 v[128:129], v184 offset:0
    ds_read_b64_tr_b16 v[130:131], v184 offset:1792
    ds_read_b64_tr_b16 v[132:133], v185 offset:0
    ds_read_b64_tr_b16 v[134:135], v185 offset:1792
    ds_read_b64_tr_b16 v[136:137], v184 offset:64
    ds_read_b64_tr_b16 v[138:139], v184 offset:1856
    v_mfma_f32_16x16x32_bf16 v[92:95], v[116:119], v[156:159], v[92:95]
    v_mfma_f32_16x16x32_bf16 v[96:99], v[120:123], v[152:155], v[96:99]
    ds_read_b64_tr_b16 v[140:141], v185 offset:64
    v_mfma_f32_16x16x32_bf16 v[104:107], v[120:123], v[156:159], v[104:107]
    ds_read_b64_tr_b16 v[142:143], v185 offset:1856
    v_mfma_f32_16x16x32_bf16 v[100:103], v[124:127], v[152:155], v[100:103]
    ds_read_b64_tr_b16 v[112:113], v184 offset:128
    v_mfma_f32_16x16x32_bf16 v[108:111], v[124:127], v[156:159], v[108:111]
    ds_read_b64_tr_b16 v[114:115], v184 offset:1920
    s_waitcnt lgkmcnt(6)
    v_mfma_f32_16x16x32_bf16 v[0:3], v[128:131], v[144:147], v[0:3]
    ds_read_b64_tr_b16 v[116:117], v185 offset:128
    v_mfma_f32_16x16x32_bf16 v[8:11], v[128:131], v[148:151], v[8:11]
    ds_read_b64_tr_b16 v[118:119], v185 offset:1920
    v_mfma_f32_16x16x32_bf16 v[4:7], v[132:135], v[144:147], v[4:7]
    ds_read_b64_tr_b16 v[120:121], v184 offset:192
    v_mfma_f32_16x16x32_bf16 v[12:15], v[132:135], v[148:151], v[12:15]
    ds_read_b64_tr_b16 v[122:123], v184 offset:1984
    s_waitcnt lgkmcnt(6)
    v_mfma_f32_16x16x32_bf16 v[16:19], v[136:139], v[144:147], v[16:19]
    ds_read_b64_tr_b16 v[124:125], v185 offset:192
    v_mfma_f32_16x16x32_bf16 v[24:27], v[136:139], v[148:151], v[24:27]
    ds_read_b64_tr_b16 v[126:127], v185 offset:1984
    v_mfma_f32_16x16x32_bf16 v[20:23], v[140:143], v[144:147], v[20:23]
    ds_read_b64_tr_b16 v[128:129], v184 offset:256
    v_mfma_f32_16x16x32_bf16 v[28:31], v[140:143], v[148:151], v[28:31]
    ds_read_b64_tr_b16 v[130:131], v184 offset:2048
    s_waitcnt lgkmcnt(6)
    v_mfma_f32_16x16x32_bf16 v[32:35], v[112:115], v[144:147], v[32:35]
    ds_read_b64_tr_b16 v[132:133], v185 offset:256
    v_mfma_f32_16x16x32_bf16 v[40:43], v[112:115], v[148:151], v[40:43]
    ds_read_b64_tr_b16 v[134:135], v185 offset:2048
    v_mfma_f32_16x16x32_bf16 v[36:39], v[116:119], v[144:147], v[36:39]
    ds_read_b64_tr_b16 v[136:137], v184 offset:320
    v_mfma_f32_16x16x32_bf16 v[44:47], v[116:119], v[148:151], v[44:47]
    ds_read_b64_tr_b16 v[138:139], v184 offset:2112
    s_waitcnt lgkmcnt(6)
    v_mfma_f32_16x16x32_bf16 v[48:51], v[120:123], v[144:147], v[48:51]
    ds_read_b64_tr_b16 v[140:141], v185 offset:320
    v_mfma_f32_16x16x32_bf16 v[56:59], v[120:123], v[148:151], v[56:59]
    ds_read_b64_tr_b16 v[142:143], v185 offset:2112
    v_mfma_f32_16x16x32_bf16 v[52:55], v[124:127], v[144:147], v[52:55]
    ds_read_b64_tr_b16 v[112:113], v184 offset:384
    v_mfma_f32_16x16x32_bf16 v[60:63], v[124:127], v[148:151], v[60:63]
    ds_read_b64_tr_b16 v[114:115], v184 offset:2176
    s_waitcnt lgkmcnt(6)
    v_mfma_f32_16x16x32_bf16 v[64:67], v[128:131], v[144:147], v[64:67]
    ds_read_b64_tr_b16 v[116:117], v185 offset:384
    v_mfma_f32_16x16x32_bf16 v[72:75], v[128:131], v[148:151], v[72:75]
    ds_read_b64_tr_b16 v[118:119], v185 offset:2176
    v_mfma_f32_16x16x32_bf16 v[68:71], v[132:135], v[144:147], v[68:71]
    ds_read_b128 v[152:155], v181 offset:16384
    ds_read_b128 v[156:159], v181 offset:18432
    v_mfma_f32_16x16x32_bf16 v[76:79], v[132:135], v[148:151], v[76:79]
    ds_read_b64_tr_b16 v[120:121], v184 offset:14336
    ds_read_b64_tr_b16 v[122:123], v184 offset:16128
    s_waitcnt lgkmcnt(8)
    v_mfma_f32_16x16x32_bf16 v[80:83], v[136:139], v[144:147], v[80:83]
    ds_read_b64_tr_b16 v[124:125], v185 offset:14336
    v_mfma_f32_16x16x32_bf16 v[88:91], v[136:139], v[148:151], v[88:91]
    ds_read_b64_tr_b16 v[126:127], v185 offset:16128
    v_mfma_f32_16x16x32_bf16 v[84:87], v[140:143], v[144:147], v[84:87]
    ds_read_b64_tr_b16 v[128:129], v184 offset:14400
    v_mfma_f32_16x16x32_bf16 v[92:95], v[140:143], v[148:151], v[92:95]
    ds_read_b64_tr_b16 v[130:131], v184 offset:16192
    s_waitcnt lgkmcnt(8)
    v_mfma_f32_16x16x32_bf16 v[96:99], v[112:115], v[144:147], v[96:99]
    ds_read_b64_tr_b16 v[132:133], v185 offset:14400
    v_mfma_f32_16x16x32_bf16 v[104:107], v[112:115], v[148:151], v[104:107]
    ds_read_b64_tr_b16 v[134:135], v185 offset:16192
    v_mfma_f32_16x16x32_bf16 v[100:103], v[116:119], v[144:147], v[100:103]
    ds_read_b64_tr_b16 v[136:137], v184 offset:14464
    v_mfma_f32_16x16x32_bf16 v[108:111], v[116:119], v[148:151], v[108:111]
    ds_read_b64_tr_b16 v[138:139], v184 offset:16256
    s_waitcnt lgkmcnt(6)
    v_mfma_f32_16x16x32_bf16 v[0:3], v[120:123], v[152:155], v[0:3]
    ds_read_b64_tr_b16 v[140:141], v185 offset:14464
    v_mfma_f32_16x16x32_bf16 v[8:11], v[120:123], v[156:159], v[8:11]
    ds_read_b64_tr_b16 v[142:143], v185 offset:16256
    v_mfma_f32_16x16x32_bf16 v[4:7], v[124:127], v[152:155], v[4:7]
    ds_read_b64_tr_b16 v[112:113], v184 offset:14528
    v_mfma_f32_16x16x32_bf16 v[12:15], v[124:127], v[156:159], v[12:15]
    ds_read_b64_tr_b16 v[114:115], v184 offset:16320
    s_waitcnt lgkmcnt(6)
    v_mfma_f32_16x16x32_bf16 v[16:19], v[128:131], v[152:155], v[16:19]
    ds_read_b64_tr_b16 v[116:117], v185 offset:14528
    v_mfma_f32_16x16x32_bf16 v[24:27], v[128:131], v[156:159], v[24:27]
    ds_read_b64_tr_b16 v[118:119], v185 offset:16320
    v_mfma_f32_16x16x32_bf16 v[20:23], v[132:135], v[152:155], v[20:23]
    ds_read_b64_tr_b16 v[120:121], v184 offset:14592
    v_mfma_f32_16x16x32_bf16 v[28:31], v[132:135], v[156:159], v[28:31]
    ds_read_b64_tr_b16 v[122:123], v184 offset:16384
    s_waitcnt lgkmcnt(6)
    v_mfma_f32_16x16x32_bf16 v[32:35], v[136:139], v[152:155], v[32:35]
    ds_read_b64_tr_b16 v[124:125], v185 offset:14592
    v_mfma_f32_16x16x32_bf16 v[40:43], v[136:139], v[156:159], v[40:43]
    ds_read_b64_tr_b16 v[126:127], v185 offset:16384
    v_mfma_f32_16x16x32_bf16 v[36:39], v[140:143], v[152:155], v[36:39]
    ds_read_b64_tr_b16 v[128:129], v184 offset:14656
    v_mfma_f32_16x16x32_bf16 v[44:47], v[140:143], v[156:159], v[44:47]
    ds_read_b64_tr_b16 v[130:131], v184 offset:16448
    s_waitcnt lgkmcnt(6)
    v_mfma_f32_16x16x32_bf16 v[48:51], v[112:115], v[152:155], v[48:51]
    ds_read_b64_tr_b16 v[132:133], v185 offset:14656
    v_mfma_f32_16x16x32_bf16 v[56:59], v[112:115], v[156:159], v[56:59]
    ds_read_b64_tr_b16 v[134:135], v185 offset:16448
    v_mfma_f32_16x16x32_bf16 v[52:55], v[116:119], v[152:155], v[52:55]
    ds_read_b64_tr_b16 v[136:137], v184 offset:14720
    v_mfma_f32_16x16x32_bf16 v[60:63], v[116:119], v[156:159], v[60:63]
    ds_read_b64_tr_b16 v[138:139], v184 offset:16512
    s_waitcnt lgkmcnt(6)
    v_mfma_f32_16x16x32_bf16 v[64:67], v[120:123], v[152:155], v[64:67]
    ds_read_b64_tr_b16 v[140:141], v185 offset:14720
    v_mfma_f32_16x16x32_bf16 v[72:75], v[120:123], v[156:159], v[72:75]
    ds_read_b64_tr_b16 v[142:143], v185 offset:16512
    v_mfma_f32_16x16x32_bf16 v[68:71], v[124:127], v[152:155], v[68:71]
    v_mfma_f32_16x16x32_bf16 v[76:79], v[124:127], v[156:159], v[76:79]
    s_waitcnt lgkmcnt(4)
    v_mfma_f32_16x16x32_bf16 v[80:83], v[128:131], v[152:155], v[80:83]
    v_mfma_f32_16x16x32_bf16 v[88:91], v[128:131], v[156:159], v[88:91]
    v_mfma_f32_16x16x32_bf16 v[84:87], v[132:135], v[152:155], v[84:87]
    v_add_u32 v184, 106496, v190
    v_add_u32 v185, 106496, v191
    s_waitcnt lgkmcnt(0)
    s_barrier
    ds_read_b128 v[144:147], v180 offset:32768
    ds_read_b128 v[148:151], v180 offset:34816
    ds_read_b64_tr_b16 v[112:113], v184 offset:0
    ds_read_b64_tr_b16 v[114:115], v184 offset:1792
    ds_read_b64_tr_b16 v[116:117], v185 offset:0
    ds_read_b64_tr_b16 v[118:119], v185 offset:1792
    ds_read_b64_tr_b16 v[120:121], v184 offset:64
    ds_read_b64_tr_b16 v[122:123], v184 offset:1856
    v_mfma_f32_16x16x32_bf16 v[92:95], v[132:135], v[156:159], v[92:95]
    v_mfma_f32_16x16x32_bf16 v[96:99], v[136:139], v[152:155], v[96:99]
    ds_read_b64_tr_b16 v[124:125], v185 offset:64
    v_mfma_f32_16x16x32_bf16 v[104:107], v[136:139], v[156:159], v[104:107]
    ds_read_b64_tr_b16 v[126:127], v185 offset:1856
    v_mfma_f32_16x16x32_bf16 v[100:103], v[140:143], v[152:155], v[100:103]
    ds_read_b64_tr_b16 v[128:129], v184 offset:128
    v_mfma_f32_16x16x32_bf16 v[108:111], v[140:143], v[156:159], v[108:111]
    ds_read_b64_tr_b16 v[130:131], v184 offset:1920
    s_waitcnt lgkmcnt(6)
    v_mfma_f32_16x16x32_bf16 v[0:3], v[112:115], v[144:147], v[0:3]
    ds_read_b64_tr_b16 v[132:133], v185 offset:128
    v_mfma_f32_16x16x32_bf16 v[8:11], v[112:115], v[148:151], v[8:11]
    ds_read_b64_tr_b16 v[134:135], v185 offset:1920
    v_mfma_f32_16x16x32_bf16 v[4:7], v[116:119], v[144:147], v[4:7]
    ds_read_b64_tr_b16 v[136:137], v184 offset:192
    v_mfma_f32_16x16x32_bf16 v[12:15], v[116:119], v[148:151], v[12:15]
    ds_read_b64_tr_b16 v[138:139], v184 offset:1984
    s_waitcnt lgkmcnt(6)
    v_mfma_f32_16x16x32_bf16 v[16:19], v[120:123], v[144:147], v[16:19]
    ds_read_b64_tr_b16 v[140:141], v185 offset:192
    v_mfma_f32_16x16x32_bf16 v[24:27], v[120:123], v[148:151], v[24:27]
    ds_read_b64_tr_b16 v[142:143], v185 offset:1984
    v_mfma_f32_16x16x32_bf16 v[20:23], v[124:127], v[144:147], v[20:23]
    ds_read_b64_tr_b16 v[112:113], v184 offset:256
    v_mfma_f32_16x16x32_bf16 v[28:31], v[124:127], v[148:151], v[28:31]
    ds_read_b64_tr_b16 v[114:115], v184 offset:2048
    s_waitcnt lgkmcnt(6)
    v_mfma_f32_16x16x32_bf16 v[32:35], v[128:131], v[144:147], v[32:35]
    ds_read_b64_tr_b16 v[116:117], v185 offset:256
    v_mfma_f32_16x16x32_bf16 v[40:43], v[128:131], v[148:151], v[40:43]
    ds_read_b64_tr_b16 v[118:119], v185 offset:2048
    v_mfma_f32_16x16x32_bf16 v[36:39], v[132:135], v[144:147], v[36:39]
    ds_read_b64_tr_b16 v[120:121], v184 offset:320
    v_mfma_f32_16x16x32_bf16 v[44:47], v[132:135], v[148:151], v[44:47]
    ds_read_b64_tr_b16 v[122:123], v184 offset:2112
    s_waitcnt lgkmcnt(6)
    v_mfma_f32_16x16x32_bf16 v[48:51], v[136:139], v[144:147], v[48:51]
    ds_read_b64_tr_b16 v[124:125], v185 offset:320
    v_mfma_f32_16x16x32_bf16 v[56:59], v[136:139], v[148:151], v[56:59]
    ds_read_b64_tr_b16 v[126:127], v185 offset:2112
    v_mfma_f32_16x16x32_bf16 v[52:55], v[140:143], v[144:147], v[52:55]
    ds_read_b64_tr_b16 v[128:129], v184 offset:384
    v_mfma_f32_16x16x32_bf16 v[60:63], v[140:143], v[148:151], v[60:63]
    ds_read_b64_tr_b16 v[130:131], v184 offset:2176
    s_waitcnt lgkmcnt(6)
    v_mfma_f32_16x16x32_bf16 v[64:67], v[112:115], v[144:147], v[64:67]
    ds_read_b64_tr_b16 v[132:133], v185 offset:384
    v_mfma_f32_16x16x32_bf16 v[72:75], v[112:115], v[148:151], v[72:75]
    ds_read_b64_tr_b16 v[134:135], v185 offset:2176
    v_mfma_f32_16x16x32_bf16 v[68:71], v[116:119], v[144:147], v[68:71]
    ds_read_b128 v[152:155], v181 offset:32768
    ds_read_b128 v[156:159], v181 offset:34816
    v_mfma_f32_16x16x32_bf16 v[76:79], v[116:119], v[148:151], v[76:79]
    ds_read_b64_tr_b16 v[136:137], v184 offset:14336
    ds_read_b64_tr_b16 v[138:139], v184 offset:16128
    s_waitcnt lgkmcnt(8)
    v_mfma_f32_16x16x32_bf16 v[80:83], v[120:123], v[144:147], v[80:83]
    ds_read_b64_tr_b16 v[140:141], v185 offset:14336
    v_mfma_f32_16x16x32_bf16 v[88:91], v[120:123], v[148:151], v[88:91]
    ds_read_b64_tr_b16 v[142:143], v185 offset:16128
    v_mfma_f32_16x16x32_bf16 v[84:87], v[124:127], v[144:147], v[84:87]
    ds_read_b64_tr_b16 v[112:113], v184 offset:14400
    v_mfma_f32_16x16x32_bf16 v[92:95], v[124:127], v[148:151], v[92:95]
    ds_read_b64_tr_b16 v[114:115], v184 offset:16192
    s_waitcnt lgkmcnt(8)
    v_mfma_f32_16x16x32_bf16 v[96:99], v[128:131], v[144:147], v[96:99]
    ds_read_b64_tr_b16 v[116:117], v185 offset:14400
    v_mfma_f32_16x16x32_bf16 v[104:107], v[128:131], v[148:151], v[104:107]
    ds_read_b64_tr_b16 v[118:119], v185 offset:16192
    v_mfma_f32_16x16x32_bf16 v[100:103], v[132:135], v[144:147], v[100:103]
    ds_read_b64_tr_b16 v[120:121], v184 offset:14464
    v_mfma_f32_16x16x32_bf16 v[108:111], v[132:135], v[148:151], v[108:111]
    ds_read_b64_tr_b16 v[122:123], v184 offset:16256
    s_waitcnt lgkmcnt(6)
    v_mfma_f32_16x16x32_bf16 v[0:3], v[136:139], v[152:155], v[0:3]
    ds_read_b64_tr_b16 v[124:125], v185 offset:14464
    v_mfma_f32_16x16x32_bf16 v[8:11], v[136:139], v[156:159], v[8:11]
    ds_read_b64_tr_b16 v[126:127], v185 offset:16256
    v_mfma_f32_16x16x32_bf16 v[4:7], v[140:143], v[152:155], v[4:7]
    ds_read_b64_tr_b16 v[128:129], v184 offset:14528
    v_mfma_f32_16x16x32_bf16 v[12:15], v[140:143], v[156:159], v[12:15]
    ds_read_b64_tr_b16 v[130:131], v184 offset:16320
    s_waitcnt lgkmcnt(6)
    v_mfma_f32_16x16x32_bf16 v[16:19], v[112:115], v[152:155], v[16:19]
    ds_read_b64_tr_b16 v[132:133], v185 offset:14528
    v_mfma_f32_16x16x32_bf16 v[24:27], v[112:115], v[156:159], v[24:27]
    ds_read_b64_tr_b16 v[134:135], v185 offset:16320
    v_mfma_f32_16x16x32_bf16 v[20:23], v[116:119], v[152:155], v[20:23]
    ds_read_b64_tr_b16 v[136:137], v184 offset:14592
    v_mfma_f32_16x16x32_bf16 v[28:31], v[116:119], v[156:159], v[28:31]
    ds_read_b64_tr_b16 v[138:139], v184 offset:16384
    s_waitcnt lgkmcnt(6)
    v_mfma_f32_16x16x32_bf16 v[32:35], v[120:123], v[152:155], v[32:35]
    ds_read_b64_tr_b16 v[140:141], v185 offset:14592
    v_mfma_f32_16x16x32_bf16 v[40:43], v[120:123], v[156:159], v[40:43]
    ds_read_b64_tr_b16 v[142:143], v185 offset:16384
    v_mfma_f32_16x16x32_bf16 v[36:39], v[124:127], v[152:155], v[36:39]
    ds_read_b64_tr_b16 v[112:113], v184 offset:14656
    v_mfma_f32_16x16x32_bf16 v[44:47], v[124:127], v[156:159], v[44:47]
    ds_read_b64_tr_b16 v[114:115], v184 offset:16448
    s_waitcnt lgkmcnt(6)
    v_mfma_f32_16x16x32_bf16 v[48:51], v[128:131], v[152:155], v[48:51]
    ds_read_b64_tr_b16 v[116:117], v185 offset:14656
    v_mfma_f32_16x16x32_bf16 v[56:59], v[128:131], v[156:159], v[56:59]
    ds_read_b64_tr_b16 v[118:119], v185 offset:16448
    v_mfma_f32_16x16x32_bf16 v[52:55], v[132:135], v[152:155], v[52:55]
    ds_read_b64_tr_b16 v[120:121], v184 offset:14720
    v_mfma_f32_16x16x32_bf16 v[60:63], v[132:135], v[156:159], v[60:63]
    ds_read_b64_tr_b16 v[122:123], v184 offset:16512
    s_waitcnt lgkmcnt(6)
    v_mfma_f32_16x16x32_bf16 v[64:67], v[136:139], v[152:155], v[64:67]
    ds_read_b64_tr_b16 v[124:125], v185 offset:14720
    v_mfma_f32_16x16x32_bf16 v[72:75], v[136:139], v[156:159], v[72:75]
    ds_read_b64_tr_b16 v[126:127], v185 offset:16512
    v_mfma_f32_16x16x32_bf16 v[68:71], v[140:143], v[152:155], v[68:71]
    v_mfma_f32_16x16x32_bf16 v[76:79], v[140:143], v[156:159], v[76:79]
    s_waitcnt lgkmcnt(4)
    v_mfma_f32_16x16x32_bf16 v[80:83], v[112:115], v[152:155], v[80:83]
    v_mfma_f32_16x16x32_bf16 v[88:91], v[112:115], v[156:159], v[88:91]
    v_mfma_f32_16x16x32_bf16 v[84:87], v[116:119], v[152:155], v[84:87]
    v_add_u32 v184, 49152, v190
    v_add_u32 v185, 49152, v191
    s_waitcnt lgkmcnt(0)
    s_barrier
    ds_read_b128 v[144:147], v180 offset:0
    ds_read_b128 v[148:151], v180 offset:2048
    ds_read_b64_tr_b16 v[128:129], v184 offset:0
    ds_read_b64_tr_b16 v[130:131], v184 offset:1792
    ds_read_b64_tr_b16 v[132:133], v185 offset:0
    ds_read_b64_tr_b16 v[134:135], v185 offset:1792
    ds_read_b64_tr_b16 v[136:137], v184 offset:64
    ds_read_b64_tr_b16 v[138:139], v184 offset:1856
    v_mfma_f32_16x16x32_bf16 v[92:95], v[116:119], v[156:159], v[92:95]
    v_mfma_f32_16x16x32_bf16 v[96:99], v[120:123], v[152:155], v[96:99]
    ds_read_b64_tr_b16 v[140:141], v185 offset:64
    v_mfma_f32_16x16x32_bf16 v[104:107], v[120:123], v[156:159], v[104:107]
    ds_read_b64_tr_b16 v[142:143], v185 offset:1856
    v_mfma_f32_16x16x32_bf16 v[100:103], v[124:127], v[152:155], v[100:103]
    ds_read_b64_tr_b16 v[112:113], v184 offset:128
    v_mfma_f32_16x16x32_bf16 v[108:111], v[124:127], v[156:159], v[108:111]
    ds_read_b64_tr_b16 v[114:115], v184 offset:1920
    s_waitcnt lgkmcnt(6)
    v_mfma_f32_16x16x32_bf16 v[0:3], v[128:131], v[144:147], v[0:3]
    ds_read_b64_tr_b16 v[116:117], v185 offset:128
    v_mfma_f32_16x16x32_bf16 v[8:11], v[128:131], v[148:151], v[8:11]
    ds_read_b64_tr_b16 v[118:119], v185 offset:1920
    v_mfma_f32_16x16x32_bf16 v[4:7], v[132:135], v[144:147], v[4:7]
    ds_read_b64_tr_b16 v[120:121], v184 offset:192
    v_mfma_f32_16x16x32_bf16 v[12:15], v[132:135], v[148:151], v[12:15]
    ds_read_b64_tr_b16 v[122:123], v184 offset:1984
    s_waitcnt lgkmcnt(6)
    v_mfma_f32_16x16x32_bf16 v[16:19], v[136:139], v[144:147], v[16:19]
    ds_read_b64_tr_b16 v[124:125], v185 offset:192
    v_mfma_f32_16x16x32_bf16 v[24:27], v[136:139], v[148:151], v[24:27]
    ds_read_b64_tr_b16 v[126:127], v185 offset:1984
    v_mfma_f32_16x16x32_bf16 v[20:23], v[140:143], v[144:147], v[20:23]
    ds_read_b64_tr_b16 v[128:129], v184 offset:256
    v_mfma_f32_16x16x32_bf16 v[28:31], v[140:143], v[148:151], v[28:31]
    ds_read_b64_tr_b16 v[130:131], v184 offset:2048
    s_waitcnt lgkmcnt(6)
    v_mfma_f32_16x16x32_bf16 v[32:35], v[112:115], v[144:147], v[32:35]
    ds_read_b64_tr_b16 v[132:133], v185 offset:256
    v_mfma_f32_16x16x32_bf16 v[40:43], v[112:115], v[148:151], v[40:43]
    ds_read_b64_tr_b16 v[134:135], v185 offset:2048
    v_mfma_f32_16x16x32_bf16 v[36:39], v[116:119], v[144:147], v[36:39]
    ds_read_b64_tr_b16 v[136:137], v184 offset:320
    v_mfma_f32_16x16x32_bf16 v[44:47], v[116:119], v[148:151], v[44:47]
    ds_read_b64_tr_b16 v[138:139], v184 offset:2112
    s_waitcnt lgkmcnt(6)
    v_mfma_f32_16x16x32_bf16 v[48:51], v[120:123], v[144:147], v[48:51]
    ds_read_b64_tr_b16 v[140:141], v185 offset:320
    v_mfma_f32_16x16x32_bf16 v[56:59], v[120:123], v[148:151], v[56:59]
    ds_read_b64_tr_b16 v[142:143], v185 offset:2112
    v_mfma_f32_16x16x32_bf16 v[52:55], v[124:127], v[144:147], v[52:55]
    ds_read_b64_tr_b16 v[112:113], v184 offset:384
    v_mfma_f32_16x16x32_bf16 v[60:63], v[124:127], v[148:151], v[60:63]
    ds_read_b64_tr_b16 v[114:115], v184 offset:2176
    s_waitcnt lgkmcnt(6)
    v_mfma_f32_16x16x32_bf16 v[64:67], v[128:131], v[144:147], v[64:67]
    ds_read_b64_tr_b16 v[116:117], v185 offset:384
    v_mfma_f32_16x16x32_bf16 v[72:75], v[128:131], v[148:151], v[72:75]
    ds_read_b64_tr_b16 v[118:119], v185 offset:2176
    v_mfma_f32_16x16x32_bf16 v[68:71], v[132:135], v[144:147], v[68:71]
    ds_read_b128 v[152:155], v181 offset:0
    ds_read_b128 v[156:159], v181 offset:2048
    v_mfma_f32_16x16x32_bf16 v[76:79], v[132:135], v[148:151], v[76:79]
    ds_read_b64_tr_b16 v[120:121], v184 offset:14336
    ds_read_b64_tr_b16 v[122:123], v184 offset:16128
    s_waitcnt lgkmcnt(8)
    v_mfma_f32_16x16x32_bf16 v[80:83], v[136:139], v[144:147], v[80:83]
    ds_read_b64_tr_b16 v[124:125], v185 offset:14336
    v_mfma_f32_16x16x32_bf16 v[88:91], v[136:139], v[148:151], v[88:91]
    ds_read_b64_tr_b16 v[126:127], v185 offset:16128
    v_mfma_f32_16x16x32_bf16 v[84:87], v[140:143], v[144:147], v[84:87]
    ds_read_b64_tr_b16 v[128:129], v184 offset:14400
    v_mfma_f32_16x16x32_bf16 v[92:95], v[140:143], v[148:151], v[92:95]
    ds_read_b64_tr_b16 v[130:131], v184 offset:16192
    s_waitcnt lgkmcnt(8)
    v_mfma_f32_16x16x32_bf16 v[96:99], v[112:115], v[144:147], v[96:99]
    ds_read_b64_tr_b16 v[132:133], v185 offset:14400
    v_mfma_f32_16x16x32_bf16 v[104:107], v[112:115], v[148:151], v[104:107]
    ds_read_b64_tr_b16 v[134:135], v185 offset:16192
    v_mfma_f32_16x16x32_bf16 v[100:103], v[116:119], v[144:147], v[100:103]
    ds_read_b64_tr_b16 v[136:137], v184 offset:14464
    v_mfma_f32_16x16x32_bf16 v[108:111], v[116:119], v[148:151], v[108:111]
    ds_read_b64_tr_b16 v[138:139], v184 offset:16256
    s_waitcnt lgkmcnt(6)
    v_mfma_f32_16x16x32_bf16 v[0:3], v[120:123], v[152:155], v[0:3]
    ds_read_b64_tr_b16 v[140:141], v185 offset:14464
    v_mfma_f32_16x16x32_bf16 v[8:11], v[120:123], v[156:159], v[8:11]
    ds_read_b64_tr_b16 v[142:143], v185 offset:16256
    v_mfma_f32_16x16x32_bf16 v[4:7], v[124:127], v[152:155], v[4:7]
    ds_read_b64_tr_b16 v[112:113], v184 offset:14528
    v_mfma_f32_16x16x32_bf16 v[12:15], v[124:127], v[156:159], v[12:15]
    ds_read_b64_tr_b16 v[114:115], v184 offset:16320
    s_waitcnt lgkmcnt(6)
    v_mfma_f32_16x16x32_bf16 v[16:19], v[128:131], v[152:155], v[16:19]
    ds_read_b64_tr_b16 v[116:117], v185 offset:14528
    v_mfma_f32_16x16x32_bf16 v[24:27], v[128:131], v[156:159], v[24:27]
    ds_read_b64_tr_b16 v[118:119], v185 offset:16320
    v_mfma_f32_16x16x32_bf16 v[20:23], v[132:135], v[152:155], v[20:23]
    ds_read_b64_tr_b16 v[120:121], v184 offset:14592
    v_mfma_f32_16x16x32_bf16 v[28:31], v[132:135], v[156:159], v[28:31]
    ds_read_b64_tr_b16 v[122:123], v184 offset:16384
    s_waitcnt lgkmcnt(6)
    v_mfma_f32_16x16x32_bf16 v[32:35], v[136:139], v[152:155], v[32:35]
    ds_read_b64_tr_b16 v[124:125], v185 offset:14592
    v_mfma_f32_16x16x32_bf16 v[40:43], v[136:139], v[156:159], v[40:43]
    ds_read_b64_tr_b16 v[126:127], v185 offset:16384
    v_mfma_f32_16x16x32_bf16 v[36:39], v[140:143], v[152:155], v[36:39]
    ds_read_b64_tr_b16 v[128:129], v184 offset:14656
    v_mfma_f32_16x16x32_bf16 v[44:47], v[140:143], v[156:159], v[44:47]
    ds_read_b64_tr_b16 v[130:131], v184 offset:16448
    s_waitcnt lgkmcnt(6)
    v_mfma_f32_16x16x32_bf16 v[48:51], v[112:115], v[152:155], v[48:51]
    ds_read_b64_tr_b16 v[132:133], v185 offset:14656
    v_mfma_f32_16x16x32_bf16 v[56:59], v[112:115], v[156:159], v[56:59]
    ds_read_b64_tr_b16 v[134:135], v185 offset:16448
    v_mfma_f32_16x16x32_bf16 v[52:55], v[116:119], v[152:155], v[52:55]
    ds_read_b64_tr_b16 v[136:137], v184 offset:14720
    v_mfma_f32_16x16x32_bf16 v[60:63], v[116:119], v[156:159], v[60:63]
    ds_read_b64_tr_b16 v[138:139], v184 offset:16512
    s_waitcnt lgkmcnt(6)
    v_mfma_f32_16x16x32_bf16 v[64:67], v[120:123], v[152:155], v[64:67]
    ds_read_b64_tr_b16 v[140:141], v185 offset:14720
    v_mfma_f32_16x16x32_bf16 v[72:75], v[120:123], v[156:159], v[72:75]
    ds_read_b64_tr_b16 v[142:143], v185 offset:16512
    v_mfma_f32_16x16x32_bf16 v[68:71], v[124:127], v[152:155], v[68:71]
    v_mfma_f32_16x16x32_bf16 v[76:79], v[124:127], v[156:159], v[76:79]
    s_waitcnt lgkmcnt(4)
    v_mfma_f32_16x16x32_bf16 v[80:83], v[128:131], v[152:155], v[80:83]
    v_mfma_f32_16x16x32_bf16 v[88:91], v[128:131], v[156:159], v[88:91]
    v_mfma_f32_16x16x32_bf16 v[84:87], v[132:135], v[152:155], v[84:87]
    v_add_u32 v184, 77824, v190
    v_add_u32 v185, 77824, v191
    s_waitcnt lgkmcnt(0)
    s_barrier
    ds_read_b128 v[144:147], v180 offset:16384
    ds_read_b128 v[148:151], v180 offset:18432
    ds_read_b64_tr_b16 v[112:113], v184 offset:0
    ds_read_b64_tr_b16 v[114:115], v184 offset:1792
    ds_read_b64_tr_b16 v[116:117], v185 offset:0
    ds_read_b64_tr_b16 v[118:119], v185 offset:1792
    ds_read_b64_tr_b16 v[120:121], v184 offset:64
    ds_read_b64_tr_b16 v[122:123], v184 offset:1856
    v_mfma_f32_16x16x32_bf16 v[92:95], v[132:135], v[156:159], v[92:95]
    v_mfma_f32_16x16x32_bf16 v[96:99], v[136:139], v[152:155], v[96:99]
    ds_read_b64_tr_b16 v[124:125], v185 offset:64
    v_mfma_f32_16x16x32_bf16 v[104:107], v[136:139], v[156:159], v[104:107]
    ds_read_b64_tr_b16 v[126:127], v185 offset:1856
    v_mfma_f32_16x16x32_bf16 v[100:103], v[140:143], v[152:155], v[100:103]
    ds_read_b64_tr_b16 v[128:129], v184 offset:128
    v_mfma_f32_16x16x32_bf16 v[108:111], v[140:143], v[156:159], v[108:111]
    ds_read_b64_tr_b16 v[130:131], v184 offset:1920
    s_waitcnt lgkmcnt(6)
    v_mfma_f32_16x16x32_bf16 v[0:3], v[112:115], v[144:147], v[0:3]
    ds_read_b64_tr_b16 v[132:133], v185 offset:128
    v_mfma_f32_16x16x32_bf16 v[8:11], v[112:115], v[148:151], v[8:11]
    ds_read_b64_tr_b16 v[134:135], v185 offset:1920
    v_mfma_f32_16x16x32_bf16 v[4:7], v[116:119], v[144:147], v[4:7]
    ds_read_b64_tr_b16 v[136:137], v184 offset:192
    v_mfma_f32_16x16x32_bf16 v[12:15], v[116:119], v[148:151], v[12:15]
    ds_read_b64_tr_b16 v[138:139], v184 offset:1984
    s_waitcnt lgkmcnt(6)
    v_mfma_f32_16x16x32_bf16 v[16:19], v[120:123], v[144:147], v[16:19]
    ds_read_b64_tr_b16 v[140:141], v185 offset:192
    v_mfma_f32_16x16x32_bf16 v[24:27], v[120:123], v[148:151], v[24:27]
    ds_read_b64_tr_b16 v[142:143], v185 offset:1984
    v_mfma_f32_16x16x32_bf16 v[20:23], v[124:127], v[144:147], v[20:23]
    ds_read_b64_tr_b16 v[112:113], v184 offset:256
    v_mfma_f32_16x16x32_bf16 v[28:31], v[124:127], v[148:151], v[28:31]
    ds_read_b64_tr_b16 v[114:115], v184 offset:2048
    s_waitcnt lgkmcnt(6)
    v_mfma_f32_16x16x32_bf16 v[32:35], v[128:131], v[144:147], v[32:35]
    ds_read_b64_tr_b16 v[116:117], v185 offset:256
    v_mfma_f32_16x16x32_bf16 v[40:43], v[128:131], v[148:151], v[40:43]
    ds_read_b64_tr_b16 v[118:119], v185 offset:2048
    v_mfma_f32_16x16x32_bf16 v[36:39], v[132:135], v[144:147], v[36:39]
    ds_read_b64_tr_b16 v[120:121], v184 offset:320
    v_mfma_f32_16x16x32_bf16 v[44:47], v[132:135], v[148:151], v[44:47]
    ds_read_b64_tr_b16 v[122:123], v184 offset:2112
    s_waitcnt lgkmcnt(6)
    v_mfma_f32_16x16x32_bf16 v[48:51], v[136:139], v[144:147], v[48:51]
    ds_read_b64_tr_b16 v[124:125], v185 offset:320
    v_mfma_f32_16x16x32_bf16 v[56:59], v[136:139], v[148:151], v[56:59]
    ds_read_b64_tr_b16 v[126:127], v185 offset:2112
    v_mfma_f32_16x16x32_bf16 v[52:55], v[140:143], v[144:147], v[52:55]
    ds_read_b64_tr_b16 v[128:129], v184 offset:384
    v_mfma_f32_16x16x32_bf16 v[60:63], v[140:143], v[148:151], v[60:63]
    ds_read_b64_tr_b16 v[130:131], v184 offset:2176
    s_waitcnt lgkmcnt(6)
    v_mfma_f32_16x16x32_bf16 v[64:67], v[112:115], v[144:147], v[64:67]
    ds_read_b64_tr_b16 v[132:133], v185 offset:384
    v_mfma_f32_16x16x32_bf16 v[72:75], v[112:115], v[148:151], v[72:75]
    ds_read_b64_tr_b16 v[134:135], v185 offset:2176
    v_mfma_f32_16x16x32_bf16 v[68:71], v[116:119], v[144:147], v[68:71]
    ds_read_b128 v[152:155], v181 offset:16384
    ds_read_b128 v[156:159], v181 offset:18432
    v_mfma_f32_16x16x32_bf16 v[76:79], v[116:119], v[148:151], v[76:79]
    ds_read_b64_tr_b16 v[136:137], v184 offset:14336
    ds_read_b64_tr_b16 v[138:139], v184 offset:16128
    s_waitcnt lgkmcnt(8)
    v_mfma_f32_16x16x32_bf16 v[80:83], v[120:123], v[144:147], v[80:83]
    ds_read_b64_tr_b16 v[140:141], v185 offset:14336
    v_mfma_f32_16x16x32_bf16 v[88:91], v[120:123], v[148:151], v[88:91]
    ds_read_b64_tr_b16 v[142:143], v185 offset:16128
    v_mfma_f32_16x16x32_bf16 v[84:87], v[124:127], v[144:147], v[84:87]
    ds_read_b64_tr_b16 v[112:113], v184 offset:14400
    v_mfma_f32_16x16x32_bf16 v[92:95], v[124:127], v[148:151], v[92:95]
    ds_read_b64_tr_b16 v[114:115], v184 offset:16192
    s_waitcnt lgkmcnt(8)
    v_mfma_f32_16x16x32_bf16 v[96:99], v[128:131], v[144:147], v[96:99]
    ds_read_b64_tr_b16 v[116:117], v185 offset:14400
    v_mfma_f32_16x16x32_bf16 v[104:107], v[128:131], v[148:151], v[104:107]
    ds_read_b64_tr_b16 v[118:119], v185 offset:16192
    v_mfma_f32_16x16x32_bf16 v[100:103], v[132:135], v[144:147], v[100:103]
    ds_read_b64_tr_b16 v[120:121], v184 offset:14464
    v_mfma_f32_16x16x32_bf16 v[108:111], v[132:135], v[148:151], v[108:111]
    ds_read_b64_tr_b16 v[122:123], v184 offset:16256
    s_waitcnt lgkmcnt(6)
    v_mfma_f32_16x16x32_bf16 v[0:3], v[136:139], v[152:155], v[0:3]
    ds_read_b64_tr_b16 v[124:125], v185 offset:14464
    v_mfma_f32_16x16x32_bf16 v[8:11], v[136:139], v[156:159], v[8:11]
    ds_read_b64_tr_b16 v[126:127], v185 offset:16256
    v_mfma_f32_16x16x32_bf16 v[4:7], v[140:143], v[152:155], v[4:7]
    ds_read_b64_tr_b16 v[128:129], v184 offset:14528
    v_mfma_f32_16x16x32_bf16 v[12:15], v[140:143], v[156:159], v[12:15]
    ds_read_b64_tr_b16 v[130:131], v184 offset:16320
    s_waitcnt lgkmcnt(6)
    v_mfma_f32_16x16x32_bf16 v[16:19], v[112:115], v[152:155], v[16:19]
    ds_read_b64_tr_b16 v[132:133], v185 offset:14528
    v_mfma_f32_16x16x32_bf16 v[24:27], v[112:115], v[156:159], v[24:27]
    ds_read_b64_tr_b16 v[134:135], v185 offset:16320
    v_mfma_f32_16x16x32_bf16 v[20:23], v[116:119], v[152:155], v[20:23]
    ds_read_b64_tr_b16 v[136:137], v184 offset:14592
    v_mfma_f32_16x16x32_bf16 v[28:31], v[116:119], v[156:159], v[28:31]
    ds_read_b64_tr_b16 v[138:139], v184 offset:16384
    s_waitcnt lgkmcnt(6)
    v_mfma_f32_16x16x32_bf16 v[32:35], v[120:123], v[152:155], v[32:35]
    ds_read_b64_tr_b16 v[140:141], v185 offset:14592
    v_mfma_f32_16x16x32_bf16 v[40:43], v[120:123], v[156:159], v[40:43]
    ds_read_b64_tr_b16 v[142:143], v185 offset:16384
    v_mfma_f32_16x16x32_bf16 v[36:39], v[124:127], v[152:155], v[36:39]
    ds_read_b64_tr_b16 v[112:113], v184 offset:14656
    v_mfma_f32_16x16x32_bf16 v[44:47], v[124:127], v[156:159], v[44:47]
    ds_read_b64_tr_b16 v[114:115], v184 offset:16448
    s_waitcnt lgkmcnt(6)
    v_mfma_f32_16x16x32_bf16 v[48:51], v[128:131], v[152:155], v[48:51]
    ds_read_b64_tr_b16 v[116:117], v185 offset:14656
    v_mfma_f32_16x16x32_bf16 v[56:59], v[128:131], v[156:159], v[56:59]
    ds_read_b64_tr_b16 v[118:119], v185 offset:16448
    v_mfma_f32_16x16x32_bf16 v[52:55], v[132:135], v[152:155], v[52:55]
    ds_read_b64_tr_b16 v[120:121], v184 offset:14720
    v_mfma_f32_16x16x32_bf16 v[60:63], v[132:135], v[156:159], v[60:63]
    ds_read_b64_tr_b16 v[122:123], v184 offset:16512
    s_waitcnt lgkmcnt(6)
    v_mfma_f32_16x16x32_bf16 v[64:67], v[136:139], v[152:155], v[64:67]
    ds_read_b64_tr_b16 v[124:125], v185 offset:14720
    v_mfma_f32_16x16x32_bf16 v[72:75], v[136:139], v[156:159], v[72:75]
    ds_read_b64_tr_b16 v[126:127], v185 offset:16512
    v_mfma_f32_16x16x32_bf16 v[68:71], v[140:143], v[152:155], v[68:71]
    v_mfma_f32_16x16x32_bf16 v[76:79], v[140:143], v[156:159], v[76:79]
    s_waitcnt lgkmcnt(4)
    v_mfma_f32_16x16x32_bf16 v[80:83], v[112:115], v[152:155], v[80:83]
    v_mfma_f32_16x16x32_bf16 v[88:91], v[112:115], v[156:159], v[88:91]
    v_mfma_f32_16x16x32_bf16 v[84:87], v[116:119], v[152:155], v[84:87]
    v_add_u32 v184, 106496, v190
    v_add_u32 v185, 106496, v191
    s_waitcnt lgkmcnt(0)
    s_barrier
    ds_read_b128 v[144:147], v180 offset:32768
    ds_read_b128 v[148:151], v180 offset:34816
    ds_read_b64_tr_b16 v[128:129], v184 offset:0
    ds_read_b64_tr_b16 v[130:131], v184 offset:1792
    ds_read_b64_tr_b16 v[132:133], v185 offset:0
    ds_read_b64_tr_b16 v[134:135], v185 offset:1792
    ds_read_b64_tr_b16 v[136:137], v184 offset:64
    ds_read_b64_tr_b16 v[138:139], v184 offset:1856
    v_mfma_f32_16x16x32_bf16 v[92:95], v[116:119], v[156:159], v[92:95]
    v_mfma_f32_16x16x32_bf16 v[96:99], v[120:123], v[152:155], v[96:99]
    ds_read_b64_tr_b16 v[140:141], v185 offset:64
    v_mfma_f32_16x16x32_bf16 v[104:107], v[120:123], v[156:159], v[104:107]
    ds_read_b64_tr_b16 v[142:143], v185 offset:1856
    v_mfma_f32_16x16x32_bf16 v[100:103], v[124:127], v[152:155], v[100:103]
    ds_read_b64_tr_b16 v[112:113], v184 offset:128
    v_mfma_f32_16x16x32_bf16 v[108:111], v[124:127], v[156:159], v[108:111]
    ds_read_b64_tr_b16 v[114:115], v184 offset:1920
    s_waitcnt lgkmcnt(6)
    v_mfma_f32_16x16x32_bf16 v[0:3], v[128:131], v[144:147], v[0:3]
    ds_read_b64_tr_b16 v[116:117], v185 offset:128
    v_mfma_f32_16x16x32_bf16 v[8:11], v[128:131], v[148:151], v[8:11]
    ds_read_b64_tr_b16 v[118:119], v185 offset:1920
    v_mfma_f32_16x16x32_bf16 v[4:7], v[132:135], v[144:147], v[4:7]
    ds_read_b64_tr_b16 v[120:121], v184 offset:192
    v_mfma_f32_16x16x32_bf16 v[12:15], v[132:135], v[148:151], v[12:15]
    ds_read_b64_tr_b16 v[122:123], v184 offset:1984
    s_waitcnt lgkmcnt(6)
    v_mfma_f32_16x16x32_bf16 v[16:19], v[136:139], v[144:147], v[16:19]
    ds_read_b64_tr_b16 v[124:125], v185 offset:192
    v_mfma_f32_16x16x32_bf16 v[24:27], v[136:139], v[148:151], v[24:27]
    ds_read_b64_tr_b16 v[126:127], v185 offset:1984
    v_mfma_f32_16x16x32_bf16 v[20:23], v[140:143], v[144:147], v[20:23]
    ds_read_b64_tr_b16 v[128:129], v184 offset:256
    v_mfma_f32_16x16x32_bf16 v[28:31], v[140:143], v[148:151], v[28:31]
    ds_read_b64_tr_b16 v[130:131], v184 offset:2048
    s_waitcnt lgkmcnt(6)
    v_mfma_f32_16x16x32_bf16 v[32:35], v[112:115], v[144:147], v[32:35]
    ds_read_b64_tr_b16 v[132:133], v185 offset:256
    v_mfma_f32_16x16x32_bf16 v[40:43], v[112:115], v[148:151], v[40:43]
    ds_read_b64_tr_b16 v[134:135], v185 offset:2048
    v_mfma_f32_16x16x32_bf16 v[36:39], v[116:119], v[144:147], v[36:39]
    ds_read_b64_tr_b16 v[136:137], v184 offset:320
    v_mfma_f32_16x16x32_bf16 v[44:47], v[116:119], v[148:151], v[44:47]
    ds_read_b64_tr_b16 v[138:139], v184 offset:2112
    s_waitcnt lgkmcnt(6)
    v_mfma_f32_16x16x32_bf16 v[48:51], v[120:123], v[144:147], v[48:51]
    ds_read_b64_tr_b16 v[140:141], v185 offset:320
    v_mfma_f32_16x16x32_bf16 v[56:59], v[120:123], v[148:151], v[56:59]
    ds_read_b64_tr_b16 v[142:143], v185 offset:2112
    v_mfma_f32_16x16x32_bf16 v[52:55], v[124:127], v[144:147], v[52:55]
    ds_read_b64_tr_b16 v[112:113], v184 offset:384
    v_mfma_f32_16x16x32_bf16 v[60:63], v[124:127], v[148:151], v[60:63]
    ds_read_b64_tr_b16 v[114:115], v184 offset:2176
    s_waitcnt lgkmcnt(6)
    v_mfma_f32_16x16x32_bf16 v[64:67], v[128:131], v[144:147], v[64:67]
    ds_read_b64_tr_b16 v[116:117], v185 offset:384
    v_mfma_f32_16x16x32_bf16 v[72:75], v[128:131], v[148:151], v[72:75]
    ds_read_b64_tr_b16 v[118:119], v185 offset:2176
    v_mfma_f32_16x16x32_bf16 v[68:71], v[132:135], v[144:147], v[68:71]
    ds_read_b128 v[152:155], v181 offset:32768
    ds_read_b128 v[156:159], v181 offset:34816
    v_mfma_f32_16x16x32_bf16 v[76:79], v[132:135], v[148:151], v[76:79]
    ds_read_b64_tr_b16 v[120:121], v184 offset:14336
    ds_read_b64_tr_b16 v[122:123], v184 offset:16128
    s_waitcnt lgkmcnt(8)
    v_mfma_f32_16x16x32_bf16 v[80:83], v[136:139], v[144:147], v[80:83]
    ds_read_b64_tr_b16 v[124:125], v185 offset:14336
    v_mfma_f32_16x16x32_bf16 v[88:91], v[136:139], v[148:151], v[88:91]
    ds_read_b64_tr_b16 v[126:127], v185 offset:16128
    v_mfma_f32_16x16x32_bf16 v[84:87], v[140:143], v[144:147], v[84:87]
    ds_read_b64_tr_b16 v[128:129], v184 offset:14400
    v_mfma_f32_16x16x32_bf16 v[92:95], v[140:143], v[148:151], v[92:95]
    ds_read_b64_tr_b16 v[130:131], v184 offset:16192
    s_waitcnt lgkmcnt(8)
    v_mfma_f32_16x16x32_bf16 v[96:99], v[112:115], v[144:147], v[96:99]
    ds_read_b64_tr_b16 v[132:133], v185 offset:14400
    v_mfma_f32_16x16x32_bf16 v[104:107], v[112:115], v[148:151], v[104:107]
    ds_read_b64_tr_b16 v[134:135], v185 offset:16192
    v_mfma_f32_16x16x32_bf16 v[100:103], v[116:119], v[144:147], v[100:103]
    ds_read_b64_tr_b16 v[136:137], v184 offset:14464
    v_mfma_f32_16x16x32_bf16 v[108:111], v[116:119], v[148:151], v[108:111]
    ds_read_b64_tr_b16 v[138:139], v184 offset:16256
    s_waitcnt lgkmcnt(6)
    v_mfma_f32_16x16x32_bf16 v[0:3], v[120:123], v[152:155], v[0:3]
    ds_read_b64_tr_b16 v[140:141], v185 offset:14464
    v_mfma_f32_16x16x32_bf16 v[8:11], v[120:123], v[156:159], v[8:11]
    ds_read_b64_tr_b16 v[142:143], v185 offset:16256
    v_mfma_f32_16x16x32_bf16 v[4:7], v[124:127], v[152:155], v[4:7]
    ds_read_b64_tr_b16 v[112:113], v184 offset:14528
    v_mfma_f32_16x16x32_bf16 v[12:15], v[124:127], v[156:159], v[12:15]
    ds_read_b64_tr_b16 v[114:115], v184 offset:16320
    s_waitcnt lgkmcnt(6)
    v_mfma_f32_16x16x32_bf16 v[16:19], v[128:131], v[152:155], v[16:19]
    ds_read_b64_tr_b16 v[116:117], v185 offset:14528
    v_mfma_f32_16x16x32_bf16 v[24:27], v[128:131], v[156:159], v[24:27]
    ds_read_b64_tr_b16 v[118:119], v185 offset:16320
    v_mfma_f32_16x16x32_bf16 v[20:23], v[132:135], v[152:155], v[20:23]
    ds_read_b64_tr_b16 v[120:121], v184 offset:14592
    v_mfma_f32_16x16x32_bf16 v[28:31], v[132:135], v[156:159], v[28:31]
    ds_read_b64_tr_b16 v[122:123], v184 offset:16384
    s_waitcnt lgkmcnt(6)
    v_mfma_f32_16x16x32_bf16 v[32:35], v[136:139], v[152:155], v[32:35]
    ds_read_b64_tr_b16 v[124:125], v185 offset:14592
    v_mfma_f32_16x16x32_bf16 v[40:43], v[136:139], v[156:159], v[40:43]
    ds_read_b64_tr_b16 v[126:127], v185 offset:16384
    v_mfma_f32_16x16x32_bf16 v[36:39], v[140:143], v[152:155], v[36:39]
    ds_read_b64_tr_b16 v[128:129], v184 offset:14656
    ds_read_b64_tr_b16 v[130:131], v184 offset:16448
    v_mfma_f32_16x16x32_bf16 v[44:47], v[140:143], v[156:159], v[44:47]
    ds_read_b128 v[252:255], v230 offset:0
    s_waitcnt lgkmcnt(7)
    v_mfma_f32_16x16x32_bf16 v[48:51], v[112:115], v[152:155], v[48:51]
    ds_read_b64_tr_b16 v[132:133], v185 offset:14656
    v_mfma_f32_16x16x32_bf16 v[56:59], v[112:115], v[156:159], v[56:59]
    ds_read_b64_tr_b16 v[134:135], v185 offset:16448
    v_mfma_f32_16x16x32_bf16 v[52:55], v[116:119], v[152:155], v[52:55]
    ds_read_b64_tr_b16 v[136:137], v184 offset:14720
    v_mfma_f32_16x16x32_bf16 v[60:63], v[116:119], v[156:159], v[60:63]
    ds_read_b64_tr_b16 v[138:139], v184 offset:16512
    s_waitcnt lgkmcnt(7)
    v_mfma_f32_16x16x32_bf16 v[64:67], v[120:123], v[152:155], v[64:67]
    ds_read_b64_tr_b16 v[140:141], v185 offset:14720
    v_mfma_f32_16x16x32_bf16 v[72:75], v[120:123], v[156:159], v[72:75]
    ds_read_b64_tr_b16 v[142:143], v185 offset:16512
    v_mfma_f32_16x16x32_bf16 v[68:71], v[124:127], v[152:155], v[68:71]
    v_add_u32 v184, 49152, v190
    v_add_u32 v185, 49152, v191
    s_waitcnt lgkmcnt(6)
    v_min3_u32 v252, v252, v253, v254
    v_min_u32 v252, v252, v255
    v_cmp_gt_u32 vcc, 7, v252
    s_nop 0
    s_cbranch_vccz L_Hw6_ok
L_Hw6:
    s_add_u32 s3, s3, 1
    s_cmp_gt_u32 s3, 2097152
    s_cbranch_scc1 L_Hw6_ok
    ds_read_b128 v[252:255], v230 offset:0
    s_waitcnt lgkmcnt(0)
    v_min3_u32 v252, v252, v253, v254
    v_min_u32 v252, v252, v255
    v_cmp_gt_u32 vcc, 7, v252
    s_nop 0
    s_cbranch_vccnz L_Hw6
L_Hw6_ok:
    ds_read_b128 v[144:147], v180 offset:0
    ds_read_b128 v[148:151], v180 offset:2048
    v_mfma_f32_16x16x32_bf16 v[76:79], v[124:127], v[156:159], v[76:79]
    ds_read_b64_tr_b16 v[112:113], v184 offset:0
    ds_read_b64_tr_b16 v[114:115], v184 offset:1792
    s_waitcnt lgkmcnt(8)
    v_mfma_f32_16x16x32_bf16 v[80:83], v[128:131], v[152:155], v[80:83]
    ds_read_b128 v[160:163], v181 offset:0
    ds_read_b128 v[164:167], v181 offset:2048
    v_mfma_f32_16x16x32_bf16 v[88:91], v[128:131], v[156:159], v[88:91]
    ds_read_b64_tr_b16 v[116:117], v184 offset:14336
    ds_read_b64_tr_b16 v[118:119], v184 offset:16128
    v_mfma_f32_16x16x32_bf16 v[84:87], v[132:135], v[152:155], v[84:87]
    ds_read_b32 v204, v202 offset:256
    ds_read_b32 v208, v202 offset:512
    v_mfma_f32_16x16x32_bf16 v[92:95], v[132:135], v[156:159], v[92:95]
    ds_read_b32 v120, v224 offset:0
    s_waitcnt lgkmcnt(11)
    v_mfma_f32_16x16x32_bf16 v[96:99], v[136:139], v[152:155], v[96:99]
    ds_read_b64_tr_b16 v[124:125], v185 offset:0
    v_mfma_f32_16x16x32_bf16 v[104:107], v[136:139], v[156:159], v[104:107]
    ds_read_b64_tr_b16 v[126:127], v185 offset:1792
    v_mfma_f32_16x16x32_bf16 v[100:103], v[140:143], v[152:155], v[100:103]
    ds_read_b64_tr_b16 v[128:129], v185 offset:14336
    v_mfma_f32_16x16x32_bf16 v[108:111], v[140:143], v[156:159], v[108:111]
    ds_read_b64_tr_b16 v[130:131], v185 offset:16128
    v_mov_b32 v251, 6
    ds_write_b32 v231, v251
    s_waitcnt lgkmcnt(8)
    v_mfma_f32_16x16x32_bf16 v[0:3], v[112:115], v[144:147], v[0:3]
    ds_read_b32 v132, v224 offset:128
    v_mfma_f32_16x16x32_bf16 v[8:11], v[112:115], v[148:151], v[8:11]
    s_setprio 1
    v_mfma_f32_16x16x32_bf16 v[0:3], v[116:119], v[160:163], v[0:3]
    ds_read_b64_tr_b16 v[136:137], v184 offset:64
    v_mfma_f32_16x16x32_bf16 v[8:11], v[116:119], v[164:167], v[8:11]
    ds_read_b64_tr_b16 v[138:139], v184 offset:1856
    s_waitcnt lgkmcnt(6)
    v_mfma_f32_16x16x32_bf16 v[0:3], v[120:123], v[204:207], v[0:3]
    ds_read_b64_tr_b16 v[140:141], v184 offset:14400
    v_mfma_f32_16x16x32_bf16 v[8:11], v[120:123], v[208:211], v[8:11]
    ds_read_b64_tr_b16 v[142:143], v184 offset:16192
    v_mfma_f32_16x16x32_bf16 v[4:7], v[124:127], v[144:147], v[4:7]
    ds_read_b32 v112, v224 offset:256
    v_mfma_f32_16x16x32_bf16 v[12:15], v[124:127], v[148:151], v[12:15]
    s_waitcnt lgkmcnt(5)
    v_mfma_f32_16x16x32_bf16 v[4:7], v[128:131], v[160:163], v[4:7]
    ds_read_b64_tr_b16 v[116:117], v185 offset:64
    v_mfma_f32_16x16x32_bf16 v[12:15], v[128:131], v[164:167], v[12:15]
    ds_read_b64_tr_b16 v[118:119], v185 offset:1856
    v_mfma_f32_16x16x32_bf16 v[4:7], v[132:135], v[204:207], v[4:7]
    ds_read_b64_tr_b16 v[120:121], v185 offset:14400
    v_mfma_f32_16x16x32_bf16 v[12:15], v[132:135], v[208:211], v[12:15]
    ds_read_b64_tr_b16 v[122:123], v185 offset:16192
    s_waitcnt lgkmcnt(5)
    v_mfma_f32_16x16x32_bf16 v[16:19], v[136:139], v[144:147], v[16:19]
    ds_read_b32 v124, v224 offset:384
    v_mfma_f32_16x16x32_bf16 v[24:27], v[136:139], v[148:151], v[24:27]
    v_mfma_f32_16x16x32_bf16 v[16:19], v[140:143], v[160:163], v[16:19]
    ds_read_b64_tr_b16 v[128:129], v184 offset:128
    v_mfma_f32_16x16x32_bf16 v[24:27], v[140:143], v[164:167], v[24:27]
    ds_read_b64_tr_b16 v[130:131], v184 offset:1920
    s_waitcnt lgkmcnt(5)
    v_mfma_f32_16x16x32_bf16 v[16:19], v[112:115], v[204:207], v[16:19]
    ds_read_b64_tr_b16 v[132:133], v184 offset:14464
    v_max_f32 v0, 0, v0
    v_max_f32 v1, 0, v1
    v_mfma_f32_16x16x32_bf16 v[24:27], v[112:115], v[208:211], v[24:27]
    ds_read_b64_tr_b16 v[134:135], v184 offset:16256
    v_max_f32 v2, 0, v2
    v_max_f32 v3, 0, v3
    v_mfma_f32_16x16x32_bf16 v[20:23], v[116:119], v[144:147], v[20:23]
    ds_read_b32 v136, v224 offset:512
    v_max_f32 v4, 0, v4
    v_max_f32 v5, 0, v5
    v_mfma_f32_16x16x32_bf16 v[28:31], v[116:119], v[148:151], v[28:31]
    v_max_f32 v6, 0, v6
    v_max_f32 v7, 0, v7
    s_waitcnt lgkmcnt(5)
    v_mfma_f32_16x16x32_bf16 v[20:23], v[120:123], v[160:163], v[20:23]
    ds_read_b64_tr_b16 v[140:141], v185 offset:128
    v_cvt_pk_bf16_f32 v0, v0, v1
    v_cvt_pk_bf16_f32 v1, v2, v3
    v_mfma_f32_16x16x32_bf16 v[28:31], v[120:123], v[164:167], v[28:31]
    ds_read_b64_tr_b16 v[142:143], v185 offset:1920
    v_cvt_pk_bf16_f32 v2, v4, v5
    v_cvt_pk_bf16_f32 v3, v6, v7
    v_mfma_f32_16x16x32_bf16 v[20:23], v[124:127], v[204:207], v[20:23]
    ds_read_b64_tr_b16 v[112:113], v185 offset:14464
    buffer_store_dwordx4 v[0:3], v223, s[40:43], s60 offen offset:0 sc1
    v_max_f32 v8, 0, v8
    v_mfma_f32_16x16x32_bf16 v[28:31], v[124:127], v[208:211], v[28:31]
    ds_read_b64_tr_b16 v[114:115], v185 offset:16256
    v_max_f32 v9, 0, v9
    v_max_f32 v10, 0, v10
    s_waitcnt lgkmcnt(5)
    v_mfma_f32_16x16x32_bf16 v[32:35], v[128:131], v[144:147], v[32:35]
    ds_read_b32 v116, v224 offset:640
    v_max_f32 v11, 0, v11
    v_max_f32 v12, 0, v12
    v_mfma_f32_16x16x32_bf16 v[40:43], v[128:131], v[148:151], v[40:43]
    v_max_f32 v13, 0, v13
    v_max_f32 v14, 0, v14
    v_mfma_f32_16x16x32_bf16 v[32:35], v[132:135], v[160:163], v[32:35]
    ds_read_b64_tr_b16 v[120:121], v184 offset:192
    v_max_f32 v15, 0, v15
    v_cvt_pk_bf16_f32 v8, v8, v9
    v_mfma_f32_16x16x32_bf16 v[40:43], v[132:135], v[164:167], v[40:43]
    ds_read_b64_tr_b16 v[122:123], v184 offset:1984
    v_cvt_pk_bf16_f32 v9, v10, v11
    v_cvt_pk_bf16_f32 v10, v12, v13
    s_waitcnt lgkmcnt(5)
    v_mfma_f32_16x16x32_bf16 v[32:35], v[136:139], v[204:207], v[32:35]
    ds_read_b64_tr_b16 v[124:125], v184 offset:14528
    v_cvt_pk_bf16_f32 v11, v14, v15
    buffer_store_dwordx4 v[8:11], v223, s[40:43], s61 offen offset:0 sc1
    v_mfma_f32_16x16x32_bf16 v[40:43], v[136:139], v[208:211], v[40:43]
    ds_read_b64_tr_b16 v[126:127], v184 offset:16320
    v_max_f32 v16, 0, v16
    v_max_f32 v17, 0, v17
    v_mfma_f32_16x16x32_bf16 v[36:39], v[140:143], v[144:147], v[36:39]
    ds_read_b32 v128, v224 offset:768
    v_max_f32 v18, 0, v18
    v_max_f32 v19, 0, v19
    v_mfma_f32_16x16x32_bf16 v[44:47], v[140:143], v[148:151], v[44:47]
    v_max_f32 v20, 0, v20
    v_max_f32 v21, 0, v21
    s_waitcnt lgkmcnt(5)
    v_mfma_f32_16x16x32_bf16 v[36:39], v[112:115], v[160:163], v[36:39]
    ds_read_b64_tr_b16 v[132:133], v185 offset:192
    v_max_f32 v22, 0, v22
    v_max_f32 v23, 0, v23
    v_mfma_f32_16x16x32_bf16 v[44:47], v[112:115], v[164:167], v[44:47]
    ds_read_b64_tr_b16 v[134:135], v185 offset:1984
    v_cvt_pk_bf16_f32 v16, v16, v17
    v_cvt_pk_bf16_f32 v17, v18, v19
    v_mfma_f32_16x16x32_bf16 v[36:39], v[116:119], v[204:207], v[36:39]
    ds_read_b64_tr_b16 v[136:137], v185 offset:14528
    v_cvt_pk_bf16_f32 v18, v20, v21
    v_cvt_pk_bf16_f32 v19, v22, v23
    v_mfma_f32_16x16x32_bf16 v[44:47], v[116:119], v[208:211], v[44:47]
    ds_read_b64_tr_b16 v[138:139], v185 offset:16320
    buffer_store_dwordx4 v[16:19], v223, s[40:43], s60 offen offset:1024 sc1
    v_max_f32 v24, 0, v24
    s_waitcnt lgkmcnt(5)
    v_mfma_f32_16x16x32_bf16 v[48:51], v[120:123], v[144:147], v[48:51]
    ds_read_b32 v140, v224 offset:896
    v_max_f32 v25, 0, v25
    v_max_f32 v26, 0, v26
    v_mfma_f32_16x16x32_bf16 v[56:59], v[120:123], v[148:151], v[56:59]
    v_max_f32 v27, 0, v27
    v_max_f32 v28, 0, v28
    v_mfma_f32_16x16x32_bf16 v[48:51], v[124:127], v[160:163], v[48:51]
    ds_read_b64_tr_b16 v[112:113], v184 offset:256
    v_max_f32 v29, 0, v29
    v_max_f32 v30, 0, v30
    v_mfma_f32_16x16x32_bf16 v[56:59], v[124:127], v[164:167], v[56:59]
    ds_read_b64_tr_b16 v[114:115], v184 offset:2048
    v_max_f32 v31, 0, v31
    v_cvt_pk_bf16_f32 v24, v24, v25
    s_waitcnt lgkmcnt(5)
    v_mfma_f32_16x16x32_bf16 v[48:51], v[128:131], v[204:207], v[48:51]
    ds_read_b64_tr_b16 v[116:117], v184 offset:14592
    v_cvt_pk_bf16_f32 v25, v26, v27
    v_cvt_pk_bf16_f32 v26, v28, v29
    v_mfma_f32_16x16x32_bf16 v[56:59], v[128:131], v[208:211], v[56:59]
    ds_read_b64_tr_b16 v[118:119], v184 offset:16384
    v_cvt_pk_bf16_f32 v27, v30, v31
    buffer_store_dwordx4 v[24:27], v223, s[40:43], s61 offen offset:1024 sc1
    v_mfma_f32_16x16x32_bf16 v[52:55], v[132:135], v[144:147], v[52:55]
    ds_read_b32 v120, v224 offset:1024
    v_max_f32 v32, 0, v32
    v_max_f32 v33, 0, v33
    v_mfma_f32_16x16x32_bf16 v[60:63], v[132:135], v[148:151], v[60:63]
    v_max_f32 v34, 0, v34
    v_max_f32 v35, 0, v35
    s_waitcnt lgkmcnt(5)
    v_mfma_f32_16x16x32_bf16 v[52:55], v[136:139], v[160:163], v[52:55]
    ds_read_b64_tr_b16 v[124:125], v185 offset:256
    v_max_f32 v36, 0, v36
    v_max_f32 v37, 0, v37
    v_mfma_f32_16x16x32_bf16 v[60:63], v[136:139], v[164:167], v[60:63]
    ds_read_b64_tr_b16 v[126:127], v185 offset:2048
    v_max_f32 v38, 0, v38
    v_max_f32 v39, 0, v39
    v_mfma_f32_16x16x32_bf16 v[52:55], v[140:143], v[204:207], v[52:55]
    ds_read_b64_tr_b16 v[128:129], v185 offset:14592
    v_cvt_pk_bf16_f32 v32, v32, v33
    v_cvt_pk_bf16_f32 v33, v34, v35
    v_mfma_f32_16x16x32_bf16 v[60:63], v[140:143], v[208:211], v[60:63]
    ds_read_b64_tr_b16 v[130:131], v185 offset:16384
    v_cvt_pk_bf16_f32 v34, v36, v37
    v_cvt_pk_bf16_f32 v35, v38, v39
    s_waitcnt lgkmcnt(5)
    v_mfma_f32_16x16x32_bf16 v[64:67], v[112:115], v[144:147], v[64:67]
    ds_read_b32 v132, v224 offset:1152
    buffer_store_dwordx4 v[32:35], v223, s[40:43], s60 offen offset:2048 sc1
    v_max_f32 v40, 0, v40
    v_mfma_f32_16x16x32_bf16 v[72:75], v[112:115], v[148:151], v[72:75]
    v_max_f32 v41, 0, v41
    v_max_f32 v42, 0, v42
    v_mfma_f32_16x16x32_bf16 v[64:67], v[116:119], v[160:163], v[64:67]
    ds_read_b64_tr_b16 v[136:137], v184 offset:320
    v_max_f32 v43, 0, v43
    v_max_f32 v44, 0, v44
    v_mfma_f32_16x16x32_bf16 v[72:75], v[116:119], v[164:167], v[72:75]
    ds_read_b64_tr_b16 v[138:139], v184 offset:2112
    v_max_f32 v45, 0, v45
    v_max_f32 v46, 0, v46
    s_waitcnt lgkmcnt(5)
    v_mfma_f32_16x16x32_bf16 v[64:67], v[120:123], v[204:207], v[64:67]
    ds_read_b64_tr_b16 v[140:141], v184 offset:14656
    v_max_f32 v47, 0, v47
    v_cvt_pk_bf16_f32 v40, v40, v41
    v_mfma_f32_16x16x32_bf16 v[72:75], v[120:123], v[208:211], v[72:75]
    ds_read_b64_tr_b16 v[142:143], v184 offset:16448
    v_cvt_pk_bf16_f32 v41, v42, v43
    v_cvt_pk_bf16_f32 v42, v44, v45
    v_mfma_f32_16x16x32_bf16 v[68:71], v[124:127], v[144:147], v[68:71]
    ds_read_b32 v112, v224 offset:1280
    v_cvt_pk_bf16_f32 v43, v46, v47
    buffer_store_dwordx4 v[40:43], v223, s[40:43], s61 offen offset:2048 sc1
    v_mfma_f32_16x16x32_bf16 v[76:79], v[124:127], v[148:151], v[76:79]
    v_max_f32 v48, 0, v48
    v_max_f32 v49, 0, v49
    s_waitcnt lgkmcnt(5)
    v_mfma_f32_16x16x32_bf16 v[68:71], v[128:131], v[160:163], v[68:71]
    ds_read_b64_tr_b16 v[116:117], v185 offset:320
    v_max_f32 v50, 0, v50
    v_max_f32 v51, 0, v51
    v_mfma_f32_16x16x32_bf16 v[76:79], v[128:131], v[164:167], v[76:79]
    ds_read_b64_tr_b16 v[118:119], v185 offset:2112
    v_max_f32 v52, 0, v52
    v_max_f32 v53, 0, v53
    v_mfma_f32_16x16x32_bf16 v[68:71], v[132:135], v[204:207], v[68:71]
    ds_read_b64_tr_b16 v[120:121], v185 offset:14656
    v_max_f32 v54, 0, v54
    v_max_f32 v55, 0, v55
    v_mfma_f32_16x16x32_bf16 v[76:79], v[132:135], v[208:211], v[76:79]
    ds_read_b64_tr_b16 v[122:123], v185 offset:16448
    v_cvt_pk_bf16_f32 v48, v48, v49
    v_cvt_pk_bf16_f32 v49, v50, v51
    s_waitcnt lgkmcnt(5)
    v_mfma_f32_16x16x32_bf16 v[80:83], v[136:139], v[144:147], v[80:83]
    ds_read_b32 v124, v224 offset:1408
    v_cvt_pk_bf16_f32 v50, v52, v53
    v_cvt_pk_bf16_f32 v51, v54, v55
    v_mfma_f32_16x16x32_bf16 v[88:91], v[136:139], v[148:151], v[88:91]
    buffer_store_dwordx4 v[48:51], v223, s[40:43], s60 offen offset:3072 sc1
    v_max_f32 v56, 0, v56
    v_mfma_f32_16x16x32_bf16 v[80:83], v[140:143], v[160:163], v[80:83]
    ds_read_b64_tr_b16 v[128:129], v184 offset:384
    v_max_f32 v57, 0, v57
    v_max_f32 v58, 0, v58
    v_mfma_f32_16x16x32_bf16 v[88:91], v[140:143], v[164:167], v[88:91]
    ds_read_b64_tr_b16 v[130:131], v184 offset:2176
    v_max_f32 v59, 0, v59
    v_max_f32 v60, 0, v60
    s_waitcnt lgkmcnt(5)
    v_mfma_f32_16x16x32_bf16 v[80:83], v[112:115], v[204:207], v[80:83]
    ds_read_b64_tr_b16 v[132:133], v184 offset:14720
    v_max_f32 v61, 0, v61
    v_max_f32 v62, 0, v62
    v_mfma_f32_16x16x32_bf16 v[88:91], v[112:115], v[208:211], v[88:91]
    ds_read_b64_tr_b16 v[134:135], v184 offset:16512
    v_max_f32 v63, 0, v63
    v_cvt_pk_bf16_f32 v56, v56, v57
    v_mfma_f32_16x16x32_bf16 v[84:87], v[116:119], v[144:147], v[84:87]
    ds_read_b32 v136, v224 offset:1536
    v_cvt_pk_bf16_f32 v57, v58, v59
    v_cvt_pk_bf16_f32 v58, v60, v61
    v_mfma_f32_16x16x32_bf16 v[92:95], v[116:119], v[148:151], v[92:95]
    v_cvt_pk_bf16_f32 v59, v62, v63
    buffer_store_dwordx4 v[56:59], v223, s[40:43], s61 offen offset:3072 sc1
    s_waitcnt lgkmcnt(5)
    v_mfma_f32_16x16x32_bf16 v[84:87], v[120:123], v[160:163], v[84:87]
    ds_read_b64_tr_b16 v[140:141], v185 offset:384
    s_add_u32 s60, s60, 4096
    s_add_u32 s61, s61, 4096
    v_mfma_f32_16x16x32_bf16 v[92:95], v[120:123], v[164:167], v[92:95]
    ds_read_b64_tr_b16 v[142:143], v185 offset:2176
    v_max_f32 v64, 0, v64
    v_max_f32 v65, 0, v65
    v_mfma_f32_16x16x32_bf16 v[84:87], v[124:127], v[204:207], v[84:87]
    ds_read_b64_tr_b16 v[112:113], v185 offset:14720
    v_max_f32 v66, 0, v66
    v_max_f32 v67, 0, v67
    v_mfma_f32_16x16x32_bf16 v[92:95], v[124:127], v[208:211], v[92:95]
    ds_read_b64_tr_b16 v[114:115], v185 offset:16512
    v_max_f32 v68, 0, v68
    v_max_f32 v69, 0, v69
    s_waitcnt lgkmcnt(5)
    v_mfma_f32_16x16x32_bf16 v[96:99], v[128:131], v[144:147], v[96:99]
    ds_read_b32 v116, v224 offset:1664
    v_max_f32 v70, 0, v70
    v_max_f32 v71, 0, v71
    v_mfma_f32_16x16x32_bf16 v[104:107], v[128:131], v[148:151], v[104:107]
    v_cvt_pk_bf16_f32 v64, v64, v65
    v_cvt_pk_bf16_f32 v65, v66, v67
    v_mfma_f32_16x16x32_bf16 v[96:99], v[132:135], v[160:163], v[96:99]
    v_cvt_pk_bf16_f32 v66, v68, v69
    v_cvt_pk_bf16_f32 v67, v70, v71
    v_mfma_f32_16x16x32_bf16 v[104:107], v[132:135], v[164:167], v[104:107]
    buffer_store_dwordx4 v[64:67], v223, s[40:43], s60 offen offset:0 sc1
    v_max_f32 v72, 0, v72
    s_waitcnt lgkmcnt(3)
    v_mfma_f32_16x16x32_bf16 v[96:99], v[136:139], v[204:207], v[96:99]
    v_max_f32 v73, 0, v73
    v_max_f32 v74, 0, v74
    v_mfma_f32_16x16x32_bf16 v[104:107], v[136:139], v[208:211], v[104:107]
    v_max_f32 v75, 0, v75
    v_max_f32 v76, 0, v76
    v_mfma_f32_16x16x32_bf16 v[100:103], v[140:143], v[144:147], v[100:103]
    v_max_f32 v77, 0, v77
    v_max_f32 v78, 0, v78
    v_mfma_f32_16x16x32_bf16 v[108:111], v[140:143], v[148:151], v[108:111]
    v_max_f32 v79, 0, v79
    v_cvt_pk_bf16_f32 v72, v72, v73
    s_waitcnt lgkmcnt(0)
    v_mfma_f32_16x16x32_bf16 v[100:103], v[112:115], v[160:163], v[100:103]
    v_cvt_pk_bf16_f32 v73, v74, v75
    v_cvt_pk_bf16_f32 v74, v76, v77
    v_mfma_f32_16x16x32_bf16 v[108:111], v[112:115], v[164:167], v[108:111]
    v_cvt_pk_bf16_f32 v75, v78, v79
    buffer_store_dwordx4 v[72:75], v223, s[40:43], s61 offen offset:0 sc1
    v_mfma_f32_16x16x32_bf16 v[100:103], v[116:119], v[204:207], v[100:103]
    v_max_f32 v80, 0, v80
    v_max_f32 v81, 0, v81
    v_mfma_f32_16x16x32_bf16 v[108:111], v[116:119], v[208:211], v[108:111]
    v_max_f32 v82, 0, v82
    v_max_f32 v83, 0, v83
    v_max_f32 v84, 0, v84
    v_max_f32 v85, 0, v85
    v_max_f32 v86, 0, v86
    v_max_f32 v87, 0, v87
    v_cvt_pk_bf16_f32 v80, v80, v81
    v_cvt_pk_bf16_f32 v81, v82, v83
    v_cvt_pk_bf16_f32 v82, v84, v85
    v_cvt_pk_bf16_f32 v83, v86, v87
    buffer_store_dwordx4 v[80:83], v223, s[40:43], s60 offen offset:1024 sc1
    v_max_f32 v88, 0, v88
    v_max_f32 v89, 0, v89
    v_max_f32 v90, 0, v90
    v_max_f32 v91, 0, v91
    v_max_f32 v92, 0, v92
    v_max_f32 v93, 0, v93
    v_max_f32 v94, 0, v94
    v_max_f32 v95, 0, v95
    v_cvt_pk_bf16_f32 v88, v88, v89
    v_cvt_pk_bf16_f32 v89, v90, v91
    v_cvt_pk_bf16_f32 v90, v92, v93
    v_cvt_pk_bf16_f32 v91, v94, v95
    buffer_store_dwordx4 v[88:91], v223, s[40:43], s61 offen offset:1024 sc1
    v_max_f32 v96, 0, v96
    v_max_f32 v97, 0, v97
    v_max_f32 v98, 0, v98
    v_max_f32 v99, 0, v99
    v_max_f32 v100, 0, v100
    v_max_f32 v101, 0, v101
    v_max_f32 v102, 0, v102
    v_max_f32 v103, 0, v103
    v_cvt_pk_bf16_f32 v96, v96, v97
    v_cvt_pk_bf16_f32 v97, v98, v99
    v_cvt_pk_bf16_f32 v98, v100, v101
    v_cvt_pk_bf16_f32 v99, v102, v103
    buffer_store_dwordx4 v[96:99], v223, s[40:43], s60 offen offset:2048 sc1
    v_max_f32 v104, 0, v104
    v_max_f32 v105, 0, v105
    v_max_f32 v106, 0, v106
    v_max_f32 v107, 0, v107
    v_max_f32 v108, 0, v108
    v_max_f32 v109, 0, v109
    v_max_f32 v110, 0, v110
    v_max_f32 v111, 0, v111
    v_cvt_pk_bf16_f32 v104, v104, v105
    v_cvt_pk_bf16_f32 v105, v106, v107
    v_cvt_pk_bf16_f32 v106, v108, v109
    v_cvt_pk_bf16_f32 v107, v110, v111
    buffer_store_dwordx4 v[104:107], v223, s[40:43], s61 offen offset:2048 sc1
    v_mov_b32 v245, 9
    ds_write_b32 v231, v245
    s_waitcnt vmcnt(0)
    s_branch L_CFLAG
L_CQ:
    v_lshrrev_b32 v12, 4, v0
    v_lshlrev_b32 v12, 3, v12
    v_bfe_u32 v15, v0, 2, 2
    v_add_u32 v12, v12, v15
    v_lshlrev_b32 v12, 7, v12
    v_bfe_u32 v13, v0, 3, 2
    v_lshlrev_b32 v13, 5, v13
    v_and_b32 v14, 3, v0
    v_lshlrev_b32 v14, 3, v14
    s_cmp_eq_u32 s50, 7
    s_cselect_b32 s58, 16, 0
    v_add_u32 v14, s58, v14
    v_add_u32 v190, 0, v14
    v_min_u32 v190, 120, v190
    v_xor_b32 v190, v190, v13
    v_add_u32 v190, v190, v12
    v_add_u32 v191, 32, v14
    v_min_u32 v191, 120, v191
    v_xor_b32 v191, v191, v13
    v_add_u32 v191, v191, v12
    v_add_u32 v192, 56, v14
    v_min_u32 v192, 120, v192
    v_xor_b32 v192, v192, v13
    v_add_u32 v192, v192, v12
    v_add_u32 v193, 88, v14
    v_min_u32 v193, 120, v193
    v_xor_b32 v193, v193, v13
    v_add_u32 v193, v193, v12
    s_bitcmp1_b32 s57, 0
    s_cselect_b64 vcc, -1, 0
    s_lshr_b32 s58, s57, 1
    s_add_u32 s58, s58, 1
    s_lshl_b32 s58, s58, 13
    v_cndmask_b32 v194, v190, v192, vcc
    v_cndmask_b32 v195, v191, v193, vcc
    v_add_u32 v194, s58, v194
    v_add_u32 v195, s58, v195
    s_lshl_b32 s58, s57, 8
    s_add_u32 s58, s58, 512
    v_add_u32 v225, s58, v224
    v_cmp_gt_u32 vcc, 48, v0
    s_nop 1
    v_cndmask_b32 v222, 0, -1, vcc
    v_lshlrev_b32 v13, 2, v10
    v_sub_u32 v13, v11, v13
    v_mov_b32 v15, 0xf149f2ca
    v_add_u32 v14, 16, v13
    v_and_b32 v14, -15, v14
    v_cmp_eq_u32 vcc, 0, v14
    s_nop 1
    v_cndmask_b32 v232, v15, 0, vcc
    v_add_u32 v14, 0, v13
    v_and_b32 v14, -15, v14
    v_cmp_eq_u32 vcc, 0, v14
    s_nop 1
    v_cndmask_b32 v236, v15, 0, vcc
    v_add_u32 v14, 15, v13
    v_and_b32 v14, -15, v14
    v_cmp_eq_u32 vcc, 0, v14
    s_nop 1
    v_cndmask_b32 v233, v15, 0, vcc
    v_add_u32 v14, -1, v13
    v_and_b32 v14, -15, v14
    v_cmp_eq_u32 vcc, 0, v14
    s_nop 1
    v_cndmask_b32 v237, v15, 0, vcc
    v_add_u32 v14, 14, v13
    v_and_b32 v14, -15, v14
    v_cmp_eq_u32 vcc, 0, v14
    s_nop 1
    v_cndmask_b32 v234, v15, 0, vcc
    v_add_u32 v14, -2, v13
    v_and_b32 v14, -15, v14
    v_cmp_eq_u32 vcc, 0, v14
    s_nop 1
    v_cndmask_b32 v238, v15, 0, vcc
    v_add_u32 v14, 13, v13
    v_and_b32 v14, -15, v14
    v_cmp_eq_u32 vcc, 0, v14
    s_nop 1
    v_cndmask_b32 v235, v15, 0, vcc
    v_add_u32 v14, -3, v13
    v_and_b32 v14, -15, v14
    v_cmp_eq_u32 vcc, 0, v14
    s_nop 1
    v_cndmask_b32 v239, v15, 0, vcc
    s_cmp_eq_u32 s62, 0
    s_cselect_b64 vcc, -1, 0
    v_cndmask_b32 v240, v232, v15, vcc
    v_cndmask_b32 v241, v233, v15, vcc
    v_cndmask_b32 v242, v234, v15, vcc
    v_cndmask_b32 v243, v235, v15, vcc
    v_mul_u32_u24 v13, 56, v11
    v_lshl_add_u32 v13, v10, 3, v13
    s_mul_i32 s58, s57, 1792
    s_add_u32 s59, s58, 142208
    v_add_u32 v226, s59, v13
    s_and_b32 s59, s57, 1
    s_mul_i32 s59, s59, 8064
    s_add_u32 s59, s59, 141312
    v_add_u32 v227, s59, v13
    v_lshrrev_b32 v13, 2, v0
    v_mul_u32_u24 v13, 56, v13
    v_and_b32 v14, 3, v0
    v_lshl_add_u32 v13, v14, 3, v13
    s_add_u32 s58, s58, 141312
    v_add_u32 v228, s58, v13
    s_lshl_b32 s58, s57, 11
    s_add_u32 s58, s58, 24576
    v_add_u32 v229, s58, v223
    s_add_u32 s59, s58, 2048
    s_cmp_eq_u32 s57, 3
    s_cselect_b32 s59, 135168, s59
    v_add_u32 v216, s59, v223
    v_add_u32 v13, 32, v227
    v_mov_b32 v14, 163712
    v_cmp_gt_u32 vcc, 48, v0
    s_nop 1
    v_cndmask_b32 v13, v14, v13, vcc
    s_lshl_b32 s58, s57, 10
    s_add_u32 s58, s58, 24576
    v_add_u32 v14, s58, v223
    v_add_u32 v15, 8, v14
    s_cmp_ge_u32 s57, 2
    s_cselect_b64 vcc, -1, 0
    v_cndmask_b32 v217, v14, v227, vcc
    v_cndmask_b32 v218, v15, v13, vcc
    v_and_b32 v13, 1, v0
    v_lshlrev_b32 v13, 4, v13
    v_mov_b32 v14, 0xffff
    v_lshlrev_b32 v219, v13, v14
    v_mov_b32 v104, 0x3f803f80
    v_mov_b32 v105, 0x3f803f80
    v_mov_b32 v106, 0x3f803f80
    v_mov_b32 v107, 0x3f803f80
    v_add_u32 v184, 49152, v190
    v_add_u32 v185, 49152, v191
    v_add_u32 v186, 49152, v192
    v_add_u32 v187, 49152, v193
    v_add_u32 v188, 49152, v194
    v_add_u32 v189, 49152, v195
    s_waitcnt lgkmcnt(0)
    s_mul_i32 s56, s56, 0x9e3779b1
    s_add_u32 s56, s56, 0x7f4a7c15
    s_waitcnt vmcnt(0)
    v_lshlrev_b32 v32, 16, v20
    v_and_b32 v33, 0xffff0000, v20
    v_lshlrev_b32 v34, 16, v21
    v_and_b32 v35, 0xffff0000, v21
    v_lshlrev_b32 v36, 16, v22
    v_and_b32 v37, 0xffff0000, v22
    v_lshlrev_b32 v38, 16, v23
    v_and_b32 v39, 0xffff0000, v23
    v_lshlrev_b32 v40, 16, v24
    v_and_b32 v41, 0xffff0000, v24
    v_lshlrev_b32 v42, 16, v25
    v_and_b32 v43, 0xffff0000, v25
    v_lshlrev_b32 v44, 16, v26
    v_and_b32 v45, 0xffff0000, v26
    v_lshlrev_b32 v46, 16, v27
    v_and_b32 v47, 0xffff0000, v27
    v_add_f32 v28, v32, v33
    v_add_f32 v29, v34, v35
    v_add_f32 v28, v28, v36
    v_add_f32 v29, v29, v37
    v_add_f32 v28, v28, v38
    v_add_f32 v29, v29, v39
    v_add_f32 v28, v28, v40
    v_add_f32 v29, v29, v41
    v_add_f32 v28, v28, v42
    v_add_f32 v29, v29, v43
    v_add_f32 v28, v28, v44
    v_add_f32 v29, v29, v45
    v_add_f32 v28, v28, v46
    v_add_f32 v29, v29, v47
    v_add_f32 v28, v28, v29
    s_nop 1
    v_add_f32_dpp v28, v28, v28 row_ror:8 row_mask:0xf bank_mask:0xf
    s_nop 1
    v_add_f32_dpp v28, v28, v28 row_ror:4 row_mask:0xf bank_mask:0xf
    s_nop 1
    v_add_f32_dpp v28, v28, v28 row_ror:2 row_mask:0xf bank_mask:0xf
    s_nop 1
    v_add_f32_dpp v28, v28, v28 row_ror:1 row_mask:0xf bank_mask:0xf
    v_mov_b32 v29, v28
    s_nop 1
    v_permlane16_swap_b32 v29, v28
    v_add_f32 v28, v28, v29
    v_mul_f32 v28, 0x3b124925, v28
    v_sub_f32 v32, v32, v28
    v_sub_f32 v33, v33, v28
    v_sub_f32 v34, v34, v28
    v_sub_f32 v35, v35, v28
    v_sub_f32 v36, v36, v28
    v_sub_f32 v37, v37, v28
    v_sub_f32 v38, v38, v28
    v_sub_f32 v39, v39, v28
    v_sub_f32 v40, v40, v28
    v_sub_f32 v41, v41, v28
    v_sub_f32 v42, v42, v28
    v_sub_f32 v43, v43, v28
    v_sub_f32 v44, v44, v28
    v_sub_f32 v45, v45, v28
    v_sub_f32 v46, v46, v28
    v_sub_f32 v47, v47, v28
    v_mul_f32 v30, v32, v32
    v_mul_f32 v31, v33, v33
    v_fmac_f32 v30, v34, v34
    v_fmac_f32 v31, v35, v35
    v_fmac_f32 v30, v36, v36
    v_fmac_f32 v31, v37, v37
    v_fmac_f32 v30, v38, v38
    v_fmac_f32 v31, v39, v39
    v_fmac_f32 v30, v40, v40
    v_fmac_f32 v31, v41, v41
    v_fmac_f32 v30, v42, v42
    v_fmac_f32 v31, v43, v43
    v_fmac_f32 v30, v44, v44
    v_fmac_f32 v31, v45, v45
    v_fmac_f32 v30, v46, v46
    v_fmac_f32 v31, v47, v47
    v_add_f32 v30, v30, v31
    v_mul_f32 v30, v30, v19
    s_nop 1
    v_add_f32_dpp v30, v30, v30 row_ror:8 row_mask:0xf bank_mask:0xf
    s_nop 1
    v_add_f32_dpp v30, v30, v30 row_ror:4 row_mask:0xf bank_mask:0xf
    s_nop 1
    v_add_f32_dpp v30, v30, v30 row_ror:2 row_mask:0xf bank_mask:0xf
    s_nop 1
    v_add_f32_dpp v30, v30, v30 row_ror:1 row_mask:0xf bank_mask:0xf
    v_mov_b32 v29, v30
    s_nop 1
    v_permlane16_swap_b32 v29, v30
    v_add_f32 v30, v30, v29
    v_mul_f32 v30, 0x3b124925, v30
    v_cvt_pk_bf16_f32 v30, 0, v30
    v_add_f32 v30, 0x3727c5ac, v30
    v_cvt_pk_bf16_f32 v30, 0, v30
    v_sqrt_f32 v30, v30
    v_cvt_pk_bf16_f32 v28, -v28, -v28
    v_cvt_pk_bf16_f32 v30, 0, v30
    v_mov_b32 v29, s56
    v_mov_b32 v31, s56
    v_lshlrev_b32 v32, 4, v17
    s_lshl_b32 s61, s61, 4
    s_add_u32 s61, s61, 16384
    s_mov_b32 exec_lo, 1
    s_mov_b32 exec_hi, 1
    buffer_store_dwordx4 v[28:31], v32, s[40:43], s61 offen sc1
    s_mov_b64 exec, -1
    s_setprio 0
    s_barrier
    ds_read_b128 v[144:147], v180 offset:0
    ds_read_b128 v[148:151], v180 offset:2048
    ds_read_b64_tr_b16 v[112:113], v184 offset:8192
    ds_read_b64_tr_b16 v[114:115], v184 offset:8704
    ds_read_b64_tr_b16 v[116:117], v185 offset:8192
    ds_read_b64_tr_b16 v[118:119], v185 offset:8704
    ds_read_b64_tr_b16 v[120:121], v184 offset:16384
    ds_read_b64_tr_b16 v[122:123], v184 offset:16896
    ds_read_b64_tr_b16 v[124:125], v185 offset:16384
    ds_read_b64_tr_b16 v[126:127], v185 offset:16896
    ds_read_b64_tr_b16 v[128:129], v186 offset:8192
    ds_read_b64_tr_b16 v[130:131], v186 offset:8704
    s_waitcnt lgkmcnt(6)
    v_mfma_f32_16x16x32_bf16 v[0:3], v[112:115], v[144:147], 0
    ds_read_b64_tr_b16 v[132:133], v187 offset:8192
    v_mfma_f32_16x16x32_bf16 v[8:11], v[112:115], v[148:151], 0
    ds_read_b64_tr_b16 v[134:135], v187 offset:8704
    v_mfma_f32_16x16x32_bf16 v[4:7], v[116:119], v[144:147], 0
    ds_read_b64_tr_b16 v[136:137], v186 offset:16384
    v_mfma_f32_16x16x32_bf16 v[12:15], v[116:119], v[148:151], 0
    ds_read_b64_tr_b16 v[138:139], v186 offset:16896
    s_waitcnt lgkmcnt(6)
    v_mfma_f32_16x16x32_bf16 v[16:19], v[120:123], v[144:147], 0
    ds_read_b64_tr_b16 v[140:141], v187 offset:16384
    v_mfma_f32_16x16x32_bf16 v[24:27], v[120:123], v[148:151], 0
    ds_read_b64_tr_b16 v[142:143], v187 offset:16896
    v_mfma_f32_16x16x32_bf16 v[20:23], v[124:127], v[144:147], 0
    ds_read_b128 v[168:171], v182 offset:6144
    ds_read_b64_tr_b16 v[112:113], v188 offset:0
    v_mfma_f32_16x16x32_bf16 v[28:31], v[124:127], v[148:151], 0
    ds_read_b64_tr_b16 v[114:115], v188 offset:512
    s_waitcnt lgkmcnt(7)
    v_mfma_f32_16x16x32_bf16 v[32:35], v[128:131], v[144:147], 0
    ds_read_b64_tr_b16 v[116:117], v189 offset:0
    v_mfma_f32_16x16x32_bf16 v[40:43], v[128:131], v[148:151], 0
    ds_read_b64_tr_b16 v[118:119], v189 offset:512
    v_mfma_f32_16x16x32_bf16 v[36:39], v[132:135], v[144:147], 0
    ds_read_b64_tr_b16 v[120:121], v184 offset:0
    v_mfma_f32_16x16x32_bf16 v[44:47], v[132:135], v[148:151], 0
    ds_read_b64_tr_b16 v[122:123], v184 offset:512
    s_waitcnt lgkmcnt(7)
    v_mfma_f32_16x16x32_bf16 v[48:51], v[136:139], v[144:147], 0
    ds_read_b64_tr_b16 v[124:125], v185 offset:0
    v_mfma_f32_16x16x32_bf16 v[56:59], v[136:139], v[148:151], 0
    ds_read_b64_tr_b16 v[126:127], v185 offset:512
    v_mfma_f32_16x16x32_bf16 v[52:55], v[140:143], v[144:147], 0
    ds_read_b64_tr_b16 v[128:129], v186 offset:0
    v_mfma_f32_16x16x32_bf16 v[60:63], v[140:143], v[148:151], 0
    ds_read_b64_tr_b16 v[130:131], v186 offset:512
    s_waitcnt lgkmcnt(6)
    v_mfma_f32_16x16x32_bf16 v[96:99], v[112:115], v[168:171], 0
    ds_read_b64_tr_b16 v[132:133], v187 offset:0
    ds_read_b64_tr_b16 v[134:135], v187 offset:512
    v_mfma_f32_16x16x32_bf16 v[100:103], v[116:119], v[168:171], 0
    ds_read_b128 v[152:155], v181 offset:0
    ds_read_b128 v[156:159], v181 offset:2048
    ds_read_b64_tr_b16 v[136:137], v184 offset:12288
    ds_read_b64_tr_b16 v[138:139], v184 offset:12800
    s_waitcnt lgkmcnt(8)
    v_mfma_f32_16x16x32_bf16 v[64:67], v[120:123], v[144:147], 0
    ds_read_b64_tr_b16 v[140:141], v185 offset:12288
    v_mfma_f32_16x16x32_bf16 v[72:75], v[120:123], v[148:151], 0
    ds_read_b64_tr_b16 v[142:143], v185 offset:12800
    v_mfma_f32_16x16x32_bf16 v[68:71], v[124:127], v[144:147], 0
    ds_read_b64_tr_b16 v[112:113], v184 offset:20480
    v_mfma_f32_16x16x32_bf16 v[76:79], v[124:127], v[148:151], 0
    ds_read_b64_tr_b16 v[114:115], v184 offset:20992
    s_waitcnt lgkmcnt(8)
    v_mfma_f32_16x16x32_bf16 v[80:83], v[128:131], v[144:147], 0
    ds_read_b64_tr_b16 v[116:117], v185 offset:20480
    v_mfma_f32_16x16x32_bf16 v[88:91], v[128:131], v[148:151], 0
    ds_read_b64_tr_b16 v[118:119], v185 offset:20992
    v_mfma_f32_16x16x32_bf16 v[84:87], v[132:135], v[144:147], 0
    ds_read_b64_tr_b16 v[120:121], v186 offset:12288
    v_mfma_f32_16x16x32_bf16 v[92:95], v[132:135], v[148:151], 0
    ds_read_b64_tr_b16 v[122:123], v186 offset:12800
    s_waitcnt lgkmcnt(6)
    v_mfma_f32_16x16x32_bf16 v[0:3], v[136:139], v[152:155], v[0:3]
    ds_read_b64_tr_b16 v[124:125], v187 offset:12288
    v_mfma_f32_16x16x32_bf16 v[8:11], v[136:139], v[156:159], v[8:11]
    ds_read_b64_tr_b16 v[126:127], v187 offset:12800
    v_mfma_f32_16x16x32_bf16 v[4:7], v[140:143], v[152:155], v[4:7]
    ds_read_b64_tr_b16 v[128:129], v186 offset:20480
    v_mfma_f32_16x16x32_bf16 v[12:15], v[140:143], v[156:159], v[12:15]
    ds_read_b64_tr_b16 v[130:131], v186 offset:20992
    s_waitcnt lgkmcnt(6)
    v_mfma_f32_16x16x32_bf16 v[16:19], v[112:115], v[152:155], v[16:19]
    ds_read_b64_tr_b16 v[132:133], v187 offset:20480
    v_mfma_f32_16x16x32_bf16 v[24:27], v[112:115], v[156:159], v[24:27]
    ds_read_b64_tr_b16 v[134:135], v187 offset:20992
    v_mfma_f32_16x16x32_bf16 v[20:23], v[116:119], v[152:155], v[20:23]
    ds_read_b128 v[172:175], v183 offset:6144
    ds_read_b64_tr_b16 v[136:137], v188 offset:4096
    v_mfma_f32_16x16x32_bf16 v[28:31], v[116:119], v[156:159], v[28:31]
    ds_read_b64_tr_b16 v[138:139], v188 offset:4608
    s_waitcnt lgkmcnt(7)
    v_mfma_f32_16x16x32_bf16 v[32:35], v[120:123], v[152:155], v[32:35]
    ds_read_b64_tr_b16 v[140:141], v189 offset:4096
    v_mfma_f32_16x16x32_bf16 v[40:43], v[120:123], v[156:159], v[40:43]
    ds_read_b64_tr_b16 v[142:143], v189 offset:4608
    v_mfma_f32_16x16x32_bf16 v[36:39], v[124:127], v[152:155], v[36:39]
    ds_read_b64_tr_b16 v[112:113], v184 offset:4096
    v_mfma_f32_16x16x32_bf16 v[44:47], v[124:127], v[156:159], v[44:47]
    ds_read_b64_tr_b16 v[114:115], v184 offset:4608
    s_waitcnt lgkmcnt(7)
    v_mfma_f32_16x16x32_bf16 v[48:51], v[128:131], v[152:155], v[48:51]
    ds_read_b64_tr_b16 v[116:117], v185 offset:4096
    v_mfma_f32_16x16x32_bf16 v[56:59], v[128:131], v[156:159], v[56:59]
    ds_read_b64_tr_b16 v[118:119], v185 offset:4608
    v_mfma_f32_16x16x32_bf16 v[52:55], v[132:135], v[152:155], v[52:55]
    ds_read_b64_tr_b16 v[120:121], v186 offset:4096
    v_mfma_f32_16x16x32_bf16 v[60:63], v[132:135], v[156:159], v[60:63]
    ds_read_b64_tr_b16 v[122:123], v186 offset:4608
    s_waitcnt lgkmcnt(6)
    v_mfma_f32_16x16x32_bf16 v[96:99], v[136:139], v[172:175], v[96:99]
    ds_read_b64_tr_b16 v[124:125], v187 offset:4096
    ds_read_b64_tr_b16 v[126:127], v187 offset:4608
    v_mfma_f32_16x16x32_bf16 v[100:103], v[140:143], v[172:175], v[100:103]
    s_waitcnt lgkmcnt(4)
    v_mfma_f32_16x16x32_bf16 v[64:67], v[112:115], v[152:155], v[64:67]
    v_mfma_f32_16x16x32_bf16 v[72:75], v[112:115], v[156:159], v[72:75]
    v_mfma_f32_16x16x32_bf16 v[68:71], v[116:119], v[152:155], v[68:71]
    v_add_u32 v184, 77824, v190
    v_add_u32 v185, 77824, v191
    v_add_u32 v186, 77824, v192
    v_add_u32 v187, 77824, v193
    v_add_u32 v188, 77824, v194
    v_add_u32 v189, 77824, v195
    s_waitcnt lgkmcnt(0)
    s_barrier
    ds_read_b128 v[144:147], v180 offset:16384
    ds_read_b128 v[148:151], v180 offset:18432
    ds_read_b64_tr_b16 v[128:129], v184 offset:8192
    ds_read_b64_tr_b16 v[130:131], v184 offset:8704
    ds_read_b64_tr_b16 v[132:133], v185 offset:8192
    ds_read_b64_tr_b16 v[134:135], v185 offset:8704
    ds_read_b64_tr_b16 v[136:137], v184 offset:16384
    ds_read_b64_tr_b16 v[138:139], v184 offset:16896
    v_mfma_f32_16x16x32_bf16 v[76:79], v[116:119], v[156:159], v[76:79]
    v_mfma_f32_16x16x32_bf16 v[80:83], v[120:123], v[152:155], v[80:83]
    ds_read_b64_tr_b16 v[140:141], v185 offset:16384
    v_mfma_f32_16x16x32_bf16 v[88:91], v[120:123], v[156:159], v[88:91]
    ds_read_b64_tr_b16 v[142:143], v185 offset:16896
    v_mfma_f32_16x16x32_bf16 v[84:87], v[124:127], v[152:155], v[84:87]
    ds_read_b64_tr_b16 v[112:113], v186 offset:8192
    v_mfma_f32_16x16x32_bf16 v[92:95], v[124:127], v[156:159], v[92:95]
    ds_read_b64_tr_b16 v[114:115], v186 offset:8704
    s_waitcnt lgkmcnt(6)
    v_mfma_f32_16x16x32_bf16 v[0:3], v[128:131], v[144:147], v[0:3]
    ds_read_b64_tr_b16 v[116:117], v187 offset:8192
    v_mfma_f32_16x16x32_bf16 v[8:11], v[128:131], v[148:151], v[8:11]
    ds_read_b64_tr_b16 v[118:119], v187 offset:8704
    v_mfma_f32_16x16x32_bf16 v[4:7], v[132:135], v[144:147], v[4:7]
    ds_read_b64_tr_b16 v[120:121], v186 offset:16384
    v_mfma_f32_16x16x32_bf16 v[12:15], v[132:135], v[148:151], v[12:15]
    ds_read_b64_tr_b16 v[122:123], v186 offset:16896
    s_waitcnt lgkmcnt(6)
    v_mfma_f32_16x16x32_bf16 v[16:19], v[136:139], v[144:147], v[16:19]
    ds_read_b64_tr_b16 v[124:125], v187 offset:16384
    v_mfma_f32_16x16x32_bf16 v[24:27], v[136:139], v[148:151], v[24:27]
    ds_read_b64_tr_b16 v[126:127], v187 offset:16896
    v_mfma_f32_16x16x32_bf16 v[20:23], v[140:143], v[144:147], v[20:23]
    ds_read_b128 v[168:171], v182 offset:8192
    ds_read_b64_tr_b16 v[128:129], v188 offset:0
    v_mfma_f32_16x16x32_bf16 v[28:31], v[140:143], v[148:151], v[28:31]
    ds_read_b64_tr_b16 v[130:131], v188 offset:512
    s_waitcnt lgkmcnt(7)
    v_mfma_f32_16x16x32_bf16 v[32:35], v[112:115], v[144:147], v[32:35]
    ds_read_b64_tr_b16 v[132:133], v189 offset:0
    v_mfma_f32_16x16x32_bf16 v[40:43], v[112:115], v[148:151], v[40:43]
    ds_read_b64_tr_b16 v[134:135], v189 offset:512
    v_mfma_f32_16x16x32_bf16 v[36:39], v[116:119], v[144:147], v[36:39]
    ds_read_b64_tr_b16 v[136:137], v184 offset:0
    v_mfma_f32_16x16x32_bf16 v[44:47], v[116:119], v[148:151], v[44:47]
    ds_read_b64_tr_b16 v[138:139], v184 offset:512
    s_waitcnt lgkmcnt(7)
    v_mfma_f32_16x16x32_bf16 v[48:51], v[120:123], v[144:147], v[48:51]
    ds_read_b64_tr_b16 v[140:141], v185 offset:0
    v_mfma_f32_16x16x32_bf16 v[56:59], v[120:123], v[148:151], v[56:59]
    ds_read_b64_tr_b16 v[142:143], v185 offset:512
    v_mfma_f32_16x16x32_bf16 v[52:55], v[124:127], v[144:147], v[52:55]
    ds_read_b64_tr_b16 v[112:113], v186 offset:0
    v_mfma_f32_16x16x32_bf16 v[60:63], v[124:127], v[148:151], v[60:63]
    ds_read_b64_tr_b16 v[114:115], v186 offset:512
    s_waitcnt lgkmcnt(6)
    v_mfma_f32_16x16x32_bf16 v[96:99], v[128:131], v[168:171], v[96:99]
    ds_read_b64_tr_b16 v[116:117], v187 offset:0
    ds_read_b64_tr_b16 v[118:119], v187 offset:512
    v_mfma_f32_16x16x32_bf16 v[100:103], v[132:135], v[168:171], v[100:103]
    ds_read_b128 v[152:155], v181 offset:16384
    ds_read_b128 v[156:159], v181 offset:18432
    ds_read_b64_tr_b16 v[120:121], v184 offset:12288
    ds_read_b64_tr_b16 v[122:123], v184 offset:12800
    s_waitcnt lgkmcnt(8)
    v_mfma_f32_16x16x32_bf16 v[64:67], v[136:139], v[144:147], v[64:67]
    ds_read_b64_tr_b16 v[124:125], v185 offset:12288
    v_mfma_f32_16x16x32_bf16 v[72:75], v[136:139], v[148:151], v[72:75]
    ds_read_b64_tr_b16 v[126:127], v185 offset:12800
    v_mfma_f32_16x16x32_bf16 v[68:71], v[140:143], v[144:147], v[68:71]
    ds_read_b64_tr_b16 v[128:129], v184 offset:20480
    v_mfma_f32_16x16x32_bf16 v[76:79], v[140:143], v[148:151], v[76:79]
    ds_read_b64_tr_b16 v[130:131], v184 offset:20992
    s_waitcnt lgkmcnt(8)
    v_mfma_f32_16x16x32_bf16 v[80:83], v[112:115], v[144:147], v[80:83]
    ds_read_b64_tr_b16 v[132:133], v185 offset:20480
    v_mfma_f32_16x16x32_bf16 v[88:91], v[112:115], v[148:151], v[88:91]
    ds_read_b64_tr_b16 v[134:135], v185 offset:20992
    v_mfma_f32_16x16x32_bf16 v[84:87], v[116:119], v[144:147], v[84:87]
    ds_read_b64_tr_b16 v[136:137], v186 offset:12288
    v_mfma_f32_16x16x32_bf16 v[92:95], v[116:119], v[148:151], v[92:95]
    ds_read_b64_tr_b16 v[138:139], v186 offset:12800
    s_waitcnt lgkmcnt(6)
    v_mfma_f32_16x16x32_bf16 v[0:3], v[120:123], v[152:155], v[0:3]
    ds_read_b64_tr_b16 v[140:141], v187 offset:12288
    v_mfma_f32_16x16x32_bf16 v[8:11], v[120:123], v[156:159], v[8:11]
    ds_read_b64_tr_b16 v[142:143], v187 offset:12800
    v_mfma_f32_16x16x32_bf16 v[4:7], v[124:127], v[152:155], v[4:7]
    ds_read_b64_tr_b16 v[112:113], v186 offset:20480
    v_mfma_f32_16x16x32_bf16 v[12:15], v[124:127], v[156:159], v[12:15]
    ds_read_b64_tr_b16 v[114:115], v186 offset:20992
    s_waitcnt lgkmcnt(6)
    v_mfma_f32_16x16x32_bf16 v[16:19], v[128:131], v[152:155], v[16:19]
    ds_read_b64_tr_b16 v[116:117], v187 offset:20480
    v_mfma_f32_16x16x32_bf16 v[24:27], v[128:131], v[156:159], v[24:27]
    ds_read_b64_tr_b16 v[118:119], v187 offset:20992
    v_mfma_f32_16x16x32_bf16 v[20:23], v[132:135], v[152:155], v[20:23]
    ds_read_b128 v[172:175], v183 offset:8192
    ds_read_b64_tr_b16 v[120:121], v188 offset:4096
    v_mfma_f32_16x16x32_bf16 v[28:31], v[132:135], v[156:159], v[28:31]
    ds_read_b64_tr_b16 v[122:123], v188 offset:4608
    s_waitcnt lgkmcnt(7)
    v_mfma_f32_16x16x32_bf16 v[32:35], v[136:139], v[152:155], v[32:35]
    ds_read_b64_tr_b16 v[124:125], v189 offset:4096
    v_mfma_f32_16x16x32_bf16 v[40:43], v[136:139], v[156:159], v[40:43]
    ds_read_b64_tr_b16 v[126:127], v189 offset:4608
    v_mfma_f32_16x16x32_bf16 v[36:39], v[140:143], v[152:155], v[36:39]
    ds_read_b64_tr_b16 v[128:129], v184 offset:4096
    v_mfma_f32_16x16x32_bf16 v[44:47], v[140:143], v[156:159], v[44:47]
    ds_read_b64_tr_b16 v[130:131], v184 offset:4608
    s_waitcnt lgkmcnt(7)
    v_mfma_f32_16x16x32_bf16 v[48:51], v[112:115], v[152:155], v[48:51]
    ds_read_b64_tr_b16 v[132:133], v185 offset:4096
    v_mfma_f32_16x16x32_bf16 v[56:59], v[112:115], v[156:159], v[56:59]
    ds_read_b64_tr_b16 v[134:135], v185 offset:4608
    v_mfma_f32_16x16x32_bf16 v[52:55], v[116:119], v[152:155], v[52:55]
    ds_read_b64_tr_b16 v[136:137], v186 offset:4096
    v_mfma_f32_16x16x32_bf16 v[60:63], v[116:119], v[156:159], v[60:63]
    ds_read_b64_tr_b16 v[138:139], v186 offset:4608
    s_waitcnt lgkmcnt(6)
    v_mfma_f32_16x16x32_bf16 v[96:99], v[120:123], v[172:175], v[96:99]
    ds_read_b64_tr_b16 v[140:141], v187 offset:4096
    ds_read_b64_tr_b16 v[142:143], v187 offset:4608
    v_mfma_f32_16x16x32_bf16 v[100:103], v[124:127], v[172:175], v[100:103]
    s_waitcnt lgkmcnt(4)
    v_mfma_f32_16x16x32_bf16 v[64:67], v[128:131], v[152:155], v[64:67]
    v_mfma_f32_16x16x32_bf16 v[72:75], v[128:131], v[156:159], v[72:75]
    v_mfma_f32_16x16x32_bf16 v[68:71], v[132:135], v[152:155], v[68:71]
    v_add_u32 v184, 106496, v190
    v_add_u32 v185, 106496, v191
    v_add_u32 v186, 106496, v192
    v_add_u32 v187, 106496, v193
    v_add_u32 v188, 106496, v194
    v_add_u32 v189, 106496, v195
    s_waitcnt lgkmcnt(0)
    s_barrier
    ds_read_b128 v[144:147], v180 offset:32768
    ds_read_b128 v[148:151], v180 offset:34816
    ds_read_b64_tr_b16 v[112:113], v184 offset:8192
    ds_read_b64_tr_b16 v[114:115], v184 offset:8704
    ds_read_b64_tr_b16 v[116:117], v185 offset:8192
    ds_read_b64_tr_b16 v[118:119], v185 offset:8704
    ds_read_b64_tr_b16 v[120:121], v184 offset:16384
    ds_read_b64_tr_b16 v[122:123], v184 offset:16896
    v_mfma_f32_16x16x32_bf16 v[76:79], v[132:135], v[156:159], v[76:79]
    v_mfma_f32_16x16x32_bf16 v[80:83], v[136:139], v[152:155], v[80:83]
    ds_read_b64_tr_b16 v[124:125], v185 offset:16384
    v_mfma_f32_16x16x32_bf16 v[88:91], v[136:139], v[156:159], v[88:91]
    ds_read_b64_tr_b16 v[126:127], v185 offset:16896
    v_mfma_f32_16x16x32_bf16 v[84:87], v[140:143], v[152:155], v[84:87]
    ds_read_b64_tr_b16 v[128:129], v186 offset:8192
    v_mfma_f32_16x16x32_bf16 v[92:95], v[140:143], v[156:159], v[92:95]
    ds_read_b64_tr_b16 v[130:131], v186 offset:8704
    s_waitcnt lgkmcnt(6)
    v_mfma_f32_16x16x32_bf16 v[0:3], v[112:115], v[144:147], v[0:3]
    ds_read_b64_tr_b16 v[132:133], v187 offset:8192
    v_mfma_f32_16x16x32_bf16 v[8:11], v[112:115], v[148:151], v[8:11]
    ds_read_b64_tr_b16 v[134:135], v187 offset:8704
    v_mfma_f32_16x16x32_bf16 v[4:7], v[116:119], v[144:147], v[4:7]
    ds_read_b64_tr_b16 v[136:137], v186 offset:16384
    v_mfma_f32_16x16x32_bf16 v[12:15], v[116:119], v[148:151], v[12:15]
    ds_read_b64_tr_b16 v[138:139], v186 offset:16896
    s_waitcnt lgkmcnt(6)
    v_mfma_f32_16x16x32_bf16 v[16:19], v[120:123], v[144:147], v[16:19]
    ds_read_b64_tr_b16 v[140:141], v187 offset:16384
    v_mfma_f32_16x16x32_bf16 v[24:27], v[120:123], v[148:151], v[24:27]
    ds_read_b64_tr_b16 v[142:143], v187 offset:16896
    v_mfma_f32_16x16x32_bf16 v[20:23], v[124:127], v[144:147], v[20:23]
    ds_read_b128 v[168:171], v182 offset:10240
    ds_read_b64_tr_b16 v[112:113], v188 offset:0
    v_mfma_f32_16x16x32_bf16 v[28:31], v[124:127], v[148:151], v[28:31]
    ds_read_b64_tr_b16 v[114:115], v188 offset:512
    s_waitcnt lgkmcnt(7)
    v_mfma_f32_16x16x32_bf16 v[32:35], v[128:131], v[144:147], v[32:35]
    ds_read_b64_tr_b16 v[116:117], v189 offset:0
    v_mfma_f32_16x16x32_bf16 v[40:43], v[128:131], v[148:151], v[40:43]
    ds_read_b64_tr_b16 v[118:119], v189 offset:512
    v_mfma_f32_16x16x32_bf16 v[36:39], v[132:135], v[144:147], v[36:39]
    ds_read_b64_tr_b16 v[120:121], v184 offset:0
    v_mfma_f32_16x16x32_bf16 v[44:47], v[132:135], v[148:151], v[44:47]
    ds_read_b64_tr_b16 v[122:123], v184 offset:512
    s_waitcnt lgkmcnt(7)
    v_mfma_f32_16x16x32_bf16 v[48:51], v[136:139], v[144:147], v[48:51]
    ds_read_b64_tr_b16 v[124:125], v185 offset:0
    v_mfma_f32_16x16x32_bf16 v[56:59], v[136:139], v[148:151], v[56:59]
    ds_read_b64_tr_b16 v[126:127], v185 offset:512
    v_mfma_f32_16x16x32_bf16 v[52:55], v[140:143], v[144:147], v[52:55]
    ds_read_b64_tr_b16 v[128:129], v186 offset:0
    v_mfma_f32_16x16x32_bf16 v[60:63], v[140:143], v[148:151], v[60:63]
    ds_read_b64_tr_b16 v[130:131], v186 offset:512
    s_waitcnt lgkmcnt(6)
    v_mfma_f32_16x16x32_bf16 v[96:99], v[112:115], v[168:171], v[96:99]
    ds_read_b64_tr_b16 v[132:133], v187 offset:0
    ds_read_b64_tr_b16 v[134:135], v187 offset:512
    v_mfma_f32_16x16x32_bf16 v[100:103], v[116:119], v[168:171], v[100:103]
    ds_read_b128 v[152:155], v181 offset:32768
    ds_read_b128 v[156:159], v181 offset:34816
    ds_read_b64_tr_b16 v[136:137], v184 offset:12288
    ds_read_b64_tr_b16 v[138:139], v184 offset:12800
    s_waitcnt lgkmcnt(8)
    v_mfma_f32_16x16x32_bf16 v[64:67], v[120:123], v[144:147], v[64:67]
    ds_read_b64_tr_b16 v[140:141], v185 offset:12288
    v_mfma_f32_16x16x32_bf16 v[72:75], v[120:123], v[148:151], v[72:75]
    ds_read_b64_tr_b16 v[142:143], v185 offset:12800
    v_mfma_f32_16x16x32_bf16 v[68:71], v[124:127], v[144:147], v[68:71]
    ds_read_b64_tr_b16 v[112:113], v184 offset:20480
    v_mfma_f32_16x16x32_bf16 v[76:79], v[124:127], v[148:151], v[76:79]
    ds_read_b64_tr_b16 v[114:115], v184 offset:20992
    s_waitcnt lgkmcnt(8)
    v_mfma_f32_16x16x32_bf16 v[80:83], v[128:131], v[144:147], v[80:83]
    ds_read_b64_tr_b16 v[116:117], v185 offset:20480
    v_mfma_f32_16x16x32_bf16 v[88:91], v[128:131], v[148:151], v[88:91]
    ds_read_b64_tr_b16 v[118:119], v185 offset:20992
    v_mfma_f32_16x16x32_bf16 v[84:87], v[132:135], v[144:147], v[84:87]
    ds_read_b64_tr_b16 v[120:121], v186 offset:12288
    v_mfma_f32_16x16x32_bf16 v[92:95], v[132:135], v[148:151], v[92:95]
    ds_read_b64_tr_b16 v[122:123], v186 offset:12800
    s_waitcnt lgkmcnt(6)
    v_mfma_f32_16x16x32_bf16 v[0:3], v[136:139], v[152:155], v[0:3]
    ds_read_b64_tr_b16 v[124:125], v187 offset:12288
    v_mfma_f32_16x16x32_bf16 v[8:11], v[136:139], v[156:159], v[8:11]
    ds_read_b64_tr_b16 v[126:127], v187 offset:12800
    v_mfma_f32_16x16x32_bf16 v[4:7], v[140:143], v[152:155], v[4:7]
    ds_read_b64_tr_b16 v[128:129], v186 offset:20480
    v_mfma_f32_16x16x32_bf16 v[12:15], v[140:143], v[156:159], v[12:15]
    ds_read_b64_tr_b16 v[130:131], v186 offset:20992
    s_waitcnt lgkmcnt(6)
    v_mfma_f32_16x16x32_bf16 v[16:19], v[112:115], v[152:155], v[16:19]
    ds_read_b64_tr_b16 v[132:133], v187 offset:20480
    v_mfma_f32_16x16x32_bf16 v[24:27], v[112:115], v[156:159], v[24:27]
    ds_read_b64_tr_b16 v[134:135], v187 offset:20992
    v_mfma_f32_16x16x32_bf16 v[20:23], v[116:119], v[152:155], v[20:23]
    ds_read_b128 v[172:175], v183 offset:10240
    ds_read_b64_tr_b16 v[136:137], v188 offset:4096
    v_mfma_f32_16x16x32_bf16 v[28:31], v[116:119], v[156:159], v[28:31]
    ds_read_b64_tr_b16 v[138:139], v188 offset:4608
    s_waitcnt lgkmcnt(7)
    v_mfma_f32_16x16x32_bf16 v[32:35], v[120:123], v[152:155], v[32:35]
    ds_read_b64_tr_b16 v[140:141], v189 offset:4096
    v_mfma_f32_16x16x32_bf16 v[40:43], v[120:123], v[156:159], v[40:43]
    ds_read_b64_tr_b16 v[142:143], v189 offset:4608
    v_mfma_f32_16x16x32_bf16 v[36:39], v[124:127], v[152:155], v[36:39]
    ds_read_b64_tr_b16 v[112:113], v184 offset:4096
    v_mfma_f32_16x16x32_bf16 v[44:47], v[124:127], v[156:159], v[44:47]
    ds_read_b64_tr_b16 v[114:115], v184 offset:4608
    s_waitcnt lgkmcnt(7)
    v_mfma_f32_16x16x32_bf16 v[48:51], v[128:131], v[152:155], v[48:51]
    ds_read_b64_tr_b16 v[116:117], v185 offset:4096
    v_mfma_f32_16x16x32_bf16 v[56:59], v[128:131], v[156:159], v[56:59]
    ds_read_b64_tr_b16 v[118:119], v185 offset:4608
    v_mfma_f32_16x16x32_bf16 v[52:55], v[132:135], v[152:155], v[52:55]
    ds_read_b64_tr_b16 v[120:121], v186 offset:4096
    v_mfma_f32_16x16x32_bf16 v[60:63], v[132:135], v[156:159], v[60:63]
    ds_read_b64_tr_b16 v[122:123], v186 offset:4608
    s_waitcnt lgkmcnt(6)
    v_mfma_f32_16x16x32_bf16 v[96:99], v[136:139], v[172:175], v[96:99]
    ds_read_b64_tr_b16 v[124:125], v187 offset:4096
    ds_read_b64_tr_b16 v[126:127], v187 offset:4608
    v_mfma_f32_16x16x32_bf16 v[100:103], v[140:143], v[172:175], v[100:103]
    s_waitcnt lgkmcnt(4)
    v_mfma_f32_16x16x32_bf16 v[64:67], v[112:115], v[152:155], v[64:67]
    v_mfma_f32_16x16x32_bf16 v[72:75], v[112:115], v[156:159], v[72:75]
    v_mfma_f32_16x16x32_bf16 v[68:71], v[116:119], v[152:155], v[68:71]
    v_add_u32 v184, 49152, v190
    v_add_u32 v185, 49152, v191
    v_add_u32 v186, 49152, v192
    v_add_u32 v187, 49152, v193
    v_add_u32 v188, 49152, v194
    v_add_u32 v189, 49152, v195
    s_waitcnt lgkmcnt(0)
    s_barrier
    ds_read_b128 v[144:147], v180 offset:0
    ds_read_b128 v[148:151], v180 offset:2048
    ds_read_b64_tr_b16 v[128:129], v184 offset:8192
    ds_read_b64_tr_b16 v[130:131], v184 offset:8704
    ds_read_b64_tr_b16 v[132:133], v185 offset:8192
    ds_read_b64_tr_b16 v[134:135], v185 offset:8704
    ds_read_b64_tr_b16 v[136:137], v184 offset:16384
    ds_read_b64_tr_b16 v[138:139], v184 offset:16896
    v_mfma_f32_16x16x32_bf16 v[76:79], v[116:119], v[156:159], v[76:79]
    v_mfma_f32_16x16x32_bf16 v[80:83], v[120:123], v[152:155], v[80:83]
    ds_read_b64_tr_b16 v[140:141], v185 offset:16384
    v_mfma_f32_16x16x32_bf16 v[88:91], v[120:123], v[156:159], v[88:91]
    ds_read_b64_tr_b16 v[142:143], v185 offset:16896
    v_mfma_f32_16x16x32_bf16 v[84:87], v[124:127], v[152:155], v[84:87]
    ds_read_b64_tr_b16 v[112:113], v186 offset:8192
    v_mfma_f32_16x16x32_bf16 v[92:95], v[124:127], v[156:159], v[92:95]
    ds_read_b64_tr_b16 v[114:115], v186 offset:8704
    s_waitcnt lgkmcnt(6)
    v_mfma_f32_16x16x32_bf16 v[0:3], v[128:131], v[144:147], v[0:3]
    ds_read_b64_tr_b16 v[116:117], v187 offset:8192
    v_mfma_f32_16x16x32_bf16 v[8:11], v[128:131], v[148:151], v[8:11]
    ds_read_b64_tr_b16 v[118:119], v187 offset:8704
    v_mfma_f32_16x16x32_bf16 v[4:7], v[132:135], v[144:147], v[4:7]
    ds_read_b64_tr_b16 v[120:121], v186 offset:16384
    v_mfma_f32_16x16x32_bf16 v[12:15], v[132:135], v[148:151], v[12:15]
    ds_read_b64_tr_b16 v[122:123], v186 offset:16896
    s_waitcnt lgkmcnt(6)
    v_mfma_f32_16x16x32_bf16 v[16:19], v[136:139], v[144:147], v[16:19]
    ds_read_b64_tr_b16 v[124:125], v187 offset:16384
    v_mfma_f32_16x16x32_bf16 v[24:27], v[136:139], v[148:151], v[24:27]
    ds_read_b64_tr_b16 v[126:127], v187 offset:16896
    v_mfma_f32_16x16x32_bf16 v[20:23], v[140:143], v[144:147], v[20:23]
    ds_read_b128 v[168:171], v182 offset:12288
    ds_read_b64_tr_b16 v[128:129], v188 offset:0
    v_mfma_f32_16x16x32_bf16 v[28:31], v[140:143], v[148:151], v[28:31]
    ds_read_b64_tr_b16 v[130:131], v188 offset:512
    s_waitcnt lgkmcnt(7)
    v_mfma_f32_16x16x32_bf16 v[32:35], v[112:115], v[144:147], v[32:35]
    ds_read_b64_tr_b16 v[132:133], v189 offset:0
    v_mfma_f32_16x16x32_bf16 v[40:43], v[112:115], v[148:151], v[40:43]
    ds_read_b64_tr_b16 v[134:135], v189 offset:512
    v_mfma_f32_16x16x32_bf16 v[36:39], v[116:119], v[144:147], v[36:39]
    ds_read_b64_tr_b16 v[136:137], v184 offset:0
    v_mfma_f32_16x16x32_bf16 v[44:47], v[116:119], v[148:151], v[44:47]
    ds_read_b64_tr_b16 v[138:139], v184 offset:512
    s_waitcnt lgkmcnt(7)
    v_mfma_f32_16x16x32_bf16 v[48:51], v[120:123], v[144:147], v[48:51]
    ds_read_b64_tr_b16 v[140:141], v185 offset:0
    v_mfma_f32_16x16x32_bf16 v[56:59], v[120:123], v[148:151], v[56:59]
    ds_read_b64_tr_b16 v[142:143], v185 offset:512
    v_mfma_f32_16x16x32_bf16 v[52:55], v[124:127], v[144:147], v[52:55]
    ds_read_b64_tr_b16 v[112:113], v186 offset:0
    v_mfma_f32_16x16x32_bf16 v[60:63], v[124:127], v[148:151], v[60:63]
    ds_read_b64_tr_b16 v[114:115], v186 offset:512
    s_waitcnt lgkmcnt(6)
    v_mfma_f32_16x16x32_bf16 v[96:99], v[128:131], v[168:171], v[96:99]
    ds_read_b64_tr_b16 v[116:117], v187 offset:0
    ds_read_b64_tr_b16 v[118:119], v187 offset:512
    v_mfma_f32_16x16x32_bf16 v[100:103], v[132:135], v[168:171], v[100:103]
    ds_read_b128 v[152:155], v181 offset:0
    ds_read_b128 v[156:159], v181 offset:2048
    ds_read_b64_tr_b16 v[120:121], v184 offset:12288
    ds_read_b64_tr_b16 v[122:123], v184 offset:12800
    s_waitcnt lgkmcnt(8)
    v_mfma_f32_16x16x32_bf16 v[64:67], v[136:139], v[144:147], v[64:67]
    ds_read_b64_tr_b16 v[124:125], v185 offset:12288
    v_mfma_f32_16x16x32_bf16 v[72:75], v[136:139], v[148:151], v[72:75]
    ds_read_b64_tr_b16 v[126:127], v185 offset:12800
    v_mfma_f32_16x16x32_bf16 v[68:71], v[140:143], v[144:147], v[68:71]
    ds_read_b64_tr_b16 v[128:129], v184 offset:20480
    v_mfma_f32_16x16x32_bf16 v[76:79], v[140:143], v[148:151], v[76:79]
    ds_read_b64_tr_b16 v[130:131], v184 offset:20992
    s_waitcnt lgkmcnt(8)
    v_mfma_f32_16x16x32_bf16 v[80:83], v[112:115], v[144:147], v[80:83]
    ds_read_b64_tr_b16 v[132:133], v185 offset:20480
    v_mfma_f32_16x16x32_bf16 v[88:91], v[112:115], v[148:151], v[88:91]
    ds_read_b64_tr_b16 v[134:135], v185 offset:20992
    v_mfma_f32_16x16x32_bf16 v[84:87], v[116:119], v[144:147], v[84:87]
    ds_read_b64_tr_b16 v[136:137], v186 offset:12288
    v_mfma_f32_16x16x32_bf16 v[92:95], v[116:119], v[148:151], v[92:95]
    ds_read_b64_tr_b16 v[138:139], v186 offset:12800
    s_waitcnt lgkmcnt(6)
    v_mfma_f32_16x16x32_bf16 v[0:3], v[120:123], v[152:155], v[0:3]
    ds_read_b64_tr_b16 v[140:141], v187 offset:12288
    v_mfma_f32_16x16x32_bf16 v[8:11], v[120:123], v[156:159], v[8:11]
    ds_read_b64_tr_b16 v[142:143], v187 offset:12800
    v_mfma_f32_16x16x32_bf16 v[4:7], v[124:127], v[152:155], v[4:7]
    ds_read_b64_tr_b16 v[112:113], v186 offset:20480
    v_mfma_f32_16x16x32_bf16 v[12:15], v[124:127], v[156:159], v[12:15]
    ds_read_b64_tr_b16 v[114:115], v186 offset:20992
    s_waitcnt lgkmcnt(6)
    v_mfma_f32_16x16x32_bf16 v[16:19], v[128:131], v[152:155], v[16:19]
    ds_read_b64_tr_b16 v[116:117], v187 offset:20480
    v_mfma_f32_16x16x32_bf16 v[24:27], v[128:131], v[156:159], v[24:27]
    ds_read_b64_tr_b16 v[118:119], v187 offset:20992
    v_mfma_f32_16x16x32_bf16 v[20:23], v[132:135], v[152:155], v[20:23]
    ds_read_b128 v[172:175], v183 offset:12288
    ds_read_b64_tr_b16 v[120:121], v188 offset:4096
    v_mfma_f32_16x16x32_bf16 v[28:31], v[132:135], v[156:159], v[28:31]
    ds_read_b64_tr_b16 v[122:123], v188 offset:4608
    s_waitcnt lgkmcnt(7)
    v_mfma_f32_16x16x32_bf16 v[32:35], v[136:139], v[152:155], v[32:35]
    ds_read_b64_tr_b16 v[124:125], v189 offset:4096
    v_mfma_f32_16x16x32_bf16 v[40:43], v[136:139], v[156:159], v[40:43]
    ds_read_b64_tr_b16 v[126:127], v189 offset:4608
    v_mfma_f32_16x16x32_bf16 v[36:39], v[140:143], v[152:155], v[36:39]
    ds_read_b64_tr_b16 v[128:129], v184 offset:4096
    v_mfma_f32_16x16x32_bf16 v[44:47], v[140:143], v[156:159], v[44:47]
    ds_read_b64_tr_b16 v[130:131], v184 offset:4608
    s_waitcnt lgkmcnt(7)
    v_mfma_f32_16x16x32_bf16 v[48:51], v[112:115], v[152:155], v[48:51]
    ds_read_b64_tr_b16 v[132:133], v185 offset:4096
    v_mfma_f32_16x16x32_bf16 v[56:59], v[112:115], v[156:159], v[56:59]
    ds_read_b64_tr_b16 v[134:135], v185 offset:4608
    v_mfma_f32_16x16x32_bf16 v[52:55], v[116:119], v[152:155], v[52:55]
    ds_read_b64_tr_b16 v[136:137], v186 offset:4096
    v_mfma_f32_16x16x32_bf16 v[60:63], v[116:119], v[156:159], v[60:63]
    ds_read_b64_tr_b16 v[138:139], v186 offset:4608
    s_waitcnt lgkmcnt(6)
    v_mfma_f32_16x16x32_bf16 v[96:99], v[120:123], v[172:175], v[96:99]
    ds_read_b64_tr_b16 v[140:141], v187 offset:4096
    ds_read_b64_tr_b16 v[142:143], v187 offset:4608
    v_mfma_f32_16x16x32_bf16 v[100:103], v[124:127], v[172:175], v[100:103]
    s_waitcnt lgkmcnt(4)
    v_mfma_f32_16x16x32_bf16 v[64:67], v[128:131], v[152:155], v[64:67]
    v_mfma_f32_16x16x32_bf16 v[72:75], v[128:131], v[156:159], v[72:75]
    v_mfma_f32_16x16x32_bf16 v[68:71], v[132:135], v[152:155], v[68:71]
    v_add_u32 v184, 77824, v190
    v_add_u32 v185, 77824, v191
    v_add_u32 v186, 77824, v192
    v_add_u32 v187, 77824, v193
    v_add_u32 v188, 77824, v194
    v_add_u32 v189, 77824, v195
    s_waitcnt lgkmcnt(0)
    s_barrier
    ds_read_b128 v[144:147], v180 offset:16384
    ds_read_b128 v[148:151], v180 offset:18432
    ds_read_b64_tr_b16 v[112:113], v184 offset:8192
    ds_read_b64_tr_b16 v[114:115], v184 offset:8704
    ds_read_b64_tr_b16 v[116:117], v185 offset:8192
    ds_read_b64_tr_b16 v[118:119], v185 offset:8704
    ds_read_b64_tr_b16 v[120:121], v184 offset:16384
    ds_read_b64_tr_b16 v[122:123], v184 offset:16896
    v_mfma_f32_16x16x32_bf16 v[76:79], v[132:135], v[156:159], v[76:79]
    v_mfma_f32_16x16x32_bf16 v[80:83], v[136:139], v[152:155], v[80:83]
    ds_read_b64_tr_b16 v[124:125], v185 offset:16384
    v_mfma_f32_16x16x32_bf16 v[88:91], v[136:139], v[156:159], v[88:91]
    ds_read_b64_tr_b16 v[126:127], v185 offset:16896
    v_mfma_f32_16x16x32_bf16 v[84:87], v[140:143], v[152:155], v[84:87]
    ds_read_b64_tr_b16 v[128:129], v186 offset:8192
    v_mfma_f32_16x16x32_bf16 v[92:95], v[140:143], v[156:159], v[92:95]
    ds_read_b64_tr_b16 v[130:131], v186 offset:8704
    s_waitcnt lgkmcnt(6)
    v_mfma_f32_16x16x32_bf16 v[0:3], v[112:115], v[144:147], v[0:3]
    ds_read_b64_tr_b16 v[132:133], v187 offset:8192
    v_mfma_f32_16x16x32_bf16 v[8:11], v[112:115], v[148:151], v[8:11]
    ds_read_b64_tr_b16 v[134:135], v187 offset:8704
    v_mfma_f32_16x16x32_bf16 v[4:7], v[116:119], v[144:147], v[4:7]
    ds_read_b64_tr_b16 v[136:137], v186 offset:16384
    v_mfma_f32_16x16x32_bf16 v[12:15], v[116:119], v[148:151], v[12:15]
    ds_read_b64_tr_b16 v[138:139], v186 offset:16896
    s_waitcnt lgkmcnt(6)
    v_mfma_f32_16x16x32_bf16 v[16:19], v[120:123], v[144:147], v[16:19]
    ds_read_b64_tr_b16 v[140:141], v187 offset:16384
    v_mfma_f32_16x16x32_bf16 v[24:27], v[120:123], v[148:151], v[24:27]
    ds_read_b64_tr_b16 v[142:143], v187 offset:16896
    v_mfma_f32_16x16x32_bf16 v[20:23], v[124:127], v[144:147], v[20:23]
    ds_read_b128 v[168:171], v182 offset:0
    ds_read_b64_tr_b16 v[112:113], v188 offset:0
    v_mfma_f32_16x16x32_bf16 v[28:31], v[124:127], v[148:151], v[28:31]
    ds_read_b64_tr_b16 v[114:115], v188 offset:512
    s_waitcnt lgkmcnt(7)
    v_mfma_f32_16x16x32_bf16 v[32:35], v[128:131], v[144:147], v[32:35]
    ds_read_b64_tr_b16 v[116:117], v189 offset:0
    v_mfma_f32_16x16x32_bf16 v[40:43], v[128:131], v[148:151], v[40:43]
    ds_read_b64_tr_b16 v[118:119], v189 offset:512
    v_mfma_f32_16x16x32_bf16 v[36:39], v[132:135], v[144:147], v[36:39]
    ds_read_b64_tr_b16 v[120:121], v184 offset:0
    v_mfma_f32_16x16x32_bf16 v[44:47], v[132:135], v[148:151], v[44:47]
    ds_read_b64_tr_b16 v[122:123], v184 offset:512
    s_waitcnt lgkmcnt(7)
    v_mfma_f32_16x16x32_bf16 v[48:51], v[136:139], v[144:147], v[48:51]
    ds_read_b64_tr_b16 v[124:125], v185 offset:0
    v_mfma_f32_16x16x32_bf16 v[56:59], v[136:139], v[148:151], v[56:59]
    ds_read_b64_tr_b16 v[126:127], v185 offset:512
    v_mfma_f32_16x16x32_bf16 v[52:55], v[140:143], v[144:147], v[52:55]
    ds_read_b64_tr_b16 v[128:129], v186 offset:0
    v_mfma_f32_16x16x32_bf16 v[60:63], v[140:143], v[148:151], v[60:63]
    ds_read_b64_tr_b16 v[130:131], v186 offset:512
    s_waitcnt lgkmcnt(6)
    v_mfma_f32_16x16x32_bf16 v[96:99], v[112:115], v[168:171], v[96:99]
    ds_read_b64_tr_b16 v[132:133], v187 offset:0
    ds_read_b64_tr_b16 v[134:135], v187 offset:512
    v_mfma_f32_16x16x32_bf16 v[100:103], v[116:119], v[168:171], v[100:103]
    ds_read_b128 v[152:155], v181 offset:16384
    ds_read_b128 v[156:159], v181 offset:18432
    ds_read_b64_tr_b16 v[136:137], v184 offset:12288
    ds_read_b64_tr_b16 v[138:139], v184 offset:12800
    s_waitcnt lgkmcnt(8)
    v_mfma_f32_16x16x32_bf16 v[64:67], v[120:123], v[144:147], v[64:67]
    ds_read_b64_tr_b16 v[140:141], v185 offset:12288
    v_mfma_f32_16x16x32_bf16 v[72:75], v[120:123], v[148:151], v[72:75]
    ds_read_b64_tr_b16 v[142:143], v185 offset:12800
    v_mfma_f32_16x16x32_bf16 v[68:71], v[124:127], v[144:147], v[68:71]
    ds_read_b64_tr_b16 v[112:113], v184 offset:20480
    v_mfma_f32_16x16x32_bf16 v[76:79], v[124:127], v[148:151], v[76:79]
    ds_read_b64_tr_b16 v[114:115], v184 offset:20992
    s_waitcnt lgkmcnt(8)
    v_mfma_f32_16x16x32_bf16 v[80:83], v[128:131], v[144:147], v[80:83]
    ds_read_b64_tr_b16 v[116:117], v185 offset:20480
    v_mfma_f32_16x16x32_bf16 v[88:91], v[128:131], v[148:151], v[88:91]
    ds_read_b64_tr_b16 v[118:119], v185 offset:20992
    v_mfma_f32_16x16x32_bf16 v[84:87], v[132:135], v[144:147], v[84:87]
    ds_read_b64_tr_b16 v[120:121], v186 offset:12288
    v_mfma_f32_16x16x32_bf16 v[92:95], v[132:135], v[148:151], v[92:95]
    ds_read_b64_tr_b16 v[122:123], v186 offset:12800
    s_waitcnt lgkmcnt(6)
    v_mfma_f32_16x16x32_bf16 v[0:3], v[136:139], v[152:155], v[0:3]
    ds_read_b64_tr_b16 v[124:125], v187 offset:12288
    v_mfma_f32_16x16x32_bf16 v[8:11], v[136:139], v[156:159], v[8:11]
    ds_read_b64_tr_b16 v[126:127], v187 offset:12800
    v_mfma_f32_16x16x32_bf16 v[4:7], v[140:143], v[152:155], v[4:7]
    ds_read_b64_tr_b16 v[128:129], v186 offset:20480
    v_mfma_f32_16x16x32_bf16 v[12:15], v[140:143], v[156:159], v[12:15]
    ds_read_b64_tr_b16 v[130:131], v186 offset:20992
    s_waitcnt lgkmcnt(6)
    v_mfma_f32_16x16x32_bf16 v[16:19], v[112:115], v[152:155], v[16:19]
    ds_read_b64_tr_b16 v[132:133], v187 offset:20480
    v_mfma_f32_16x16x32_bf16 v[24:27], v[112:115], v[156:159], v[24:27]
    ds_read_b64_tr_b16 v[134:135], v187 offset:20992
    v_mfma_f32_16x16x32_bf16 v[20:23], v[116:119], v[152:155], v[20:23]
    ds_read_b128 v[172:175], v183 offset:0
    ds_read_b64_tr_b16 v[136:137], v188 offset:4096
    v_mfma_f32_16x16x32_bf16 v[28:31], v[116:119], v[156:159], v[28:31]
    ds_read_b64_tr_b16 v[138:139], v188 offset:4608
    s_waitcnt lgkmcnt(7)
    v_mfma_f32_16x16x32_bf16 v[32:35], v[120:123], v[152:155], v[32:35]
    ds_read_b64_tr_b16 v[140:141], v189 offset:4096
    v_mfma_f32_16x16x32_bf16 v[40:43], v[120:123], v[156:159], v[40:43]
    ds_read_b64_tr_b16 v[142:143], v189 offset:4608
    v_mfma_f32_16x16x32_bf16 v[36:39], v[124:127], v[152:155], v[36:39]
    ds_read_b64_tr_b16 v[112:113], v184 offset:4096
    v_mfma_f32_16x16x32_bf16 v[44:47], v[124:127], v[156:159], v[44:47]
    ds_read_b64_tr_b16 v[114:115], v184 offset:4608
    s_waitcnt lgkmcnt(7)
    v_mfma_f32_16x16x32_bf16 v[48:51], v[128:131], v[152:155], v[48:51]
    ds_read_b64_tr_b16 v[116:117], v185 offset:4096
    v_mfma_f32_16x16x32_bf16 v[56:59], v[128:131], v[156:159], v[56:59]
    ds_read_b64_tr_b16 v[118:119], v185 offset:4608
    v_mfma_f32_16x16x32_bf16 v[52:55], v[132:135], v[152:155], v[52:55]
    ds_read_b64_tr_b16 v[120:121], v186 offset:4096
    v_mfma_f32_16x16x32_bf16 v[60:63], v[132:135], v[156:159], v[60:63]
    ds_read_b64_tr_b16 v[122:123], v186 offset:4608
    s_waitcnt lgkmcnt(6)
    v_mfma_f32_16x16x32_bf16 v[96:99], v[136:139], v[172:175], v[96:99]
    ds_read_b64_tr_b16 v[124:125], v187 offset:4096
    ds_read_b64_tr_b16 v[126:127], v187 offset:4608
    v_mfma_f32_16x16x32_bf16 v[100:103], v[140:143], v[172:175], v[100:103]
    s_waitcnt lgkmcnt(4)
    v_mfma_f32_16x16x32_bf16 v[64:67], v[112:115], v[152:155], v[64:67]
    v_mfma_f32_16x16x32_bf16 v[72:75], v[112:115], v[156:159], v[72:75]
    v_mfma_f32_16x16x32_bf16 v[68:71], v[116:119], v[152:155], v[68:71]
    v_add_u32 v184, 106496, v190
    v_add_u32 v185, 106496, v191
    v_add_u32 v186, 106496, v192
    v_add_u32 v187, 106496, v193
    v_add_u32 v188, 106496, v194
    v_add_u32 v189, 106496, v195
    s_waitcnt lgkmcnt(0)
    s_barrier
    ds_read_b128 v[144:147], v180 offset:32768
    ds_read_b128 v[148:151], v180 offset:34816
    ds_read_b64_tr_b16 v[128:129], v184 offset:8192
    ds_read_b64_tr_b16 v[130:131], v184 offset:8704
    ds_read_b64_tr_b16 v[132:133], v185 offset:8192
    ds_read_b64_tr_b16 v[134:135], v185 offset:8704
    ds_read_b64_tr_b16 v[136:137], v184 offset:16384
    ds_read_b64_tr_b16 v[138:139], v184 offset:16896
    v_mfma_f32_16x16x32_bf16 v[76:79], v[116:119], v[156:159], v[76:79]
    v_mfma_f32_16x16x32_bf16 v[80:83], v[120:123], v[152:155], v[80:83]
    ds_read_b64_tr_b16 v[140:141], v185 offset:16384
    v_mfma_f32_16x16x32_bf16 v[88:91], v[120:123], v[156:159], v[88:91]
    ds_read_b64_tr_b16 v[142:143], v185 offset:16896
    v_mfma_f32_16x16x32_bf16 v[84:87], v[124:127], v[152:155], v[84:87]
    ds_read_b64_tr_b16 v[112:113], v186 offset:8192
    v_mfma_f32_16x16x32_bf16 v[92:95], v[124:127], v[156:159], v[92:95]
    ds_read_b64_tr_b16 v[114:115], v186 offset:8704
    s_waitcnt lgkmcnt(6)
    v_mfma_f32_16x16x32_bf16 v[0:3], v[128:131], v[144:147], v[0:3]
    ds_read_b64_tr_b16 v[116:117], v187 offset:8192
    v_mfma_f32_16x16x32_bf16 v[8:11], v[128:131], v[148:151], v[8:11]
    ds_read_b64_tr_b16 v[118:119], v187 offset:8704
    v_mfma_f32_16x16x32_bf16 v[4:7], v[132:135], v[144:147], v[4:7]
    ds_read_b64_tr_b16 v[120:121], v186 offset:16384
    v_mfma_f32_16x16x32_bf16 v[12:15], v[132:135], v[148:151], v[12:15]
    ds_read_b64_tr_b16 v[122:123], v186 offset:16896
    s_waitcnt lgkmcnt(6)
    v_mfma_f32_16x16x32_bf16 v[16:19], v[136:139], v[144:147], v[16:19]
    ds_read_b64_tr_b16 v[124:125], v187 offset:16384
    v_mfma_f32_16x16x32_bf16 v[24:27], v[136:139], v[148:151], v[24:27]
    ds_read_b64_tr_b16 v[126:127], v187 offset:16896
    v_mfma_f32_16x16x32_bf16 v[20:23], v[140:143], v[144:147], v[20:23]
    ds_read_b128 v[168:171], v182 offset:2048
    ds_read_b64_tr_b16 v[128:129], v188 offset:0
    v_mfma_f32_16x16x32_bf16 v[28:31], v[140:143], v[148:151], v[28:31]
    ds_read_b64_tr_b16 v[130:131], v188 offset:512
    s_waitcnt lgkmcnt(7)
    v_mfma_f32_16x16x32_bf16 v[32:35], v[112:115], v[144:147], v[32:35]
    ds_read_b64_tr_b16 v[132:133], v189 offset:0
    v_mfma_f32_16x16x32_bf16 v[40:43], v[112:115], v[148:151], v[40:43]
    ds_read_b64_tr_b16 v[134:135], v189 offset:512
    v_mfma_f32_16x16x32_bf16 v[36:39], v[116:119], v[144:147], v[36:39]
    ds_read_b64_tr_b16 v[136:137], v184 offset:0
    v_mfma_f32_16x16x32_bf16 v[44:47], v[116:119], v[148:151], v[44:47]
    ds_read_b64_tr_b16 v[138:139], v184 offset:512
    s_waitcnt lgkmcnt(7)
    v_mfma_f32_16x16x32_bf16 v[48:51], v[120:123], v[144:147], v[48:51]
    ds_read_b64_tr_b16 v[140:141], v185 offset:0
    v_mfma_f32_16x16x32_bf16 v[56:59], v[120:123], v[148:151], v[56:59]
    ds_read_b64_tr_b16 v[142:143], v185 offset:512
    v_mfma_f32_16x16x32_bf16 v[52:55], v[124:127], v[144:147], v[52:55]
    ds_read_b64_tr_b16 v[112:113], v186 offset:0
    v_mfma_f32_16x16x32_bf16 v[60:63], v[124:127], v[148:151], v[60:63]
    ds_read_b64_tr_b16 v[114:115], v186 offset:512
    s_waitcnt lgkmcnt(6)
    v_mfma_f32_16x16x32_bf16 v[96:99], v[128:131], v[168:171], v[96:99]
    ds_read_b64_tr_b16 v[116:117], v187 offset:0
    ds_read_b64_tr_b16 v[118:119], v187 offset:512
    v_mfma_f32_16x16x32_bf16 v[100:103], v[132:135], v[168:171], v[100:103]
    ds_read_b128 v[152:155], v181 offset:32768
    ds_read_b128 v[156:159], v181 offset:34816
    ds_read_b64_tr_b16 v[120:121], v184 offset:12288
    ds_read_b64_tr_b16 v[122:123], v184 offset:12800
    s_waitcnt lgkmcnt(8)
    v_mfma_f32_16x16x32_bf16 v[64:67], v[136:139], v[144:147], v[64:67]
    ds_read_b64_tr_b16 v[124:125], v185 offset:12288
    v_mfma_f32_16x16x32_bf16 v[72:75], v[136:139], v[148:151], v[72:75]
    ds_read_b64_tr_b16 v[126:127], v185 offset:12800
    v_mfma_f32_16x16x32_bf16 v[68:71], v[140:143], v[144:147], v[68:71]
    ds_read_b64_tr_b16 v[128:129], v184 offset:20480
    v_mfma_f32_16x16x32_bf16 v[76:79], v[140:143], v[148:151], v[76:79]
    ds_read_b64_tr_b16 v[130:131], v184 offset:20992
    s_waitcnt lgkmcnt(8)
    v_mfma_f32_16x16x32_bf16 v[80:83], v[112:115], v[144:147], v[80:83]
    ds_read_b64_tr_b16 v[132:133], v185 offset:20480
    v_mfma_f32_16x16x32_bf16 v[88:91], v[112:115], v[148:151], v[88:91]
    ds_read_b64_tr_b16 v[134:135], v185 offset:20992
    v_mfma_f32_16x16x32_bf16 v[84:87], v[116:119], v[144:147], v[84:87]
    ds_read_b64_tr_b16 v[136:137], v186 offset:12288
    v_mfma_f32_16x16x32_bf16 v[92:95], v[116:119], v[148:151], v[92:95]
    ds_read_b64_tr_b16 v[138:139], v186 offset:12800
    s_waitcnt lgkmcnt(6)
    v_mfma_f32_16x16x32_bf16 v[0:3], v[120:123], v[152:155], v[0:3]
    ds_read_b64_tr_b16 v[140:141], v187 offset:12288
    v_mfma_f32_16x16x32_bf16 v[8:11], v[120:123], v[156:159], v[8:11]
    ds_read_b64_tr_b16 v[142:143], v187 offset:12800
    v_mfma_f32_16x16x32_bf16 v[4:7], v[124:127], v[152:155], v[4:7]
    ds_read_b64_tr_b16 v[112:113], v186 offset:20480
    v_mfma_f32_16x16x32_bf16 v[12:15], v[124:127], v[156:159], v[12:15]
    ds_read_b64_tr_b16 v[114:115], v186 offset:20992
    s_waitcnt lgkmcnt(6)
    v_mfma_f32_16x16x32_bf16 v[16:19], v[128:131], v[152:155], v[16:19]
    ds_read_b64_tr_b16 v[116:117], v187 offset:20480
    v_mfma_f32_16x16x32_bf16 v[24:27], v[128:131], v[156:159], v[24:27]
    ds_read_b64_tr_b16 v[118:119], v187 offset:20992
    v_mfma_f32_16x16x32_bf16 v[20:23], v[132:135], v[152:155], v[20:23]
    ds_read_b128 v[172:175], v183 offset:2048
    ds_read_b64_tr_b16 v[120:121], v188 offset:4096
    v_mfma_f32_16x16x32_bf16 v[28:31], v[132:135], v[156:159], v[28:31]
    ds_read_b64_tr_b16 v[122:123], v188 offset:4608
    s_waitcnt lgkmcnt(7)
    v_mfma_f32_16x16x32_bf16 v[32:35], v[136:139], v[152:155], v[32:35]
    ds_read_b64_tr_b16 v[124:125], v189 offset:4096
    v_mfma_f32_16x16x32_bf16 v[40:43], v[136:139], v[156:159], v[40:43]
    ds_read_b64_tr_b16 v[126:127], v189 offset:4608
    v_mfma_f32_16x16x32_bf16 v[36:39], v[140:143], v[152:155], v[36:39]
    ds_read_b64_tr_b16 v[128:129], v184 offset:4096
    ds_read_b64_tr_b16 v[130:131], v184 offset:4608
    v_mfma_f32_16x16x32_bf16 v[44:47], v[140:143], v[156:159], v[44:47]
    ds_read_b128 v[252:255], v230 offset:0
    s_waitcnt lgkmcnt(8)
    v_mfma_f32_16x16x32_bf16 v[48:51], v[112:115], v[152:155], v[48:51]
    ds_read_b64_tr_b16 v[132:133], v185 offset:4096
    v_mfma_f32_16x16x32_bf16 v[56:59], v[112:115], v[156:159], v[56:59]
    ds_read_b64_tr_b16 v[134:135], v185 offset:4608
    v_mfma_f32_16x16x32_bf16 v[52:55], v[116:119], v[152:155], v[52:55]
    ds_read_b64_tr_b16 v[136:137], v186 offset:4096
    v_mfma_f32_16x16x32_bf16 v[60:63], v[116:119], v[156:159], v[60:63]
    ds_read_b64_tr_b16 v[138:139], v186 offset:4608
    s_waitcnt lgkmcnt(7)
    v_mfma_f32_16x16x32_bf16 v[96:99], v[120:123], v[172:175], v[96:99]
    ds_read_b64_tr_b16 v[140:141], v187 offset:4096
    ds_read_b64_tr_b16 v[142:143], v187 offset:4608
    v_mfma_f32_16x16x32_bf16 v[100:103], v[124:127], v[172:175], v[100:103]
    v_add_u32 v184, 49152, v190
    v_add_u32 v185, 49152, v191
    v_add_u32 v186, 49152, v192
    v_add_u32 v187, 49152, v193
    v_add_u32 v188, 49152, v194
    v_add_u32 v189, 49152, v195
    s_waitcnt lgkmcnt(6)
    v_min3_u32 v252, v252, v253, v254
    v_min_u32 v252, v252, v255
    v_cmp_gt_u32 vcc, 7, v252
    s_nop 0
    s_cbranch_vccz L_Qw6_ok
L_Qw6:
    s_add_u32 s3, s3, 1
    s_cmp_gt_u32 s3, 2097152
    s_cbranch_scc1 L_Qw6_ok
    ds_read_b128 v[252:255], v230 offset:0
    s_waitcnt lgkmcnt(0)
    v_min3_u32 v252, v252, v253, v254
    v_min_u32 v252, v252, v255
    v_cmp_gt_u32 vcc, 7, v252
    s_nop 0
    s_cbranch_vccnz L_Qw6
L_Qw6_ok:
    ds_read_b128 v[144:147], v180 offset:0
    ds_read_b128 v[148:151], v180 offset:2048
    ds_read_b64_tr_b16 v[112:113], v184 offset:8192
    ds_read_b64_tr_b16 v[114:115], v184 offset:8704
    s_waitcnt lgkmcnt(8)
    v_mfma_f32_16x16x32_bf16 v[64:67], v[128:131], v[152:155], v[64:67]
    ds_read_b128 v[160:163], v181 offset:0
    ds_read_b128 v[164:167], v181 offset:2048
    v_mfma_f32_16x16x32_bf16 v[72:75], v[128:131], v[156:159], v[72:75]
    ds_read_b64_tr_b16 v[116:117], v184 offset:12288
    ds_read_b64_tr_b16 v[118:119], v184 offset:12800
    v_mfma_f32_16x16x32_bf16 v[68:71], v[132:135], v[152:155], v[68:71]
    ds_read_b32 v204, v202 offset:256
    ds_read_b32 v196, v202 offset:264
    ds_read_b32 v208, v202 offset:512
    v_mfma_f32_16x16x32_bf16 v[76:79], v[132:135], v[156:159], v[76:79]
    ds_read_b32 v198, v202 offset:520
    ds_read_b32 v120, v224 offset:512
    s_waitcnt lgkmcnt(13)
    v_mfma_f32_16x16x32_bf16 v[80:83], v[136:139], v[152:155], v[80:83]
    ds_read_b64_tr_b16 v[124:125], v185 offset:8192
    v_mfma_f32_16x16x32_bf16 v[88:91], v[136:139], v[156:159], v[88:91]
    ds_read_b64_tr_b16 v[126:127], v185 offset:8704
    v_mfma_f32_16x16x32_bf16 v[84:87], v[140:143], v[152:155], v[84:87]
    ds_read_b64_tr_b16 v[128:129], v185 offset:12288
    v_mfma_f32_16x16x32_bf16 v[92:95], v[140:143], v[156:159], v[92:95]
    ds_read_b64_tr_b16 v[130:131], v185 offset:12800
    v_mov_b32 v251, 6
    ds_write_b32 v231, v251
    s_waitcnt lgkmcnt(10)
    v_mfma_f32_16x16x32_bf16 v[0:3], v[112:115], v[144:147], v[0:3]
    ds_read_b32 v132, v224 offset:640
    v_mfma_f32_16x16x32_bf16 v[8:11], v[112:115], v[148:151], v[8:11]
    s_setprio 1
    v_mfma_f32_16x16x32_bf16 v[0:3], v[116:119], v[160:163], v[0:3]
    ds_read_b64_tr_b16 v[136:137], v184 offset:16384
    v_mfma_f32_16x16x32_bf16 v[8:11], v[116:119], v[164:167], v[8:11]
    ds_read_b64_tr_b16 v[138:139], v184 offset:16896
    s_waitcnt lgkmcnt(6)
    v_mfma_f32_16x16x32_bf16 v[0:3], v[120:123], v[204:207], v[0:3]
    ds_read_b64_tr_b16 v[140:141], v184 offset:20480
    v_mfma_f32_16x16x32_bf16 v[8:11], v[120:123], v[208:211], v[8:11]
    ds_read_b64_tr_b16 v[142:143], v184 offset:20992
    v_mfma_f32_16x16x32_bf16 v[4:7], v[124:127], v[144:147], v[4:7]
    ds_read_b32 v112, v224 offset:1024
    v_mfma_f32_16x16x32_bf16 v[12:15], v[124:127], v[148:151], v[12:15]
    s_waitcnt lgkmcnt(5)
    v_mfma_f32_16x16x32_bf16 v[4:7], v[128:131], v[160:163], v[4:7]
    ds_read_b64_tr_b16 v[116:117], v185 offset:16384
    v_mfma_f32_16x16x32_bf16 v[12:15], v[128:131], v[164:167], v[12:15]
    ds_read_b64_tr_b16 v[118:119], v185 offset:16896
    v_mfma_f32_16x16x32_bf16 v[4:7], v[132:135], v[204:207], v[4:7]
    ds_read_b64_tr_b16 v[120:121], v185 offset:20480
    v_mfma_f32_16x16x32_bf16 v[12:15], v[132:135], v[208:211], v[12:15]
    ds_read_b64_tr_b16 v[122:123], v185 offset:20992
    s_waitcnt lgkmcnt(5)
    v_mfma_f32_16x16x32_bf16 v[16:19], v[136:139], v[144:147], v[16:19]
    ds_read_b32 v124, v224 offset:1152
    v_mfma_f32_16x16x32_bf16 v[24:27], v[136:139], v[148:151], v[24:27]
    v_mfma_f32_16x16x32_bf16 v[16:19], v[140:143], v[160:163], v[16:19]
    ds_read_b64_tr_b16 v[128:129], v186 offset:8192
    v_mfma_f32_16x16x32_bf16 v[24:27], v[140:143], v[164:167], v[24:27]
    ds_read_b64_tr_b16 v[130:131], v186 offset:8704
    s_waitcnt lgkmcnt(5)
    v_mfma_f32_16x16x32_bf16 v[16:19], v[112:115], v[204:207], v[16:19]
    ds_read_b64_tr_b16 v[132:133], v186 offset:12288
    v_rcp_f32 v196, v196
    v_rcp_f32 v198, v198
    v_mfma_f32_16x16x32_bf16 v[24:27], v[112:115], v[208:211], v[24:27]
    ds_read_b64_tr_b16 v[134:135], v186 offset:12800
    v_mul_f32 v197, 0x3e8b9a4d, v196
    v_mul_f32 v199, 0x3e8b9a4d, v198
    v_mfma_f32_16x16x32_bf16 v[20:23], v[116:119], v[144:147], v[20:23]
    ds_read_b32 v136, v224 offset:768
    v_mul_f32 v0, v0, v196
    v_mul_f32 v1, v1, v196
    v_mfma_f32_16x16x32_bf16 v[28:31], v[116:119], v[148:151], v[28:31]
    v_mul_f32 v2, v2, v196
    v_mul_f32 v3, v3, v196
    s_waitcnt lgkmcnt(5)
    v_mfma_f32_16x16x32_bf16 v[20:23], v[120:123], v[160:163], v[20:23]
    ds_read_b64_tr_b16 v[140:141], v187 offset:8192
    v_mul_f32 v4, v4, v196
    v_mul_f32 v5, v5, v196
    v_mfma_f32_16x16x32_bf16 v[28:31], v[120:123], v[164:167], v[28:31]
    ds_read_b64_tr_b16 v[142:143], v187 offset:8704
    v_mul_f32 v6, v6, v196
    v_mul_f32 v7, v7, v196
    v_mfma_f32_16x16x32_bf16 v[20:23], v[124:127], v[204:207], v[20:23]
    ds_read_b64_tr_b16 v[112:113], v187 offset:12288
    v_cvt_pk_bf16_f32 v0, v0, v1
    v_cvt_pk_bf16_f32 v1, v2, v3
    v_mfma_f32_16x16x32_bf16 v[28:31], v[124:127], v[208:211], v[28:31]
    ds_read_b64_tr_b16 v[114:115], v187 offset:12800
    v_cvt_pk_bf16_f32 v2, v4, v5
    v_cvt_pk_bf16_f32 v3, v6, v7
    s_waitcnt lgkmcnt(5)
    v_mfma_f32_16x16x32_bf16 v[32:35], v[128:131], v[144:147], v[32:35]
    ds_read_b32 v116, v224 offset:896
    v_mul_f32 v8, v8, v198
    v_mul_f32 v9, v9, v198
    v_mfma_f32_16x16x32_bf16 v[40:43], v[128:131], v[148:151], v[40:43]
    v_mul_f32 v10, v10, v198
    v_mul_f32 v11, v11, v198
    v_mfma_f32_16x16x32_bf16 v[32:35], v[132:135], v[160:163], v[32:35]
    ds_read_b64_tr_b16 v[120:121], v186 offset:16384
    v_mul_f32 v12, v12, v198
    v_mul_f32 v13, v13, v198
    v_mfma_f32_16x16x32_bf16 v[40:43], v[132:135], v[164:167], v[40:43]
    ds_read_b64_tr_b16 v[122:123], v186 offset:16896
    v_mul_f32 v14, v14, v198
    v_mul_f32 v15, v15, v198
    s_waitcnt lgkmcnt(5)
    v_mfma_f32_16x16x32_bf16 v[32:35], v[136:139], v[204:207], v[32:35]
    ds_read_b64_tr_b16 v[124:125], v186 offset:20480
    v_cvt_pk_bf16_f32 v8, v8, v9
    v_cvt_pk_bf16_f32 v9, v10, v11
    v_mfma_f32_16x16x32_bf16 v[40:43], v[136:139], v[208:211], v[40:43]
    ds_read_b64_tr_b16 v[126:127], v186 offset:20992
    v_cvt_pk_bf16_f32 v10, v12, v13
    v_cvt_pk_bf16_f32 v11, v14, v15
    v_mfma_f32_16x16x32_bf16 v[36:39], v[140:143], v[144:147], v[36:39]
    ds_read_b32 v128, v224 offset:1280
    v_mul_f32 v16, v16, v196
    v_mul_f32 v17, v17, v196
    v_mfma_f32_16x16x32_bf16 v[44:47], v[140:143], v[148:151], v[44:47]
    v_mul_f32 v18, v18, v196
    v_mul_f32 v19, v19, v196
    s_waitcnt lgkmcnt(5)
    v_mfma_f32_16x16x32_bf16 v[36:39], v[112:115], v[160:163], v[36:39]
    ds_read_b64_tr_b16 v[132:133], v187 offset:16384
    v_mul_f32 v20, v20, v196
    v_mul_f32 v21, v21, v196
    v_mfma_f32_16x16x32_bf16 v[44:47], v[112:115], v[164:167], v[44:47]
    ds_read_b64_tr_b16 v[134:135], v187 offset:16896
    v_mul_f32 v22, v22, v196
    v_mul_f32 v23, v23, v196
    v_mfma_f32_16x16x32_bf16 v[36:39], v[116:119], v[204:207], v[36:39]
    ds_read_b64_tr_b16 v[136:137], v187 offset:20480
    v_cvt_pk_bf16_f32 v16, v16, v17
    v_cvt_pk_bf16_f32 v17, v18, v19
    v_mfma_f32_16x16x32_bf16 v[44:47], v[116:119], v[208:211], v[44:47]
    ds_read_b64_tr_b16 v[138:139], v187 offset:20992
    v_cvt_pk_bf16_f32 v18, v20, v21
    v_cvt_pk_bf16_f32 v19, v22, v23
    s_waitcnt lgkmcnt(5)
    v_mfma_f32_16x16x32_bf16 v[48:51], v[120:123], v[144:147], v[48:51]
    ds_read_b32 v140, v224 offset:1408
    v_mul_f32 v24, v24, v198
    v_mul_f32 v25, v25, v198
    v_mfma_f32_16x16x32_bf16 v[56:59], v[120:123], v[148:151], v[56:59]
    v_mul_f32 v26, v26, v198
    v_mul_f32 v27, v27, v198
    v_mfma_f32_16x16x32_bf16 v[48:51], v[124:127], v[160:163], v[48:51]
    ds_read_b128 v[168:171], v182 offset:4096
    ds_read_b64_tr_b16 v[112:113], v188 offset:0
    v_mul_f32 v28, v28, v198
    v_mul_f32 v29, v29, v198
    v_mfma_f32_16x16x32_bf16 v[56:59], v[124:127], v[164:167], v[56:59]
    ds_read_b64_tr_b16 v[114:115], v188 offset:512
    v_mul_f32 v30, v30, v198
    v_mul_f32 v31, v31, v198
    s_waitcnt lgkmcnt(6)
    v_mfma_f32_16x16x32_bf16 v[48:51], v[128:131], v[204:207], v[48:51]
    ds_read_b128 v[176:179], v183 offset:4096
    ds_read_b64_tr_b16 v[116:117], v188 offset:4096
    v_cvt_pk_bf16_f32 v24, v24, v25
    v_cvt_pk_bf16_f32 v25, v26, v27
    v_mfma_f32_16x16x32_bf16 v[56:59], v[128:131], v[208:211], v[56:59]
    ds_read_b64_tr_b16 v[118:119], v188 offset:4608
    v_cvt_pk_bf16_f32 v26, v28, v29
    v_cvt_pk_bf16_f32 v27, v30, v31
    v_mfma_f32_16x16x32_bf16 v[52:55], v[132:135], v[144:147], v[52:55]
    ds_read_b32 v212, v203
    ds_read_b32 v200, v203 offset:8
    v_mul_f32 v32, v32, v196
    v_mul_f32 v33, v33, v196
    v_mfma_f32_16x16x32_bf16 v[60:63], v[132:135], v[148:151], v[60:63]
    ds_read_b32 v120, v225 offset:0
    v_mul_f32 v34, v34, v196
    v_mul_f32 v35, v35, v196
    s_waitcnt lgkmcnt(9)
    v_mfma_f32_16x16x32_bf16 v[52:55], v[136:139], v[160:163], v[52:55]
    ds_read_b64_tr_b16 v[124:125], v189 offset:0
    v_mul_f32 v36, v36, v196
    v_mul_f32 v37, v37, v196
    v_mfma_f32_16x16x32_bf16 v[60:63], v[136:139], v[164:167], v[60:63]
    ds_read_b64_tr_b16 v[126:127], v189 offset:512
    v_mul_f32 v38, v38, v196
    v_mul_f32 v39, v39, v196
    v_mfma_f32_16x16x32_bf16 v[52:55], v[140:143], v[204:207], v[52:55]
    ds_read_b64_tr_b16 v[128:129], v189 offset:4096
    v_cvt_pk_bf16_f32 v32, v32, v33
    v_cvt_pk_bf16_f32 v33, v34, v35
    v_mfma_f32_16x16x32_bf16 v[60:63], v[140:143], v[208:211], v[60:63]
    ds_read_b64_tr_b16 v[130:131], v189 offset:4608
    v_cvt_pk_bf16_f32 v34, v36, v37
    v_cvt_pk_bf16_f32 v35, v38, v39
    s_waitcnt lgkmcnt(7)
    v_mfma_f32_16x16x32_bf16 v[96:99], v[112:115], v[168:171], v[96:99]
    ds_read_b32 v132, v225 offset:128
    v_mul_f32 v40, v40, v198
    v_mul_f32 v41, v41, v198
    v_mfma_f32_16x16x32_bf16 v[96:99], v[116:119], v[176:179], v[96:99]
    ds_read_b64_tr_b16 v[136:137], v184 offset:0
    ds_read_b64_tr_b16 v[138:139], v184 offset:512
    v_mul_f32 v42, v42, v198
    v_mul_f32 v43, v43, v198
    s_waitcnt lgkmcnt(5)
    v_mfma_f32_16x16x32_bf16 v[96:99], v[120:123], v[212:215], v[96:99]
    ds_read_b64_tr_b16 v[140:141], v184 offset:4096
    ds_read_b64_tr_b16 v[142:143], v184 offset:4608
    v_mul_f32 v44, v44, v198
    v_mul_f32 v45, v45, v198
    v_mfma_f32_16x16x32_bf16 v[100:103], v[124:127], v[168:171], v[100:103]
    ds_read_b32 v112, v224 offset:0
    v_mul_f32 v46, v46, v198
    v_mul_f32 v47, v47, v198
    s_waitcnt lgkmcnt(5)
    v_mfma_f32_16x16x32_bf16 v[100:103], v[128:131], v[176:179], v[100:103]
    ds_read_b64_tr_b16 v[116:117], v185 offset:0
    ds_read_b64_tr_b16 v[118:119], v185 offset:512
    v_cvt_pk_bf16_f32 v40, v40, v41
    v_cvt_pk_bf16_f32 v41, v42, v43
    v_mfma_f32_16x16x32_bf16 v[100:103], v[132:135], v[212:215], v[100:103]
    ds_read_b64_tr_b16 v[120:121], v185 offset:4096
    ds_read_b64_tr_b16 v[122:123], v185 offset:4608
    v_cvt_pk_bf16_f32 v42, v44, v45
    v_cvt_pk_bf16_f32 v43, v46, v47
    s_waitcnt lgkmcnt(5)
    v_mfma_f32_16x16x32_bf16 v[64:67], v[136:139], v[144:147], v[64:67]
    ds_read_b32 v124, v224 offset:128
    v_mul_f32 v48, v48, v196
    v_mul_f32 v49, v49, v196
    v_mfma_f32_16x16x32_bf16 v[72:75], v[136:139], v[148:151], v[72:75]
    v_mul_f32 v50, v50, v196
    v_mul_f32 v51, v51, v196
    v_mfma_f32_16x16x32_bf16 v[64:67], v[140:143], v[160:163], v[64:67]
    ds_read_b64_tr_b16 v[128:129], v186 offset:0
    v_mul_f32 v52, v52, v196
    v_mul_f32 v53, v53, v196
    v_mfma_f32_16x16x32_bf16 v[72:75], v[140:143], v[164:167], v[72:75]
    ds_read_b64_tr_b16 v[130:131], v186 offset:512
    v_mul_f32 v54, v54, v196
    v_mul_f32 v55, v55, v196
    s_waitcnt lgkmcnt(5)
    v_mfma_f32_16x16x32_bf16 v[64:67], v[112:115], v[204:207], v[64:67]
    ds_read_b64_tr_b16 v[132:133], v186 offset:4096
    v_cvt_pk_bf16_f32 v48, v48, v49
    v_cvt_pk_bf16_f32 v49, v50, v51
    v_mfma_f32_16x16x32_bf16 v[72:75], v[112:115], v[208:211], v[72:75]
    ds_read_b64_tr_b16 v[134:135], v186 offset:4608
    v_cvt_pk_bf16_f32 v50, v52, v53
    v_cvt_pk_bf16_f32 v51, v54, v55
    v_mfma_f32_16x16x32_bf16 v[68:71], v[116:119], v[144:147], v[68:71]
    ds_read_b32 v136, v224 offset:256
    v_mul_f32 v56, v56, v198
    v_mul_f32 v57, v57, v198
    v_mfma_f32_16x16x32_bf16 v[76:79], v[116:119], v[148:151], v[76:79]
    v_mul_f32 v58, v58, v198
    v_mul_f32 v59, v59, v198
    s_waitcnt lgkmcnt(5)
    v_mfma_f32_16x16x32_bf16 v[68:71], v[120:123], v[160:163], v[68:71]
    ds_read_b64_tr_b16 v[140:141], v187 offset:0
    v_mul_f32 v60, v60, v198
    v_mul_f32 v61, v61, v198
    v_mfma_f32_16x16x32_bf16 v[76:79], v[120:123], v[164:167], v[76:79]
    ds_read_b64_tr_b16 v[142:143], v187 offset:512
    v_mul_f32 v62, v62, v198
    v_mul_f32 v63, v63, v198
    v_mfma_f32_16x16x32_bf16 v[68:71], v[124:127], v[204:207], v[68:71]
    ds_read_b64_tr_b16 v[112:113], v187 offset:4096
    v_cvt_pk_bf16_f32 v56, v56, v57
    v_cvt_pk_bf16_f32 v57, v58, v59
    v_mfma_f32_16x16x32_bf16 v[76:79], v[124:127], v[208:211], v[76:79]
    ds_read_b64_tr_b16 v[114:115], v187 offset:4608
    v_cvt_pk_bf16_f32 v58, v60, v61
    v_cvt_pk_bf16_f32 v59, v62, v63
    s_waitcnt lgkmcnt(5)
    v_mfma_f32_16x16x32_bf16 v[80:83], v[128:131], v[144:147], v[80:83]
    ds_read_b32 v116, v224 offset:384
    v_rcp_f32 v200, v200
    s_nop 0
    v_mul_f32 v96, v96, v200
    v_mfma_f32_16x16x32_bf16 v[88:91], v[128:131], v[148:151], v[88:91]
    v_mul_f32 v97, v97, v200
    v_mul_f32 v98, v98, v200
    v_mfma_f32_16x16x32_bf16 v[80:83], v[132:135], v[160:163], v[80:83]
    v_mul_f32 v99, v99, v200
    v_mul_f32 v100, v100, v200
    v_mfma_f32_16x16x32_bf16 v[88:91], v[132:135], v[164:167], v[88:91]
    v_mul_f32 v101, v101, v200
    v_mul_f32 v102, v102, v200
    s_waitcnt lgkmcnt(3)
    v_mfma_f32_16x16x32_bf16 v[80:83], v[136:139], v[204:207], v[80:83]
    v_mul_f32 v103, v103, v200
    v_cvt_pk_bf16_f32 v96, v96, v97
    v_mfma_f32_16x16x32_bf16 v[88:91], v[136:139], v[208:211], v[88:91]
    v_cvt_pk_bf16_f32 v97, v98, v99
    v_cvt_pk_bf16_f32 v98, v100, v101
    v_mfma_f32_16x16x32_bf16 v[84:87], v[140:143], v[144:147], v[84:87]
    v_cvt_pk_bf16_f32 v99, v102, v103
    v_cvt_pk_bf16_f32 v64, v64, v65
    v_mfma_f32_16x16x32_bf16 v[92:95], v[140:143], v[148:151], v[92:95]
    v_cvt_pk_bf16_f32 v65, v66, v67
    v_cvt_pk_bf16_f32 v66, v68, v69
    s_waitcnt lgkmcnt(0)
    v_mfma_f32_16x16x32_bf16 v[84:87], v[112:115], v[160:163], v[84:87]
    v_cvt_pk_bf16_f32 v67, v70, v71
    v_and_b32 v66, v66, v222
    v_mfma_f32_16x16x32_bf16 v[92:95], v[112:115], v[164:167], v[92:95]
    v_and_b32 v67, v67, v222
    v_cvt_pk_bf16_f32 v72, v72, v73
    v_mfma_f32_16x16x32_bf16 v[84:87], v[116:119], v[204:207], v[84:87]
    v_cvt_pk_bf16_f32 v73, v74, v75
    v_cvt_pk_bf16_f32 v74, v76, v77
    v_mfma_f32_16x16x32_bf16 v[92:95], v[116:119], v[208:211], v[92:95]
    v_cvt_pk_bf16_f32 v75, v78, v79
    v_and_b32 v74, v74, v222
    ds_write_b128 v216, v[8:11] offset:0
    ds_write_b64 v226, v[16:17] offset:0
    s_mov_b32 exec_hi, 0xffff
    ds_write_b64 v226, v[18:19] offset:32
    s_mov_b32 exec_hi, -1
    ds_write_b64 v226, v[24:25] offset:896
    s_mov_b32 exec_hi, 0xffff
    ds_write_b64 v226, v[26:27] offset:928
    s_mov_b32 exec_hi, -1
    ds_write_b128 v216, v[40:43] offset:1024
    ds_write_b64 v226, v[48:49] offset:8064
    s_mov_b32 exec_hi, 0xffff
    ds_write_b64 v226, v[50:51] offset:8096
    s_mov_b32 exec_hi, -1
    ds_write_b64 v226, v[56:57] offset:8960
    s_mov_b32 exec_hi, 0xffff
    ds_write_b64 v226, v[58:59] offset:8992
    s_mov_b32 exec_hi, -1
    ds_write_b64 v217, v[96:97]
    ds_write_b64 v218, v[98:99]
    v_and_b32 v75, v75, v222
    v_cvt_pk_bf16_f32 v80, v80, v81
    v_cvt_pk_bf16_f32 v81, v82, v83
    v_cvt_pk_bf16_f32 v82, v84, v85
    v_cvt_pk_bf16_f32 v83, v86, v87
    v_and_b32 v82, v82, v222
    v_and_b32 v83, v83, v222
    v_cvt_pk_bf16_f32 v88, v88, v89
    s_waitcnt lgkmcnt(0)
    v_mov_b32 v250, 1
    ds_write_b32 v231, v250 offset:16
    v_cvt_pk_bf16_f32 v89, v90, v91
    v_cvt_pk_bf16_f32 v90, v92, v93
    v_cvt_pk_bf16_f32 v91, v94, v95
    v_and_b32 v90, v90, v222
    v_and_b32 v91, v91, v222
    ds_read_b128 v[252:255], v230 offset:32
    v_mfma_f32_16x16x32_bf16 v[148:151], v[8:11], v[72:75], v[236:239]
    v_mfma_f32_16x16x32_bf16 v[156:159], v[40:43], v[88:91], v[236:239]
    v_mfma_f32_16x16x32_bf16 v[164:167], v[0:3], v[64:67], v[236:239]
    v_mfma_f32_16x16x32_bf16 v[172:175], v[32:35], v[80:83], v[236:239]
    v_mfma_f32_16x16x32_bf16 v[144:147], v[0:3], v[72:75], v[232:235]
    v_mfma_f32_16x16x32_bf16 v[152:155], v[32:35], v[88:91], v[232:235]
    s_waitcnt lgkmcnt(0)
    v_min3_u32 v252, v252, v253, v254
    v_min_u32 v252, v252, v255
    v_cmp_gt_u32 vcc, 1, v252
    s_nop 0
    s_cbranch_vccz L_attp_ok
L_attp:
    s_add_u32 s3, s3, 1
    s_cmp_gt_u32 s3, 2097152
    s_cbranch_scc1 L_attp_ok
    ds_read_b128 v[252:255], v230 offset:32
    s_waitcnt lgkmcnt(0)
    v_min3_u32 v252, v252, v253, v254
    v_min_u32 v252, v252, v255
    v_cmp_gt_u32 vcc, 1, v252
    s_nop 0
    s_cbranch_vccnz L_attp
L_attp_ok:
    ds_read_b128 v[136:139], v229 offset:0
    ds_read_b128 v[140:143], v229 offset:1024
    ds_read_b64_tr_b16 v[112:113], v228 offset:0
    ds_read_b64_tr_b16 v[114:115], v228 offset:896
    ds_read_b64_tr_b16 v[116:117], v228 offset:1792
    ds_read_b64_tr_b16 v[118:119], v228 offset:32
    ds_read_b64_tr_b16 v[120:121], v228 offset:928
    ds_read_b64_tr_b16 v[122:123], v228 offset:1824
    ds_read_b64_tr_b16 v[124:125], v228 offset:8064
    ds_read_b64_tr_b16 v[126:127], v228 offset:8960
    ds_read_b64_tr_b16 v[128:129], v228 offset:9856
    ds_read_b64_tr_b16 v[130:131], v228 offset:8096
    ds_read_b64_tr_b16 v[132:133], v228 offset:8992
    ds_read_b64_tr_b16 v[134:135], v228 offset:9888
    v_max_f32 v144, v144, v145
    v_max_f32 v145, v146, v147
    v_max_f32 v146, v148, v149
    v_max_f32 v147, v150, v151
    v_max_f32 v152, v152, v153
    v_max_f32 v153, v154, v155
    v_max_f32 v154, v156, v157
    v_max_f32 v155, v158, v159
    s_waitcnt lgkmcnt(12)
    v_mfma_f32_16x16x32_bf16 v[160:163], v[136:139], v[64:67], v[240:243]
    v_mfma_f32_16x16x32_bf16 v[168:171], v[140:143], v[80:83], v[240:243]
    v_max3_f32 v244, v144, v145, v146
    v_max3_f32 v245, v152, v153, v154
    v_max_f32 v244, v244, v147
    v_max_f32 v245, v245, v155
    s_nop 1
    v_permlane16_swap_b32 v244, v245
    v_max_f32 v244, v244, v245
    v_max_f32 v160, v160, v161
    v_max_f32 v161, v162, v163
    v_max_f32 v162, v164, v165
    v_max_f32 v163, v166, v167
    v_max_f32 v168, v168, v169
    v_max_f32 v169, v170, v171
    v_max_f32 v170, v172, v173
    v_max_f32 v171, v174, v175
    v_max3_f32 v246, v160, v161, v162
    v_max3_f32 v247, v168, v169, v170
    v_max_f32 v246, v246, v163
    v_max_f32 v247, v247, v171
    s_nop 1
    v_permlane16_swap_b32 v246, v247
    v_max_f32 v246, v246, v247
    s_nop 1
    v_permlane32_swap_b32 v244, v246
    v_max_f32 v244, v244, v246
    v_mov_b32 v246, v244
    s_nop 1
    v_permlane32_swap_b32 v244, v246
    v_mov_b32 v245, v244
    v_mov_b32 v247, v246
    s_nop 0
    v_permlane16_swap_b32 v244, v245
    v_permlane16_swap_b32 v246, v247
    v_mul_f32 v244, v199, v244
    v_mul_f32 v245, v199, v245
    v_mul_f32 v246, v197, v246
    v_mul_f32 v247, v197, v247
    v_fma_f32 v144, v144, v199, -v244
    v_fma_f32 v145, v145, v199, -v244
    v_fma_f32 v146, v146, v199, -v244
    v_fma_f32 v147, v147, v199, -v244
    v_fma_f32 v152, v152, v199, -v245
    v_fma_f32 v153, v153, v199, -v245
    v_fma_f32 v154, v154, v199, -v245
    v_fma_f32 v155, v155, v199, -v245
    v_fma_f32 v160, v160, v197, -v246
    v_fma_f32 v161, v161, v197, -v246
    v_fma_f32 v162, v162, v197, -v246
    v_fma_f32 v163, v163, v197, -v246
    v_fma_f32 v168, v168, v197, -v247
    v_fma_f32 v169, v169, v197, -v247
    v_fma_f32 v170, v170, v197, -v247
    v_fma_f32 v171, v171, v197, -v247
    v_exp_f32 v144, v144
    v_exp_f32 v145, v145
    v_exp_f32 v146, v146
    v_exp_f32 v147, v147
    v_exp_f32 v152, v152
    v_exp_f32 v153, v153
    v_exp_f32 v154, v154
    v_exp_f32 v155, v155
    v_exp_f32 v160, v160
    v_exp_f32 v161, v161
    v_exp_f32 v162, v162
    v_exp_f32 v163, v163
    v_exp_f32 v168, v168
    v_exp_f32 v169, v169
    v_exp_f32 v170, v170
    v_exp_f32 v171, v171
    s_lshl_b32 s60, s50, 11
    s_add_u32 s60, s60, s68
    s_add_u32 s60, s60, 57344
    s_add_u32 s61, s60, 73728
    s_waitcnt lgkmcnt(0)
    v_cvt_pk_bf16_f32 v144, v144, v144
    v_cvt_pk_bf16_f32 v145, v145, v145
    v_cvt_pk_bf16_f32 v146, v146, v146
    v_cvt_pk_bf16_f32 v147, v147, v147
    v_and_b32 v144, v144, v219
    v_and_b32 v145, v145, v219
    v_and_b32 v146, v146, v219
    v_and_b32 v147, v147, v219
    v_cvt_pk_bf16_f32 v152, v152, v152
    v_cvt_pk_bf16_f32 v153, v153, v153
    v_cvt_pk_bf16_f32 v154, v154, v154
    v_cvt_pk_bf16_f32 v155, v155, v155
    v_and_b32 v152, v152, v219
    v_and_b32 v153, v153, v219
    v_and_b32 v154, v154, v219
    v_and_b32 v155, v155, v219
    v_mfma_f32_16x16x32_bf16 v[148:151], v[104:107], v[144:147], 0
    v_mfma_f32_16x16x32_bf16 v[64:67], v[114:117], v[144:147], 0
    v_mfma_f32_16x16x32_bf16 v[68:71], v[120:123], v[144:147], 0
    v_cvt_pk_bf16_f32 v160, v160, v160
    v_cvt_pk_bf16_f32 v161, v161, v161
    v_cvt_pk_bf16_f32 v162, v162, v162
    v_cvt_pk_bf16_f32 v163, v163, v163
    v_and_b32 v160, v160, v219
    v_and_b32 v161, v161, v219
    v_and_b32 v162, v162, v219
    v_and_b32 v163, v163, v219
    v_mfma_f32_16x16x32_bf16 v[156:159], v[104:107], v[152:155], 0
    v_mfma_f32_16x16x32_bf16 v[72:75], v[126:129], v[152:155], 0
    v_mfma_f32_16x16x32_bf16 v[76:79], v[132:135], v[152:155], 0
    v_cvt_pk_bf16_f32 v168, v168, v168
    v_cvt_pk_bf16_f32 v169, v169, v169
    v_cvt_pk_bf16_f32 v170, v170, v170
    v_cvt_pk_bf16_f32 v171, v171, v171
    v_and_b32 v168, v168, v219
    v_and_b32 v169, v169, v219
    v_and_b32 v170, v170, v219
    v_and_b32 v171, v171, v219
    v_mfma_f32_16x16x32_bf16 v[164:167], v[104:107], v[160:163], 0
    v_mfma_f32_16x16x32_bf16 v[80:83], v[112:115], v[160:163], 0
    v_mfma_f32_16x16x32_bf16 v[84:87], v[118:121], v[160:163], 0
    v_mfma_f32_16x16x32_bf16 v[172:175], v[104:107], v[168:171], 0
    v_mfma_f32_16x16x32_bf16 v[88:91], v[124:127], v[168:171], 0
    v_mfma_f32_16x16x32_bf16 v[92:95], v[130:133], v[168:171], 0
    v_rcp_f32 v244, v148
    s_nop 0
    v_mul_f32 v64, v64, v244
    v_mul_f32 v65, v65, v244
    v_mul_f32 v66, v66, v244
    v_mul_f32 v67, v67, v244
    v_mul_f32 v68, v68, v244
    v_mul_f32 v69, v69, v244
    v_mul_f32 v70, v70, v244
    v_mul_f32 v71, v71, v244
    v_cvt_pk_bf16_f32 v64, v64, v65
    v_cvt_pk_bf16_f32 v65, v66, v67
    v_cvt_pk_bf16_f32 v66, v68, v69
    v_cvt_pk_bf16_f32 v67, v70, v71
    v_and_b32 v66, v66, v222
    v_and_b32 v67, v67, v222
    buffer_store_dwordx4 v[64:67], v223, s[40:43], s61 offen offset:0 sc1
    v_rcp_f32 v245, v156
    s_nop 0
    v_mul_f32 v72, v72, v245
    v_mul_f32 v73, v73, v245
    v_mul_f32 v74, v74, v245
    v_mul_f32 v75, v75, v245
    v_mul_f32 v76, v76, v245
    v_mul_f32 v77, v77, v245
    v_mul_f32 v78, v78, v245
    v_mul_f32 v79, v79, v245
    v_cvt_pk_bf16_f32 v72, v72, v73
    v_cvt_pk_bf16_f32 v73, v74, v75
    v_cvt_pk_bf16_f32 v74, v76, v77
    v_cvt_pk_bf16_f32 v75, v78, v79
    v_and_b32 v74, v74, v222
    v_and_b32 v75, v75, v222
    buffer_store_dwordx4 v[72:75], v223, s[40:43], s61 offen offset:1024 sc1
    v_rcp_f32 v246, v164
    s_nop 0
    v_mul_f32 v80, v80, v246
    v_mul_f32 v81, v81, v246
    v_mul_f32 v82, v82, v246
    v_mul_f32 v83, v83, v246
    v_mul_f32 v84, v84, v246
    v_mul_f32 v85, v85, v246
    v_mul_f32 v86, v86, v246
    v_mul_f32 v87, v87, v246
    v_cvt_pk_bf16_f32 v80, v80, v81
    v_cvt_pk_bf16_f32 v81, v82, v83
    v_cvt_pk_bf16_f32 v82, v84, v85
    v_cvt_pk_bf16_f32 v83, v86, v87
    v_and_b32 v82, v82, v222
    v_and_b32 v83, v83, v222
    buffer_store_dwordx4 v[80:83], v223, s[40:43], s60 offen offset:0 sc1
    v_rcp_f32 v247, v172
    s_nop 0
    v_mul_f32 v88, v88, v247
    v_mul_f32 v89, v89, v247
    v_mul_f32 v90, v90, v247
    v_mul_f32 v91, v91, v247
    v_mul_f32 v92, v92, v247
    v_mul_f32 v93, v93, v247
    v_mul_f32 v94, v94, v247
    v_mul_f32 v95, v95, v247
    v_cvt_pk_bf16_f32 v88, v88, v89
    v_cvt_pk_bf16_f32 v89, v90, v91
    v_cvt_pk_bf16_f32 v90, v92, v93
    v_cvt_pk_bf16_f32 v91, v94, v95
    v_and_b32 v90, v90, v222
    v_and_b32 v91, v91, v222
    buffer_store_dwordx4 v[88:91], v223, s[40:43], s60 offen offset:1024 sc1
    v_mov_b32 v245, 9
    ds_write_b32 v231, v245
    s_waitcnt vmcnt(0)
L_CFLAG:
    v_lshrrev_b32 v1, 2, v223
    v_mov_b32 v2, s56
    s_mov_b32 exec_lo, 0xffffffff
    s_mov_b32 exec_hi, 0
    buffer_store_dword v2, v1, s[40:43], s69 offen sc1
    s_mov_b64 exec, -1
    v_lshrrev_b32 v0, 4, v223
    s_cmp_lt_u32 s54, 7
    s_cbranch_scc1 L_P2C
    s_lshr_b32 s58, s2, 3
    s_and_b32 s58, s58, 3
    s_lshl_b32 s58, s58, 1
    s_add_u32 s53, s53, s58
    s_sub_u32 s53, s53, 8
    s_and_b32 s58, s53, 1
    s_lshl_b32 s58, s58, 2
    s_add_u32 s58, s58, s57
    s_lshr_b32 s23, s53, 1
    s_lshl_b32 s23, s23, 4
    s_add_u32 s23, s23, s58
    s_lshl_b32 s23, s23, 10
    s_add_u32 s23, s23, 9961472
    s_mul_i32 s60, s53, 294912
    s_add_u32 s60, s60, 262144
    s_mul_i32 s61, s58, 7168
    s_add_u32 s61, s61, s60
    v_min_u32 v4, 55, v0
    v_lshlrev_b32 v4, 7, v4
    v_lshlrev_b32 v6, 7, v0
    s_and_b32 s58, s53, 1
    s_mul_i32 s58, s58, 589824
    s_add_u32 s62, s61, 294912
    s_sub_u32 s62, s62, s58
    s_mul_i32 s58, s57, 73728
    s_add_u32 s60, s60, s58
    s_add_u32 s60, s60, 57344
    s_lshr_b32 s63, s53, 1
    s_lshl_b32 s63, s63, 14
    s_and_b32 s58, s53, 1
    s_lshl_b32 s58, s58, 1
    s_lshr_b32 s59, s57, 1
    s_add_u32 s58, s58, s59
    s_lshl_b32 s58, s58, 7
    s_add_u32 s63, s63, s58
    s_add_u32 s63, s63, 9969664
L_ip1:
    s_buffer_load_dword s4, s[40:43], s23 offset:0 glc
    s_buffer_load_dword s5, s[40:43], s23 offset:128 glc
    s_buffer_load_dword s6, s[40:43], s23 offset:256 glc
    s_buffer_load_dword s7, s[40:43], s23 offset:384 glc
L_ip1_w:
    s_waitcnt lgkmcnt(0)
    s_xor_b32 s4, s4, s56
    s_xor_b32 s5, s5, s56
    s_xor_b32 s6, s6, s56
    s_xor_b32 s7, s7, s56
    s_or_b64 s[4:5], s[4:5], s[6:7]
    s_cbranch_scc0 L_ip1_ok
    s_add_u32 s3, s3, 1
    s_cmp_gt_u32 s3, 2097152
    s_cbranch_scc1 L_ip1_ok
    s_sleep 1
    s_branch L_ip1
L_ip1_ok:
L_ip2:
    s_buffer_load_dword s4, s[40:43], s63 offset:0 glc
    s_buffer_load_dword s5, s[40:43], s63 offset:1024 glc
    s_buffer_load_dword s6, s[40:43], s63 offset:2048 glc
    s_buffer_load_dword s7, s[40:43], s63 offset:3072 glc
    s_buffer_load_dword s8, s[40:43], s63 offset:4096 glc
    s_buffer_load_dword s9, s[40:43], s63 offset:5120 glc
    s_buffer_load_dword s10, s[40:43], s63 offset:6144 glc
    s_buffer_load_dword s11, s[40:43], s63 offset:7168 glc
L_ip2_w:
    s_waitcnt lgkmcnt(0)
    s_xor_b32 s4, s4, s56
    s_xor_b32 s5, s5, s56
    s_xor_b32 s6, s6, s56
    s_xor_b32 s7, s7, s56
    s_xor_b32 s8, s8, s56
    s_xor_b32 s9, s9, s56
    s_xor_b32 s10, s10, s56
    s_xor_b32 s11, s11, s56
    s_or_b64 s[4:5], s[4:5], s[6:7]
    s_or_b64 s[8:9], s[8:9], s[10:11]
    s_or_b64 s[4:5], s[4:5], s[8:9]
    s_cbranch_scc0 L_ip2_ok
    s_add_u32 s3, s3, 1
    s_cmp_gt_u32 s3, 2097152
    s_cbranch_scc1 L_ip2_ok
    s_sleep 1
    s_branch L_ip2
L_ip2_ok:
    buffer_load_dword v5, v6, s[40:43], s60 offen sc1
    s_add_u32 s60, s60, 8192
    buffer_load_dword v5, v6, s[40:43], s60 offen sc1
    s_add_u32 s60, s60, 8192
    s_cmp_lg_u32 s2, 255
    s_cbranch_scc1 L_EXIT
    s_cmp_lg_u32 s48, 4
    s_cbranch_scc1 L_EXIT
    v_lshlrev_b32 v3, 12, v0
    v_add_u32 v3, 9961472, v3
L_bump:
    s_add_u32 s3, s3, 1
    s_cmp_gt_u32 s3, 2097152
    s_cbranch_scc1 L_EXIT
    s_sleep 32
L_bump1:
    buffer_load_dword v4, v3, s[40:43], 0 offen offset:0 sc1
    buffer_load_dword v5, v3, s[40:43], 0 offen offset:1024 sc1
    buffer_load_dword v6, v3, s[40:43], 0 offen offset:2048 sc1
    buffer_load_dword v7, v3, s[40:43], 0 offen offset:3072 sc1
    s_waitcnt vmcnt(0)
    v_xor_b32 v4, v4, v2
    v_xor_b32 v5, v5, v2
    v_xor_b32 v6, v6, v2
    v_xor_b32 v7, v7, v2
    v_or_b32 v4, v4, v5
    v_or_b32 v4, v4, v6
    v_or_b32 v4, v4, v7
    v_cmp_ne_u32 vcc, 0, v4
    s_nop 0
    s_cbranch_vccnz L_bump
    s_mov_b64 exec, 1
    buffer_store_dword v2, v1, s[40:43], 0 offen sc1
    s_mov_b64 exec, -1
    s_branch L_EXIT
L_P2C:
    s_setprio 1
    v_lshrrev_b32 v1, 3, v0
    v_lshl_add_u32 v1, s57, 3, v1
    v_and_b32 v20, 7, v0
    v_mul_u32_u24 v5, 896, v1
    v_lshl_add_u32 v5, v20, 4, v5
    s_mul_i32 s12, s53, 57344
    s_lshl_b32 s58, s54, 7
    s_add_u32 s12, s12, s58
    s_add_u32 s13, s12, 28672
    buffer_load_dwordx4 v[8:11], v5, s[24:27], s12 offen
    buffer_load_dwordx4 v[12:15], v5, s[24:27], s13 offen
    v_lshlrev_b32 v21, 1, v20
    v_xor_b32 v21, v21, v1
    v_and_b32 v21, 15, v21
    v_lshlrev_b32 v21, 4, v21
    v_lshl_add_u32 v2, v1, 8, v21
    v_xor_b32 v3, 16, v2
    v_xor_b32 v21, v1, v20
    v_and_b32 v21, 7, v21
    v_lshlrev_b32 v21, 4, v21
    v_lshl_add_u32 v21, v1, 7, v21
    v_add_u32 v4, 65536, v21
    s_lshl_b32 s58, s57, 10
    v_add_u32 v6, s58, v223
    v_lshlrev_b32 v7, 4, v1
    s_xor_b32 s62, s53, 1
    s_mul_i32 s62, s62, 7
    s_add_u32 s62, s62, s54
    s_lshl_b32 s62, s62, 14
    s_add_u32 s62, s62, 10485760
    s_add_u32 s63, s62, 8192
    s_mul_i32 s66, s53, 7
    s_add_u32 s66, s66, s54
    s_lshl_b32 s66, s66, 14
    s_add_u32 s66, s66, 10485760
    s_add_u32 s67, s66, 8192
    s_lshl_b32 s59, s53, 10
    s_add_u32 s59, s59, 16392
    s_mul_i32 s64, s53, 7
    s_add_u32 s64, s64, s54
    s_lshl_b32 s64, s64, 4
    s_add_u32 s64, s64, s57
    s_lshl_b32 s64, s64, 10
    s_add_u32 s64, s64, 10494972
    v_mov_b32 v113, s56
    s_lshl_b32 s58, s57, 10
    v_lshl_add_u32 v112, v0, 2, s58
    ds_read_b128 v[252:255], v230 offset:0
    s_waitcnt lgkmcnt(0)
    v_min3_u32 v252, v252, v253, v254
    v_min_u32 v252, v252, v255
    v_cmp_gt_u32 vcc, 11, v252
    s_nop 0
    s_cbranch_vccz L_cr0_ok
L_cr0:
    s_add_u32 s3, s3, 1
    s_cmp_gt_u32 s3, 2097152
    s_cbranch_scc1 L_cr0_ok
    s_sleep 1
    ds_read_b128 v[252:255], v230 offset:0
    s_waitcnt lgkmcnt(0)
    v_min3_u32 v252, v252, v253, v254
    v_min_u32 v252, v252, v255
    v_cmp_gt_u32 vcc, 11, v252
    s_nop 0
    s_cbranch_vccnz L_cr0
L_cr0_ok:
    ds_read_b128 v[72:75], v2 offset:0
    ds_read_b128 v[76:79], v3 offset:0
    ds_read_b128 v[80:83], v2 offset:16384
    ds_read_b128 v[84:87], v3 offset:16384
    ds_read_b128 v[88:91], v2 offset:32768
    ds_read_b128 v[92:95], v3 offset:32768
    ds_read_b128 v[96:99], v2 offset:49152
    ds_read_b128 v[100:103], v3 offset:49152
    s_waitcnt lgkmcnt(4)
    v_add_f32 v72, v72, v80
    v_add_f32 v73, v73, v81
    v_add_f32 v74, v74, v82
    v_add_f32 v75, v75, v83
    v_add_f32 v76, v76, v84
    v_add_f32 v77, v77, v85
    v_add_f32 v78, v78, v86
    v_add_f32 v79, v79, v87
    s_waitcnt lgkmcnt(0)
    v_mov_b32 v244, 11
    ds_write_b32 v231, v244
    v_add_f32 v88, v88, v96
    v_add_f32 v89, v89, v97
    v_add_f32 v90, v90, v98
    v_add_f32 v91, v91, v99
    v_add_f32 v92, v92, v100
    v_add_f32 v93, v93, v101
    v_add_f32 v94, v94, v102
    v_add_f32 v95, v95, v103
    v_add_f32 v72, v72, v88
    v_add_f32 v73, v73, v89
    v_add_f32 v74, v74, v90
    v_add_f32 v75, v75, v91
    v_add_f32 v76, v76, v92
    v_add_f32 v77, v77, v93
    v_add_f32 v78, v78, v94
    v_add_f32 v79, v79, v95
    v_cvt_pk_bf16_f32 v116, v72, v73
    v_cvt_pk_bf16_f32 v117, v74, v75
    v_cvt_pk_bf16_f32 v118, v76, v77
    v_cvt_pk_bf16_f32 v119, v78, v79
    buffer_store_dwordx4 v[116:119], v6, s[40:43], s62 offen sc1
    s_waitcnt vmcnt(0)
    s_mov_b32 exec_hi, 0
    buffer_store_dword v113, v112, s[40:43], s63 offen offset:896 sc1
    s_mov_b32 exec_hi, -1
    s_add_u32 s62, s62, 4096
    s_add_u32 s63, s63, 4096
    buffer_load_dword v16, v7, s[40:43], s59 offen offset:0 sc1
    buffer_load_dword v18, v7, s[40:43], s59 offen offset:512 sc1
    s_waitcnt vmcnt(4)
    v_lshlrev_b32 v40, 16, v8
    v_and_b32 v41, 0xffff0000, v8
    v_lshlrev_b32 v42, 16, v9
    v_and_b32 v43, 0xffff0000, v9
    v_lshlrev_b32 v44, 16, v10
    v_and_b32 v45, 0xffff0000, v10
    v_lshlrev_b32 v46, 16, v11
    v_and_b32 v47, 0xffff0000, v11
    v_lshlrev_b32 v48, 16, v12
    v_and_b32 v49, 0xffff0000, v12
    v_lshlrev_b32 v50, 16, v13
    v_and_b32 v51, 0xffff0000, v13
    v_lshlrev_b32 v52, 16, v14
    v_and_b32 v53, 0xffff0000, v14
    v_lshlrev_b32 v54, 16, v15
    v_and_b32 v55, 0xffff0000, v15
    ds_read_b128 v[252:255], v230 offset:0
    s_waitcnt lgkmcnt(0)
    v_min3_u32 v252, v252, v253, v254
    v_min_u32 v252, v252, v255
    v_cmp_gt_u32 vcc, 13, v252
    s_nop 0
    s_cbranch_vccz L_cr1_ok
L_cr1:
    s_add_u32 s3, s3, 1
    s_cmp_gt_u32 s3, 2097152
    s_cbranch_scc1 L_cr1_ok
    s_sleep 1
    ds_read_b128 v[252:255], v230 offset:0
    s_waitcnt lgkmcnt(0)
    v_min3_u32 v252, v252, v253, v254
    v_min_u32 v252, v252, v255
    v_cmp_gt_u32 vcc, 13, v252
    s_nop 0
    s_cbranch_vccnz L_cr1
L_cr1_ok:
    ds_read_b128 v[72:75], v2 offset:8192
    ds_read_b128 v[76:79], v3 offset:8192
    ds_read_b128 v[80:83], v2 offset:24576
    ds_read_b128 v[84:87], v3 offset:24576
    ds_read_b128 v[88:91], v2 offset:40960
    ds_read_b128 v[92:95], v3 offset:40960
    ds_read_b128 v[96:99], v2 offset:57344
    ds_read_b128 v[100:103], v3 offset:57344
    s_waitcnt lgkmcnt(4)
    v_add_f32 v72, v72, v80
    v_add_f32 v73, v73, v81
    v_add_f32 v74, v74, v82
    v_add_f32 v75, v75, v83
    v_add_f32 v76, v76, v84
    v_add_f32 v77, v77, v85
    v_add_f32 v78, v78, v86
    v_add_f32 v79, v79, v87
    s_waitcnt lgkmcnt(0)
    v_mov_b32 v244, 12
    ds_write_b32 v231, v244
    v_add_f32 v88, v88, v96
    v_add_f32 v89, v89, v97
    v_add_f32 v90, v90, v98
    v_add_f32 v91, v91, v99
    v_add_f32 v92, v92, v100
    v_add_f32 v93, v93, v101
    v_add_f32 v94, v94, v102
    v_add_f32 v95, v95, v103
    v_add_f32 v72, v72, v88
    v_add_f32 v73, v73, v89
    v_add_f32 v74, v74, v90
    v_add_f32 v75, v75, v91
    v_add_f32 v76, v76, v92
    v_add_f32 v77, v77, v93
    v_add_f32 v78, v78, v94
    v_add_f32 v79, v79, v95
    v_cvt_pk_bf16_f32 v124, v72, v73
    v_cvt_pk_bf16_f32 v125, v74, v75
    v_cvt_pk_bf16_f32 v126, v76, v77
    v_cvt_pk_bf16_f32 v127, v78, v79
    buffer_store_dwordx4 v[124:127], v6, s[40:43], s62 offen sc1
    s_waitcnt vmcnt(0)
    s_mov_b32 exec_hi, 0
    buffer_store_dword v113, v112, s[40:43], s63 offen offset:896 sc1
    s_mov_b32 exec_hi, -1
    s_setprio 1
    s_add_u32 s14, s66, 4096
    s_add_u32 s15, s67, 4096
L_cx0:
    s_buffer_load_dword s4, s[40:43], s64 offset:0 glc
L_cx0_w:
    s_waitcnt lgkmcnt(0)
    s_xor_b32 s4, s4, s56
    s_cbranch_scc0 L_cx0_ok
    s_add_u32 s3, s3, 1
    s_cmp_gt_u32 s3, 2097152
    s_cbranch_scc1 L_cx0_ok
    s_sleep 1
    s_branch L_cx0
L_cx0_ok:
    buffer_load_dwordx4 v[24:27], v6, s[40:43], s66 offen sc1
L_cx1:
    s_buffer_load_dword s4, s[40:43], s64 offset:4096 glc
L_cx1_w:
    s_waitcnt lgkmcnt(0)
    s_xor_b32 s4, s4, s56
    s_cbranch_scc0 L_cx1_ok
    s_add_u32 s3, s3, 1
    s_cmp_gt_u32 s3, 2097152
    s_cbranch_scc1 L_cx1_ok
    s_sleep 1
    s_branch L_cx1
L_cx1_ok:
    buffer_load_dwordx4 v[32:35], v6, s[40:43], s14 offen sc1
    ds_read_b128 v[252:255], v230 offset:0
    s_waitcnt lgkmcnt(0)
    v_min3_u32 v252, v252, v253, v254
    v_min_u32 v252, v252, v255
    v_cmp_gt_u32 vcc, 15, v252
    s_nop 0
    s_cbranch_vccz L_cg0_ok
L_cg0:
    s_add_u32 s3, s3, 1
    s_cmp_gt_u32 s3, 2097152
    s_cbranch_scc1 L_cg0_ok
    s_sleep 1
    ds_read_b128 v[252:255], v230 offset:0
    s_waitcnt lgkmcnt(0)
    v_min3_u32 v252, v252, v253, v254
    v_min_u32 v252, v252, v255
    v_cmp_gt_u32 vcc, 15, v252
    s_nop 0
    s_cbranch_vccnz L_cg0
L_cg0_ok:
    ds_read_b128 v[72:75], v2 offset:0
    ds_read_b128 v[76:79], v3 offset:0
    ds_read_b128 v[80:83], v2 offset:16384
    ds_read_b128 v[84:87], v3 offset:16384
    ds_read_b128 v[88:91], v2 offset:32768
    ds_read_b128 v[92:95], v3 offset:32768
    ds_read_b128 v[96:99], v2 offset:49152
    ds_read_b128 v[100:103], v3 offset:49152
    s_waitcnt lgkmcnt(4)
    v_add_f32 v72, v72, v80
    v_add_f32 v73, v73, v81
    v_add_f32 v74, v74, v82
    v_add_f32 v75, v75, v83
    v_add_f32 v76, v76, v84
    v_add_f32 v77, v77, v85
    v_add_f32 v78, v78, v86
    v_add_f32 v79, v79, v87
    s_waitcnt lgkmcnt(0)
    v_add_f32 v88, v88, v96
    v_add_f32 v89, v89, v97
    v_add_f32 v90, v90, v98
    v_add_f32 v91, v91, v99
    v_add_f32 v92, v92, v100
    v_add_f32 v93, v93, v101
    v_add_f32 v94, v94, v102
    v_add_f32 v95, v95, v103
    v_add_f32 v72, v72, v88
    v_add_f32 v73, v73, v89
    v_add_f32 v74, v74, v90
    v_add_f32 v75, v75, v91
    v_add_f32 v76, v76, v92
    v_add_f32 v77, v77, v93
    v_add_f32 v78, v78, v94
    v_add_f32 v79, v79, v95
    s_waitcnt vmcnt(1)
    v_rcp_f32 v17, v16
    s_nop 0
    v_mul_f32 v17, 0xbfb8aa3b, v17
    v_rcp_f32 v19, v18
    s_nop 0
    v_mul_f32 v19, 0xbfb8aa3b, v19
    v_lshlrev_b32 v56, 16, v24
    v_and_b32 v57, 0xffff0000, v24
    v_lshlrev_b32 v58, 16, v25
    v_and_b32 v59, 0xffff0000, v25
    v_lshlrev_b32 v60, 16, v26
    v_and_b32 v61, 0xffff0000, v26
    v_lshlrev_b32 v62, 16, v27
    v_and_b32 v63, 0xffff0000, v27
    v_add_f32 v56, v56, v72
    v_add_f32 v57, v57, v73
    v_add_f32 v58, v58, v74
    v_add_f32 v59, v59, v75
    v_add_f32 v60, v60, v76
    v_add_f32 v61, v61, v77
    v_add_f32 v62, v62, v78
    v_add_f32 v63, v63, v79
    v_mul_f32 v104, v17, v56
    v_mul_f32 v105, v17, v57
    v_mul_f32 v106, v17, v58
    v_mul_f32 v107, v17, v59
    v_mul_f32 v108, v17, v60
    v_mul_f32 v109, v17, v61
    v_mul_f32 v110, v17, v62
    v_mul_f32 v111, v17, v63
    v_exp_f32 v104, v104
    v_exp_f32 v105, v105
    v_exp_f32 v106, v106
    v_exp_f32 v107, v107
    v_exp_f32 v108, v108
    v_exp_f32 v109, v109
    v_exp_f32 v110, v110
    v_exp_f32 v111, v111
    v_fma_f32 v104, v104, v16, v16
    v_fma_f32 v105, v105, v16, v16
    v_fma_f32 v106, v106, v16, v16
    v_fma_f32 v107, v107, v16, v16
    v_fma_f32 v108, v108, v16, v16
    v_fma_f32 v109, v109, v16, v16
    v_fma_f32 v110, v110, v16, v16
    v_fma_f32 v111, v111, v16, v16
    v_rcp_f32 v104, v104
    v_rcp_f32 v105, v105
    v_rcp_f32 v106, v106
    v_rcp_f32 v107, v107
    v_rcp_f32 v108, v108
    v_rcp_f32 v109, v109
    v_rcp_f32 v110, v110
    v_rcp_f32 v111, v111
    v_mul_f32 v56, v56, v104
    v_mul_f32 v57, v57, v105
    v_mul_f32 v58, v58, v106
    v_mul_f32 v59, v59, v107
    v_mul_f32 v60, v60, v108
    v_mul_f32 v61, v61, v109
    v_mul_f32 v62, v62, v110
    v_mul_f32 v63, v63, v111
    ds_read_b128 v[252:255], v230 offset:0
    s_waitcnt lgkmcnt(0)
    v_min3_u32 v252, v252, v253, v254
    v_min_u32 v252, v252, v255
    v_cmp_gt_u32 vcc, 17, v252
    s_nop 0
    s_cbranch_vccz L_cg1_ok
L_cg1:
    s_add_u32 s3, s3, 1
    s_cmp_gt_u32 s3, 2097152
    s_cbranch_scc1 L_cg1_ok
    ds_read_b128 v[252:255], v230 offset:0
    s_waitcnt lgkmcnt(0)
    v_min3_u32 v252, v252, v253, v254
    v_min_u32 v252, v252, v255
    v_cmp_gt_u32 vcc, 17, v252
    s_nop 0
    s_cbranch_vccnz L_cg1
L_cg1_ok:
    ds_read_b128 v[72:75], v2 offset:8192
    ds_read_b128 v[76:79], v3 offset:8192
    ds_read_b128 v[80:83], v2 offset:24576
    ds_read_b128 v[84:87], v3 offset:24576
    ds_read_b128 v[88:91], v2 offset:40960
    ds_read_b128 v[92:95], v3 offset:40960
    ds_read_b128 v[96:99], v2 offset:57344
    ds_read_b128 v[100:103], v3 offset:57344
    s_waitcnt lgkmcnt(4)
    v_add_f32 v72, v72, v80
    v_add_f32 v73, v73, v81
    v_add_f32 v74, v74, v82
    v_add_f32 v75, v75, v83
    v_add_f32 v76, v76, v84
    v_add_f32 v77, v77, v85
    v_add_f32 v78, v78, v86
    v_add_f32 v79, v79, v87
    s_waitcnt lgkmcnt(0)
    v_add_f32 v88, v88, v96
    v_add_f32 v89, v89, v97
    v_add_f32 v90, v90, v98
    v_add_f32 v91, v91, v99
    v_add_f32 v92, v92, v100
    v_add_f32 v93, v93, v101
    v_add_f32 v94, v94, v102
    v_add_f32 v95, v95, v103
    v_add_f32 v72, v72, v88
    v_add_f32 v73, v73, v89
    v_add_f32 v74, v74, v90
    v_add_f32 v75, v75, v91
    v_add_f32 v76, v76, v92
    v_add_f32 v77, v77, v93
    v_add_f32 v78, v78, v94
    v_add_f32 v79, v79, v95
    s_waitcnt vmcnt(0)
    v_lshlrev_b32 v64, 16, v32
    v_and_b32 v65, 0xffff0000, v32
    v_lshlrev_b32 v66, 16, v33
    v_and_b32 v67, 0xffff0000, v33
    v_lshlrev_b32 v68, 16, v34
    v_and_b32 v69, 0xffff0000, v34
    v_lshlrev_b32 v70, 16, v35
    v_and_b32 v71, 0xffff0000, v35
    v_add_f32 v64, v64, v72
    v_add_f32 v65, v65, v73
    v_add_f32 v66, v66, v74
    v_add_f32 v67, v67, v75
    v_add_f32 v68, v68, v76
    v_add_f32 v69, v69, v77
    v_add_f32 v70, v70, v78
    v_add_f32 v71, v71, v79
    v_mul_f32 v104, v19, v64
    v_mul_f32 v105, v19, v65
    v_mul_f32 v106, v19, v66
    v_mul_f32 v107, v19, v67
    v_mul_f32 v108, v19, v68
    v_mul_f32 v109, v19, v69
    v_mul_f32 v110, v19, v70
    v_mul_f32 v111, v19, v71
    v_exp_f32 v104, v104
    v_exp_f32 v105, v105
    v_exp_f32 v106, v106
    v_exp_f32 v107, v107
    v_exp_f32 v108, v108
    v_exp_f32 v109, v109
    v_exp_f32 v110, v110
    v_exp_f32 v111, v111
    v_fma_f32 v104, v104, v18, v18
    v_fma_f32 v105, v105, v18, v18
    v_fma_f32 v106, v106, v18, v18
    v_fma_f32 v107, v107, v18, v18
    v_fma_f32 v108, v108, v18, v18
    v_fma_f32 v109, v109, v18, v18
    v_fma_f32 v110, v110, v18, v18
    v_fma_f32 v111, v111, v18, v18
    v_rcp_f32 v104, v104
    v_rcp_f32 v105, v105
    v_rcp_f32 v106, v106
    v_rcp_f32 v107, v107
    v_rcp_f32 v108, v108
    v_rcp_f32 v109, v109
    v_rcp_f32 v110, v110
    v_rcp_f32 v111, v111
    v_mul_f32 v64, v64, v104
    v_mul_f32 v65, v65, v105
    v_mul_f32 v66, v66, v106
    v_mul_f32 v67, v67, v107
    v_mul_f32 v68, v68, v108
    v_mul_f32 v69, v69, v109
    v_mul_f32 v70, v70, v110
    v_mul_f32 v71, v71, v111
    s_barrier
    ds_read_b128 v[8:11], v4 offset:0
    ds_read_b128 v[12:15], v4 offset:4096
    s_waitcnt lgkmcnt(1)
    v_lshlrev_b32 v72, 16, v8
    v_and_b32 v73, 0xffff0000, v8
    v_lshlrev_b32 v74, 16, v9
    v_and_b32 v75, 0xffff0000, v9
    v_lshlrev_b32 v76, 16, v10
    v_and_b32 v77, 0xffff0000, v10
    v_lshlrev_b32 v78, 16, v11
    v_and_b32 v79, 0xffff0000, v11
    v_pk_fma_f32 v[40:41], v[72:73], v[56:57], v[40:41]
    v_pk_fma_f32 v[42:43], v[74:75], v[58:59], v[42:43]
    v_pk_fma_f32 v[44:45], v[76:77], v[60:61], v[44:45]
    v_pk_fma_f32 v[46:47], v[78:79], v[62:63], v[46:47]
    v_cvt_pk_bf16_f32 v104, v40, v41
    v_cvt_pk_bf16_f32 v105, v42, v43
    v_cvt_pk_bf16_f32 v106, v44, v45
    v_cvt_pk_bf16_f32 v107, v46, v47
    buffer_store_dwordx4 v[104:107], v5, s[44:47], s12 offen sc1
    s_waitcnt lgkmcnt(0)
    v_lshlrev_b32 v72, 16, v12
    v_and_b32 v73, 0xffff0000, v12
    v_lshlrev_b32 v74, 16, v13
    v_and_b32 v75, 0xffff0000, v13
    v_lshlrev_b32 v76, 16, v14
    v_and_b32 v77, 0xffff0000, v14
    v_lshlrev_b32 v78, 16, v15
    v_and_b32 v79, 0xffff0000, v15
    v_pk_fma_f32 v[48:49], v[72:73], v[64:65], v[48:49]
    v_pk_fma_f32 v[50:51], v[74:75], v[66:67], v[50:51]
    v_pk_fma_f32 v[52:53], v[76:77], v[68:69], v[52:53]
    v_pk_fma_f32 v[54:55], v[78:79], v[70:71], v[54:55]
    v_cvt_pk_bf16_f32 v108, v48, v49
    v_cvt_pk_bf16_f32 v109, v50, v51
    v_cvt_pk_bf16_f32 v110, v52, v53
    v_cvt_pk_bf16_f32 v111, v54, v55
    buffer_store_dwordx4 v[108:111], v5, s[44:47], s13 offen sc1
L_EXIT:
L_END:
    s_endpgm
.section .rodata,"a"
.p2align 6
.amdhsa_kernel recurrent_scan__sliding_local_dilated__dense_activation_relu__prompt_kernel
  .amdhsa_next_free_vgpr 256
  .amdhsa_next_free_sgpr 102
  .amdhsa_accum_offset 256
  .amdhsa_group_segment_fixed_size 0
  .amdhsa_kernarg_size 72
  .amdhsa_user_sgpr_count 2
  .amdhsa_user_sgpr_kernarg_segment_ptr 1
  .amdhsa_system_sgpr_workgroup_id_x 1
.end_amdhsa_kernel
```
